```python
import torch

def _softmax(x, axis=-1):
    return torch.softmax(x, dim=axis)
def _gelu(x):
    return torch.nn.functional.gelu(x, approximate="tanh")
def _silu(x):
    return torch.nn.functional.silu(x)
def _sigmoid(x):
    return torch.sigmoid(x)
def _layernorm(x, axis=-1, eps=1e-5):
    m = x.mean(dim=axis, keepdim=True)
    v = x.var(dim=axis, keepdim=True, unbiased=False)
    return (x - m) / torch.sqrt(v + eps)
def _scatter_add(tgt, idx, src, axis=0):
    return tgt.clone().index_add_(axis, idx, src)
def _segment_sum(src, seg, n):
    out = torch.zeros((n,) + src.shape[1:], dtype=src.dtype)
    return out.index_add_(0, seg, src)
def _pad(x, pw):
    flat = tuple(v for pair in reversed(pw) for v in pair)
    return torch.nn.functional.pad(x, flat)

kernel_name = 'concat_heads__sliding_local_dilated__linear_kernel_hedgehog__prompt'

def setup_inputs():

    _w = (lambda a: (lambda t: t.to(torch.bfloat16) if t.is_floating_point() else t)(torch.as_tensor(a)))
    def _A_setup():
        B, S, D = 1, 2048, 640
        return {
            "x": _w((lambda *s: torch.randn(*s, dtype=torch.bfloat16) * 0.2)(B, S, D)),
            "wqkv": _w((lambda *s: torch.randn(*s, dtype=torch.bfloat16) * 0.2)(D, 3 * D)),
            "wo": _w((lambda *s: torch.randn(*s, dtype=torch.bfloat16) * 0.05)(D, D)),
        }
    _A_in = _A_setup()

    def _B_setup():
        B, S, D, H = 1, 2048, 640, 32
        Dh = D // H
        return {
            "x": _w((lambda *s: torch.randn(*s, dtype=torch.bfloat16) * 0.2)(B, S, D)),
            "wqkv": _w((lambda *s: torch.randn(*s, dtype=torch.bfloat16) * 0.8)(D, 3 * D)),
            "w_phi": _w((lambda *s: torch.randn(*s, dtype=torch.bfloat16) * 0.8)(H, Dh, Dh) * (Dh ** -0.5)),
            "wo": _w((lambda *s: torch.randn(*s, dtype=torch.bfloat16) * 0.2)(D, D)),
        }
    _B_in = _B_setup()

    return {
        "A_x": _A_in["x"],
        "A_wqkv": _A_in["wqkv"],
        "A_wo": _A_in["wo"],
        "B_x": _B_in["x"],
        "B_wqkv": _B_in["wqkv"],
        "B_w_phi": _B_in["w_phi"],
        "B_wo": _B_in["wo"],
    }

def reference(A_x, A_wqkv, A_wo, B_x, B_wqkv, B_w_phi, B_wo):
    def _A_ref(x, wqkv, wo):
        B, S, D = x.shape
        H = 32; Dh = D // H
        W, dil = 8, 2
        qkv = (lambda x, *d: x.permute(*d))((x @ wqkv).reshape(B, S, 3, H, Dh), 2, 0, 3, 1, 4)
        q, k, v = qkv[0], qkv[1], qkv[2]
        scale = Dh ** -0.5
        pos = torch.arange(S)
        off = torch.arange(W) * dil
        idx = pos[:, None] - off[None, :]
        mask = idx >= 0
        idx_c = torch.where(mask, idx, 0).reshape(-1)
        kg = k[:, :, idx_c, :].reshape(B, H, S, W, Dh)
        vg = v[:, :, idx_c, :].reshape(B, H, S, W, Dh)
        logits = torch.einsum("bhsd,bhswd->bhsw", q, kg) * scale
        logits = torch.where(mask[None, None, :, :], logits, -1e9)
        attn = _softmax(logits, axis=-1)
        o = torch.einsum("bhsw,bhswd->bhsd", attn, vg)
        return (lambda x, *d: x.permute(*d))(o, 0, 2, 1, 3).reshape(B, S, D) @ wo

    def _B_ref(x, wqkv, w_phi, wo):
        B, S, D = x.shape
        H = 32; Dh = D // H
        qkv = (lambda x, *d: x.permute(*d))((x @ wqkv).reshape(B, S, 3, H, Dh), 2, 0, 3, 1, 4)
        q, k, v = qkv[0], qkv[1], qkv[2]
        pq = torch.einsum("bhsd,hdf->bhsf", q, w_phi)
        pk = torch.einsum("bhsd,hdf->bhsf", k, w_phi)
        phi_q = torch.concatenate([_softmax(pq, axis=-1), _softmax(-pq, axis=-1)], axis=-1)
        phi_k = torch.concatenate([_softmax(pk, axis=-1), _softmax(-pk, axis=-1)], axis=-1)
        kv = torch.einsum("bhsf,bhsd->bhfd", phi_k, v)
        z  = torch.einsum("bhsf->bhf", phi_k)
        num = torch.einsum("bhqf,bhfd->bhqd", phi_q, kv)
        den = torch.einsum("bhqf,bhf->bhq", phi_q, z)[..., None] + 1e-6
        o = num / den
        return (lambda x, *d: x.permute(*d))(o, 0, 2, 1, 3).reshape(B, S, D) @ wo

    a = _A_ref(A_x, A_wqkv, A_wo)
    b = _B_ref(B_x, B_wqkv, B_w_phi, B_wo)
    return torch.concatenate([a, b], axis=-1)
```

```asm
; @launch grid=(256,1,1) block=(512,1,1) lds=163840
.amdgcn_target "amdgcn-amd-amdhsa--gfx950"
.text
.set WPHI_ADDR, 159744
.set ZERO_ADDR, 162944
.set AUX_OFF, 8
.set PF_EXTRA, (k_end - concat_heads__sliding_local_dilated__linear_kernel_hedgehog__prompt_kernel - 33792) / 1024
.globl concat_heads__sliding_local_dilated__linear_kernel_hedgehog__prompt_kernel
.p2align 8
.type concat_heads__sliding_local_dilated__linear_kernel_hedgehog__prompt_kernel,@function
concat_heads__sliding_local_dilated__linear_kernel_hedgehog__prompt_kernel:
  s_cmp_ge_u32 s2, 256
  s_cbranch_scc1 k_end
  s_load_dwordx16 s[16:31], s[0:1], 0
  s_load_dwordx4 s[32:35], s[0:1], 64
  v_lshrrev_b32 v4, 6, v0
  v_and_b32 v1, 63, v0
  v_readfirstlane_b32 s8, v4
  s_and_b32 s3, s2, 7
  s_lshr_b32 s5, s3, 2
  s_lshr_b32 s4, s2, 3
  s_and_b32 s6, s3, 1
  s_lshl_b32 s6, s6, 3
  s_and_b32 s9, s4, 7
  s_add_u32 s6, s6, s9
  s_bfe_u32 s7, s3, 0x10001
  s_lshl_b32 s7, s7, 2
  s_lshr_b32 s10, s4, 3
  s_add_u32 s7, s7, s10
  v_lshrrev_b32 v2, 4, v1
  v_and_b32 v3, 15, v1
  v_mov_b32 v15, 0
  v_mov_b32 v0, 163584
  s_and_b32 s11, s8, 6
  s_cmp_eq_u32 s11, 4
  s_cbranch_scc1 k_ld
  s_cmp_eq_u32 s8, 6
  s_cselect_b32 s11, s5, 0
  s_cmp_eq_u32 s11, 1
  s_cbranch_scc0 k_nost
  v_lshlrev_b32 v8, 4, v1
  s_mul_i32 s9, s7, 3200
  s_mov_b32 s54, 25600
  s_mov_b32 s55, 0x20000
  s_mov_b32 m0, WPHI_ADDR
  s_waitcnt lgkmcnt(0)
  s_mov_b32 s52, s26
  s_mov_b32 s53, s27
  buffer_load_dwordx4 v8, s[52:55], s9 offen lds
  buffer_load_dwordx4 v8, s[52:55], s9 offen offset:1024 lds
  buffer_load_dwordx4 v8, s[52:55], s9 offen offset:2048 lds
  s_mov_b64 exec, 0xff
  buffer_load_dwordx4 v8, s[52:55], s9 offen offset:3072 lds
  s_mov_b64 exec, -1
k_nost:
  s_cmp_eq_u32 s8, 7
  s_cbranch_scc0 k_nopc
  s_getpc_b64 s[10:11]
  s_lshl_b32 s9, s4, 10
  s_add_u32 s9, s9, 1024
  s_add_u32 s10, s10, s9
  s_addc_u32 s11, s11, 0
  v_lshlrev_b32 v8, 4, v1
  v_add_co_u32 v22, vcc, s10, v8
  v_mov_b32 v23, s11
  s_nop 0
  v_addc_co_u32 v23, vcc, 0, v23, vcc
  global_load_dwordx4 v[24:27], v[22:23], off
  v_add_co_u32 v22, vcc, 0x8000, v22
  s_nop 1
  v_addc_co_u32 v23, vcc, 0, v23, vcc
  s_cmp_lt_u32 s4, PF_EXTRA
  s_cbranch_scc0 k_nopc
  global_load_dwordx4 v[24:27], v[22:23], off
k_nopc:
  s_barrier
  s_lshl_b32 s9, s5, 3
  s_add_u32 s9, s9, s8
  s_cmp_lt_u32 s9, 14
  s_cbranch_scc1 k_noaux
  s_cmp_eq_u32 s9, 14
  s_cbranch_scc1 k_aux6
  v_lshlrev_b32 v9, 3, v1
  v_add_u32 v9, ZERO_ADDR, v9
  v_mov_b32 v16, 0
  v_mov_b32 v17, 0
  ds_write_b64 v9, v[16:17]
  s_mov_b64 exec, 0xffff
  ds_write_b64 v9, v[16:17] offset:512
  s_mov_b64 exec, -1
  s_waitcnt lgkmcnt(0)
  s_branch k_aux7
k_aux6:
  s_waitcnt vmcnt(0)
k_aux7:
  s_lshl_b32 s10, s8, 2
  v_add_u32 v9, s10, v0
  v_mov_b32 v12, 0x7ffffff0
  ds_write_b32 v9, v12 offset:AUX_OFF
k_noaux:
  s_cmp_eq_u32 s9, 0
  s_cbranch_scc1 k_A0
  s_cmp_eq_u32 s9, 1
  s_cbranch_scc1 k_A1
  s_cmp_eq_u32 s9, 2
  s_cbranch_scc1 k_A2
  s_cmp_eq_u32 s9, 3
  s_cbranch_scc1 k_A3
  s_cmp_ge_u32 s8, 6
  s_cbranch_scc1 k_h567
  s_branch k_notld
k_ld:
  s_cmp_eq_u32 s5, 0
  s_cbranch_scc0 k_sqB
  s_lshl_b32 s10, s10, 2
  s_lshr_b32 s12, 0x4300, s10
  s_add_u32 s9, s9, s12
  s_and_b32 s9, s9, 7
  s_lshr_b32 s79, 0x1560, s10
  s_and_b32 s79, s79, 15
  s_mov_b32 s96, 0x48265139
  s_mov_b32 s97, 0x7
  s_cmp_eq_u32 s9, 1
  s_cselect_b32 s96, 0x8237591, s96
  s_cselect_b32 s97, 0x46, s97
  s_cmp_eq_u32 s9, 2
  s_cselect_b32 s96, 0x90318465, s96
  s_cselect_b32 s97, 0x27, s97
  s_cmp_eq_u32 s9, 3
  s_cselect_b32 s96, 0x28736941, s96
  s_cselect_b32 s97, 0x5, s97
  s_cmp_eq_u32 s9, 4
  s_cselect_b32 s96, 0x73986504, s96
  s_cselect_b32 s97, 0x21, s97
  s_cmp_eq_u32 s9, 5
  s_cselect_b32 s96, 0x62538104, s96
  s_cselect_b32 s97, 0x79, s97
  s_cmp_eq_u32 s9, 6
  s_cselect_b32 s96, 0x74120586, s96
  s_cselect_b32 s97, 0x93, s97
  s_cmp_eq_u32 s9, 7
  s_cselect_b32 s96, 0x17482960, s96
  s_cselect_b32 s97, 0x53, s97
  s_branch k_sqd
k_sqB:
  s_lshl_b32 s10, s10, 2
  s_lshr_b32 s12, 0x1230, s10
  s_add_u32 s9, s9, s12
  s_and_b32 s9, s9, 7
  s_lshr_b32 s79, 0x3030, s10
  s_and_b32 s79, s79, 15
  s_mov_b32 s96, 0x96372054
  s_mov_b32 s97, 0x81
  s_cmp_eq_u32 s9, 1
  s_cselect_b32 s96, 0x23798501, s96
  s_cselect_b32 s97, 0x46, s97
  s_cmp_eq_u32 s9, 2
  s_cselect_b32 s96, 0x83905241, s96
  s_cselect_b32 s97, 0x76, s97
  s_cmp_eq_u32 s9, 3
  s_cselect_b32 s96, 0x6743851, s96
  s_cselect_b32 s97, 0x29, s97
  s_cmp_eq_u32 s9, 4
  s_cselect_b32 s96, 0x93214058, s96
  s_cselect_b32 s97, 0x67, s97
  s_cmp_eq_u32 s9, 5
  s_cselect_b32 s96, 0x20387415, s96
  s_cselect_b32 s97, 0x96, s97
  s_cmp_eq_u32 s9, 6
  s_cselect_b32 s96, 0x3625418, s96
  s_cselect_b32 s97, 0x79, s97
  s_cmp_eq_u32 s9, 7
  s_cselect_b32 s96, 0x63049851, s96
  s_cselect_b32 s97, 0x72, s97
k_sqd:
  v_lshrrev_b32 v8, 3, v1
  v_mul_u32_u24 v8, 1280, v8
  v_and_b32 v9, 7, v1
  v_xor_b32 v9, v9, v2
  v_lshl_add_u32 v24, v9, 4, v8
  v_xor_b32 v25, 64, v24
  v_add_u32 v25, 9216, v25
  v_add_u32 v26, 18432, v24
  v_add_u32 v27, 18432, v25
  v_mul_u32_u24 v8, 26, v1
  v_lshrrev_b32 v8, 8, v8
  v_mul_u32_u24 v9, 10, v8
  v_sub_u32 v9, v1, v9
  v_lshlrev_b32 v9, 4, v9
  v_mul_u32_u24 v32, 3840, v8
  v_add_u32 v32, v32, v9
  v_add_u32 v33, 30080, v32
  v_add_u32 v34, 14080, v32
  v_add_u32 v35, 44160, v32
  s_cmp_eq_u32 s5, 0
  s_cselect_b32 s9, 0x7ffffff0, 0
  v_mov_b32 v4, s9
  v_lshrrev_b32 v5, 1, v1
  v_cmp_eq_u32 vcc, 4, v5
  s_nop 1
  v_cndmask_b32 v6, v15, v4, vcc
  s_mov_b32 s10, 0
  s_mov_b32 s11, 0x1f4fffff
  v_cndmask_b32 v6, v6, 1, s[10:11]
  v_lshl_add_u32 v4, v1, 2, v0
  s_and_b32 s10, s8, 1
  s_cbranch_scc1 k_noinit
  ds_write_b32 v4, v6
k_noinit:
  s_mul_i32 s73, s10, 5120
  s_mul_i32 s75, s10, 122880
  s_mul_i32 s64, s6, 163840
  s_sub_u32 s65, s64, 20480
  s_cmp_eq_u32 s6, 0
  s_cselect_b32 s65, 0, s65
  s_mov_b32 s66, -1
  s_mov_b32 s67, 0x0fffffff
  s_mov_b32 s68, -1
  s_mov_b32 s69, 0xff
  s_mul_i32 s70, s7, 160
  s_add_u32 s75, s75, s70
  s_lshl_b32 s77, s10, 2
  s_add_u32 s77, s77, 163712
  v_mov_b32 v7, 0x7fffff00
  s_mov_b32 s38, 2621440
  s_mov_b32 s39, 0x20000
  s_mov_b32 s42, 2457600
  s_mov_b32 s43, 0x20000
  s_cmp_eq_u32 s5, 0
  s_waitcnt lgkmcnt(0)
  s_cselect_b32 s36, s16, s22
  s_cselect_b32 s37, s17, s23
  s_cselect_b32 s40, s18, s24
  s_cselect_b32 s41, s19, s25
  s_barrier
  s_mov_b32 s48, s32
  s_mov_b32 s49, s33
  s_mov_b32 s50, 256
  s_mov_b32 s51, 0x20000
  s_and_b32 s12, s96, 15
  s_add_u32 s12, s12, s79
  s_cmp_ge_u32 s12, 10
  s_cselect_b32 s9, 10, 0
  s_sub_u32 s12, s12, s9
  s_lshr_b64 s[96:97], s[96:97], 4
  s_lshl_b32 s13, s12, 7
  s_mul_i32 s71, s12, 245760
  s_add_u32 s71, s71, s75
  s_add_u32 s74, s64, s13
  s_cmp_eq_u32 s5, 0
  s_cselect_b32 s11, 2048, 0
  s_cmp_eq_u32 s8, 4
  s_cbranch_scc0 k_f_nx
  s_add_u32 m0, s11, 0
  s_add_u32 s15, s64, s13
  buffer_load_dwordx4 v24, s[36:39], s15 offen offset:0 lds
  buffer_load_dwordx4 v25, s[36:39], s15 offen offset:1024 lds
  buffer_load_dwordx4 v26, s[36:39], s15 offen offset:2048 lds
  buffer_load_dwordx4 v27, s[36:39], s15 offen offset:3072 lds
  s_add_u32 m0, s11, 4096
  s_add_u32 s15, s74, 40960
  buffer_load_dwordx4 v24, s[36:39], s15 offen offset:0 lds
  buffer_load_dwordx4 v25, s[36:39], s15 offen offset:1024 lds
  buffer_load_dwordx4 v26, s[36:39], s15 offen offset:2048 lds
  buffer_load_dwordx4 v27, s[36:39], s15 offen offset:3072 lds
  s_add_u32 m0, s11, 8192
  s_add_u32 s15, s74, 81920
  buffer_load_dwordx4 v24, s[36:39], s15 offen offset:0 lds
  buffer_load_dwordx4 v25, s[36:39], s15 offen offset:1024 lds
  buffer_load_dwordx4 v26, s[36:39], s15 offen offset:2048 lds
  buffer_load_dwordx4 v27, s[36:39], s15 offen offset:3072 lds
  s_add_u32 m0, s11, 12288
  s_add_u32 s15, s74, 122880
  buffer_load_dwordx4 v24, s[36:39], s15 offen offset:0 lds
  buffer_load_dwordx4 v25, s[36:39], s15 offen offset:1024 lds
  buffer_load_dwordx4 v26, s[36:39], s15 offen offset:2048 lds
  buffer_load_dwordx4 v27, s[36:39], s15 offen offset:3072 lds
  s_cmp_eq_u32 s5, 0
  s_cbranch_scc0 k_f_nx
  s_mov_b32 m0, 0
  s_add_u32 s15, s65, s13
  buffer_load_dwordx4 v24, s[36:39], s15 offen lds
  buffer_load_dwordx4 v25, s[36:39], s15 offen offset:1024 lds
k_f_nx:
  s_mov_b64 exec, s[68:69]
  s_add_u32 s76, s11, s73
  s_add_u32 m0, s76, 16384
  s_add_u32 s15, s71, 0
  buffer_load_dwordx4 v32, s[40:43], s15 offen offset:0 lds
  buffer_load_dwordx4 v33, s[40:43], s15 offen offset:640 lds
  buffer_load_dwordx4 v34, s[40:43], s15 offen offset:1280 lds
  buffer_load_dwordx4 v35, s[40:43], s15 offen offset:1920 lds
  s_add_u32 m0, s76, 18944
  s_add_u32 s15, s71, 61440
  buffer_load_dwordx4 v32, s[40:43], s15 offen offset:0 lds
  buffer_load_dwordx4 v33, s[40:43], s15 offen offset:640 lds
  buffer_load_dwordx4 v34, s[40:43], s15 offen offset:1280 lds
  buffer_load_dwordx4 v35, s[40:43], s15 offen offset:1920 lds
  s_add_u32 m0, s76, 26624
  s_add_u32 s15, s71, 1280
  buffer_load_dwordx4 v32, s[40:43], s15 offen offset:0 lds
  buffer_load_dwordx4 v33, s[40:43], s15 offen offset:640 lds
  buffer_load_dwordx4 v34, s[40:43], s15 offen offset:1280 lds
  buffer_load_dwordx4 v35, s[40:43], s15 offen offset:1920 lds
  s_add_u32 m0, s76, 29184
  s_add_u32 s15, s71, 62720
  buffer_load_dwordx4 v32, s[40:43], s15 offen offset:0 lds
  buffer_load_dwordx4 v33, s[40:43], s15 offen offset:640 lds
  buffer_load_dwordx4 v34, s[40:43], s15 offen offset:1280 lds
  buffer_load_dwordx4 v35, s[40:43], s15 offen offset:1920 lds
  s_add_u32 m0, s76, 36864
  s_add_u32 s15, s71, 2560
  buffer_load_dwordx4 v32, s[40:43], s15 offen offset:0 lds
  buffer_load_dwordx4 v33, s[40:43], s15 offen offset:640 lds
  buffer_load_dwordx4 v34, s[40:43], s15 offen offset:1280 lds
  buffer_load_dwordx4 v35, s[40:43], s15 offen offset:1920 lds
  s_add_u32 m0, s76, 39424
  s_add_u32 s15, s71, 64000
  buffer_load_dwordx4 v32, s[40:43], s15 offen offset:0 lds
  buffer_load_dwordx4 v33, s[40:43], s15 offen offset:640 lds
  buffer_load_dwordx4 v34, s[40:43], s15 offen offset:1280 lds
  buffer_load_dwordx4 v35, s[40:43], s15 offen offset:1920 lds
  s_mov_b32 m0, s77
  s_mov_b64 exec, 1
  buffer_load_dword v7, s[48:51], 0 offen lds
  s_mov_b64 exec, -1
  s_add_u32 s77, s77, 8
  s_add_u32 s10, s10, 2
  s_cmp_eq_u32 s5, 0
  s_cbranch_scc1 k_lA
  s_mov_b32 s11, 47104
  s_mov_b32 s100, 47104
  s_mov_b32 s101, -94208
  s_mov_b32 s72, 47104
  s_cmp_eq_u32 s5, 0
  s_cselect_b32 s56, s20, s28
  s_cselect_b32 s57, s21, s29
  s_mov_b32 s58, 819200
  s_mov_b32 s59, 0x20000
  s_mov_b32 s44, s34
  s_mov_b32 s45, s35
  s_mov_b32 s46, 268435456
  s_mov_b32 s47, 0x20000
  s_mov_b32 s48, s32
  s_mov_b32 s49, s33
  s_mov_b32 s50, 256
  s_mov_b32 s51, 0x20000
  s_mov_b32 s52, s26
  s_mov_b32 s53, s27
  s_mov_b32 s54, 25600
  s_mov_b32 s55, 0x20000
  s_mov_b32 s60, s30
  s_mov_b32 s61, s31
  s_mov_b32 s62, 5242880
  s_mov_b32 s63, 0x20000
  s_sub_u32 s16, s8, 4
  v_mul_u32_u24 v8, 26, v1
  v_lshrrev_b32 v8, 8, v8
  v_mul_u32_u24 v9, 10, v8
  v_sub_u32 v9, v1, v9
  v_lshlrev_b32 v9, 4, v9
  v_mov_b32 v7, 0x7fffff00
  s_mov_b32 s66, -1
  s_mov_b32 s67, 0x0fffffff
  s_mov_b32 s68, -1
  s_mov_b32 s69, 0xff
  s_mul_i32 s70, s7, 160
  s_lshl_b32 s9, s16, 2
  v_add_u32 v14, s9, v0
  v_mul_u32_u24 v28, 1280, v8
  v_add_u32 v28, v28, v9
  v_add_u32 v29, 6720, v28
  v_add_u32 v30, 13440, v28
  v_add_u32 v31, 20160, v28
  s_lshl_b32 s9, s16, 5
  s_add_u32 s9, s9, 16
  v_add_u32 v12, s9, v3
  v_mul_u32_u24 v12, 544, v12
  v_add_u32 v12, 90112, v12
  v_mul_u32_u24 v13, 80, v2
  v_add_u32 v126, v13, v12
  v_mad_u32_u24 v127, v2, 48, v12
  s_mul_i32 s9, s16, 3072
  s_add_u32 s9, s9, 76800
  v_lshlrev_b32 v13, 4, v1
  v_add_u32 v13, s9, v13
  v_bfe_u32 v8, v1, 2, 2
  v_and_b32 v9, 3, v1
  v_lshrrev_b32 v10, 1, v2
  v_lshlrev_b32 v10, 4, v10
  v_and_b32 v11, 1, v2
  v_lshl_add_u32 v10, v11, 2, v10
  v_add_u32 v10, v10, v8
  s_add_u32 s22, s6, 48
  s_add_u32 s23, s6, 16
  s_lshl_b32 s23, s23, 2
  s_lshl_b32 s21, s22, 2
  s_add_u32 s21, s21, s16
  s_lshl_b32 s21, s21, 8
  s_add_u32 s21, s21, 9437184
  s_lshl_b32 s22, s22, 2
  s_add_u32 s22, s22, 0
  s_lshl_b32 s18, s7, 2
  s_add_u32 s18, s18, s16
  s_lshl_b32 s17, s18, 15
  s_add_u32 s17, s17, 8388608
  s_lshl_b32 s18, s18, 8
  s_add_u32 s18, s18, 9469952
  s_lshl_b32 s19, s7, 2
  s_add_u32 s19, s19, 128
  s_mul_i32 s20, s16, 80
  s_add_u32 s20, s20, 90112
  v_mul_u32_u24 v4, 544, v10
  v_lshl_add_u32 v4, v9, 3, v4
  v_add_u32 v5, 90432, v4
  v_add_u32 v4, s20, v4
  s_mul_i32 s9, s16, 48
  v_add_u32 v5, s9, v5
  v_mul_u32_u24 v6, 544, v3
  v_lshl_add_u32 v6, v2, 3, v6
  v_add_u32 v6, s20, v6
  v_mov_b32 v10, v1
  v_min_u32 v10, 104, v10
  v_mul_u32_u24 v8, 205, v10
  v_lshrrev_b32 v8, 10, v8
  v_min_u32 v8, 22, v8
  v_mul_u32_u24 v9, 5, v8
  v_sub_u32 v9, v10, v9
  v_min_u32 v9, 4, v9
  v_mul_u32_u24 v236, 544, v8
  v_lshl_add_u32 v236, v9, 4, v236
  v_add_u32 v236, s20, v236
  v_add_u32 v10, 64, v1
  v_min_u32 v10, 104, v10
  v_mul_u32_u24 v8, 205, v10
  v_lshrrev_b32 v8, 10, v8
  v_min_u32 v8, 22, v8
  v_mul_u32_u24 v9, 5, v8
  v_sub_u32 v9, v10, v9
  v_min_u32 v9, 4, v9
  v_mul_u32_u24 v237, 544, v8
  v_lshl_add_u32 v237, v9, 4, v237
  v_add_u32 v237, s20, v237
  v_lshrrev_b32 v8, 2, v3
  v_and_b32 v9, 3, v3
  v_mul_u32_u24 v10, 80, v2
  v_add_u32 v10, 90112, v10
  v_mul_u32_u24 v11, 544, v9
  v_add_u32 v11, v11, v10
  v_add_u32 v10, 10880, v10
  v_mov_b32 v12, 162944
  v_cmp_eq_u32 vcc, v8, v2
  s_nop 1
  v_cndmask_b32 v69, v12, v10, vcc
  v_cndmask_b32 v64, v12, v11, vcc
  v_add_u32 v11, 2176, v11
  v_cndmask_b32 v65, v12, v11, vcc
  v_add_u32 v11, 2176, v11
  v_cndmask_b32 v66, v12, v11, vcc
  v_add_u32 v11, 2176, v11
  v_cndmask_b32 v67, v12, v11, vcc
  v_add_u32 v11, 2176, v11
  v_cndmask_b32 v68, v12, v11, vcc
ld_1:
  s_and_b32 s12, s96, 15
  s_add_u32 s12, s12, s79
  s_cmp_ge_u32 s12, 10
  s_cselect_b32 s9, 10, 0
  s_sub_u32 s12, s12, s9
  s_lshr_b64 s[96:97], s[96:97], 4
  s_lshl_b32 s13, s12, 7
  s_mul_i32 s71, s12, 245760
  s_add_u32 s71, s71, s75
  s_add_u32 s74, s64, s13
  s_mov_b32 s14, 0
  s_cmp_lt_u32 s10, 6
  s_cbranch_scc0 lp_3
  s_cmp_lt_u32 s10, 3
  s_cbranch_scc1 lpok_4
  s_bitcmp0_b32 s10, 0
  s_cbranch_scc1 lpok_4
  s_sub_u32 s9, s77, 12
  v_mov_b32 v22, s9
  s_mov_b32 s14, 0
lz_6:
  ds_read_b32 v16, v22 offset:0
  s_waitcnt lgkmcnt(0)
  v_readfirstlane_b32 s9, v16
  s_nop 0
  s_cmp_eq_u32 s9, 0
  s_cbranch_scc1 lzok_7
  s_sleep 1
  s_add_u32 s14, s14, 1
  s_cmp_lt_u32 s14, 1048576
  s_cbranch_scc1 lz_6
lzok_7:
  s_branch lpok_4
lp_3:
  ds_read_b128 v[16:19], v0 offset:16
  ds_read_b64 v[20:21], v0 offset:32
  s_waitcnt lgkmcnt(0)
  v_min3_u32 v16, v16, v17, v18
  v_min3_u32 v16, v16, v19, v20
  v_min_u32 v16, v16, v21
  s_nop 0
  v_readfirstlane_b32 s9, v16
  s_nop 0
  s_add_u32 s9, s9, 5
  s_cmp_ge_u32 s9, s10
  s_cbranch_scc1 lpok_4
  s_add_u32 s14, s14, 1
  s_cmp_lt_u32 s14, 1048576
  s_cbranch_scc1 lp_3
lpok_4:
  s_cmp_eq_u32 s8, 4
  s_cbranch_scc0 nx_2
  s_add_u32 m0, s11, 0
  s_add_u32 s15, s64, s13
  buffer_load_dwordx4 v24, s[36:39], s15 offen offset:0 lds
  buffer_load_dwordx4 v25, s[36:39], s15 offen offset:1024 lds
  buffer_load_dwordx4 v26, s[36:39], s15 offen offset:2048 lds
  buffer_load_dwordx4 v27, s[36:39], s15 offen offset:3072 lds
  s_add_u32 m0, s11, 4096
  s_add_u32 s15, s74, 40960
  buffer_load_dwordx4 v24, s[36:39], s15 offen offset:0 lds
  buffer_load_dwordx4 v25, s[36:39], s15 offen offset:1024 lds
  buffer_load_dwordx4 v26, s[36:39], s15 offen offset:2048 lds
  buffer_load_dwordx4 v27, s[36:39], s15 offen offset:3072 lds
  s_add_u32 m0, s11, 8192
  s_add_u32 s15, s74, 81920
  buffer_load_dwordx4 v24, s[36:39], s15 offen offset:0 lds
  buffer_load_dwordx4 v25, s[36:39], s15 offen offset:1024 lds
  buffer_load_dwordx4 v26, s[36:39], s15 offen offset:2048 lds
  buffer_load_dwordx4 v27, s[36:39], s15 offen offset:3072 lds
  s_add_u32 m0, s11, 12288
  s_add_u32 s15, s74, 122880
  buffer_load_dwordx4 v24, s[36:39], s15 offen offset:0 lds
  buffer_load_dwordx4 v25, s[36:39], s15 offen offset:1024 lds
  buffer_load_dwordx4 v26, s[36:39], s15 offen offset:2048 lds
  buffer_load_dwordx4 v27, s[36:39], s15 offen offset:3072 lds
nx_2:
  s_mov_b64 exec, s[68:69]
  s_add_u32 s76, s11, s73
  s_add_u32 m0, s76, 16384
  s_add_u32 s15, s71, 0
  buffer_load_dwordx4 v32, s[40:43], s15 offen offset:0 lds
  buffer_load_dwordx4 v33, s[40:43], s15 offen offset:640 lds
  buffer_load_dwordx4 v34, s[40:43], s15 offen offset:1280 lds
  buffer_load_dwordx4 v35, s[40:43], s15 offen offset:1920 lds
  s_add_u32 m0, s76, 18944
  s_add_u32 s15, s71, 61440
  buffer_load_dwordx4 v32, s[40:43], s15 offen offset:0 lds
  buffer_load_dwordx4 v33, s[40:43], s15 offen offset:640 lds
  buffer_load_dwordx4 v34, s[40:43], s15 offen offset:1280 lds
  buffer_load_dwordx4 v35, s[40:43], s15 offen offset:1920 lds
  s_add_u32 m0, s76, 26624
  s_add_u32 s15, s71, 1280
  buffer_load_dwordx4 v32, s[40:43], s15 offen offset:0 lds
  buffer_load_dwordx4 v33, s[40:43], s15 offen offset:640 lds
  buffer_load_dwordx4 v34, s[40:43], s15 offen offset:1280 lds
  buffer_load_dwordx4 v35, s[40:43], s15 offen offset:1920 lds
  s_add_u32 m0, s76, 29184
  s_add_u32 s15, s71, 62720
  buffer_load_dwordx4 v32, s[40:43], s15 offen offset:0 lds
  buffer_load_dwordx4 v33, s[40:43], s15 offen offset:640 lds
  buffer_load_dwordx4 v34, s[40:43], s15 offen offset:1280 lds
  buffer_load_dwordx4 v35, s[40:43], s15 offen offset:1920 lds
  s_add_u32 m0, s76, 36864
  s_add_u32 s15, s71, 2560
  buffer_load_dwordx4 v32, s[40:43], s15 offen offset:0 lds
  buffer_load_dwordx4 v33, s[40:43], s15 offen offset:640 lds
  buffer_load_dwordx4 v34, s[40:43], s15 offen offset:1280 lds
  buffer_load_dwordx4 v35, s[40:43], s15 offen offset:1920 lds
  s_add_u32 m0, s76, 39424
  s_add_u32 s15, s71, 64000
  buffer_load_dwordx4 v32, s[40:43], s15 offen offset:0 lds
  buffer_load_dwordx4 v33, s[40:43], s15 offen offset:640 lds
  buffer_load_dwordx4 v34, s[40:43], s15 offen offset:1280 lds
  buffer_load_dwordx4 v35, s[40:43], s15 offen offset:1920 lds
  s_mov_b32 m0, s77
  s_mov_b64 exec, 1
  buffer_load_dword v7, s[48:51], 0 offen lds
  s_mov_b64 exec, -1
  s_add_u32 s77, s77, 8
  s_add_u32 s10, s10, 2
  s_add_u32 s12, s12, 1
  s_cmp_eq_u32 s12, 10
  s_cselect_b32 s12, 0, s12
  s_add_u32 s11, s11, s100
  s_mov_b32 s9, s100
  s_mov_b32 s100, s101
  s_mov_b32 s101, s72
  s_mov_b32 s72, s9
  s_cmp_lt_u32 s10, 20
  s_cbranch_scc1 ld_1
  s_mov_b32 s14, 0
lw_147:
  ds_read_b64 v[248:249], v0 offset:32
  s_waitcnt lgkmcnt(0)
  v_min_u32 v248, v248, v249
  s_nop 0
  v_readfirstlane_b32 s9, v248
  s_nop 0
  s_cmp_ge_u32 s9, 1
  s_cbranch_scc1 lwok_148
  s_sleep 1
  s_add_u32 s14, s14, 1
  s_cmp_lt_u32 s14, 1048576
  s_cbranch_scc1 lw_147
lwok_148:
  v_bfe_u32 v8, v1, 2, 2
  v_and_b32 v9, 3, v1
  v_mul_u32_u24 v10, 800, v2
  v_mad_u32_u24 v10, v8, 40, v10
  v_add_u32 v10, 159744, v10
  v_mov_b32 v11, 162944
  v_cmp_eq_u32 vcc, v9, v2
  v_add_u32 v12, 640, v10
  s_nop 0
  v_cndmask_b32 v10, v11, v10, vcc
  v_cndmask_b32 v11, v11, v12, vcc
  ds_read_b64_tr_b16 v[84:85], v11 offset:0
  ds_read_b64_tr_b16 v[94:95], v11 offset:8
  ds_read_b64_tr_b16 v[104:105], v11 offset:16
  ds_read_b64_tr_b16 v[114:115], v11 offset:24
  ds_read_b64_tr_b16 v[124:125], v11 offset:32
  ds_read_b64_tr_b16 v[76:77], v10 offset:0
  ds_read_b64_tr_b16 v[78:79], v10 offset:160
  ds_read_b64_tr_b16 v[80:81], v10 offset:320
  ds_read_b64_tr_b16 v[82:83], v10 offset:480
  ds_read_b64_tr_b16 v[86:87], v10 offset:8
  ds_read_b64_tr_b16 v[88:89], v10 offset:168
  ds_read_b64_tr_b16 v[90:91], v10 offset:328
  ds_read_b64_tr_b16 v[92:93], v10 offset:488
  ds_read_b64_tr_b16 v[96:97], v10 offset:16
  ds_read_b64_tr_b16 v[98:99], v10 offset:176
  ds_read_b64_tr_b16 v[100:101], v10 offset:336
  ds_read_b64_tr_b16 v[102:103], v10 offset:496
  ds_read_b64_tr_b16 v[106:107], v10 offset:24
  ds_read_b64_tr_b16 v[108:109], v10 offset:184
  ds_read_b64_tr_b16 v[110:111], v10 offset:344
  ds_read_b64_tr_b16 v[112:113], v10 offset:504
  ds_read_b64_tr_b16 v[116:117], v10 offset:32
  ds_read_b64_tr_b16 v[118:119], v10 offset:192
  ds_read_b64_tr_b16 v[120:121], v10 offset:352
  ds_read_b64_tr_b16 v[122:123], v10 offset:512
  s_cmp_eq_u32 s8, 4
  s_cbranch_scc0 k_hB2
  s_mov_b32 s14, 0
lw_8:
  ds_read_b128 v[16:19], v0 offset:16
  s_waitcnt lgkmcnt(0)
  v_min3_u32 v16, v16, v17, v18
  v_min_u32 v16, v16, v19
  s_nop 0
  v_readfirstlane_b32 s9, v16
  s_nop 0
  s_cmp_ge_u32 s9, 16
  s_cbranch_scc1 lwok_9
  s_sleep 1
  s_add_u32 s14, s14, 1
  s_cmp_lt_u32 s14, 1048576
  s_cbranch_scc1 lw_8
lwok_9:
  s_mov_b64 exec, s[66:67]
  s_mov_b32 m0, 51200
  s_add_u32 s15, s70, 0
  buffer_load_dwordx4 v28, s[56:59], s15 offen offset:0 lds
  buffer_load_dwordx4 v29, s[56:59], s15 offen offset:960 lds
  buffer_load_dwordx4 v30, s[56:59], s15 offen offset:1920 lds
  buffer_load_dwordx4 v31, s[56:59], s15 offen offset:2880 lds
  s_mov_b32 m0, 55040
  s_add_u32 s15, s70, 30720
  buffer_load_dwordx4 v28, s[56:59], s15 offen offset:0 lds
  buffer_load_dwordx4 v29, s[56:59], s15 offen offset:960 lds
  buffer_load_dwordx4 v30, s[56:59], s15 offen offset:1920 lds
  buffer_load_dwordx4 v31, s[56:59], s15 offen offset:2880 lds
  s_mov_b32 m0, 58880
  s_add_u32 s15, s70, 61440
  buffer_load_dwordx4 v28, s[56:59], s15 offen offset:0 lds
  buffer_load_dwordx4 v29, s[56:59], s15 offen offset:960 lds
  buffer_load_dwordx4 v30, s[56:59], s15 offen offset:1920 lds
  buffer_load_dwordx4 v31, s[56:59], s15 offen offset:2880 lds
  s_mov_b32 m0, 62720
  s_add_u32 s15, s70, 92160
  buffer_load_dwordx4 v28, s[56:59], s15 offen offset:0 lds
  buffer_load_dwordx4 v29, s[56:59], s15 offen offset:960 lds
  buffer_load_dwordx4 v30, s[56:59], s15 offen offset:1920 lds
  buffer_load_dwordx4 v31, s[56:59], s15 offen offset:2880 lds
  s_mov_b32 m0, 66560
  s_add_u32 s15, s70, 122880
  buffer_load_dwordx4 v28, s[56:59], s15 offen offset:0 lds
  buffer_load_dwordx4 v29, s[56:59], s15 offen offset:960 lds
  buffer_load_dwordx4 v30, s[56:59], s15 offen offset:1920 lds
  buffer_load_dwordx4 v31, s[56:59], s15 offen offset:2880 lds
  s_mov_b32 m0, 70400
  s_add_u32 s15, s70, 153600
  buffer_load_dwordx4 v28, s[56:59], s15 offen offset:0 lds
  buffer_load_dwordx4 v29, s[56:59], s15 offen offset:960 lds
  buffer_load_dwordx4 v30, s[56:59], s15 offen offset:1920 lds
  buffer_load_dwordx4 v31, s[56:59], s15 offen offset:2880 lds
  s_mov_b32 m0, 74240
  s_add_u32 s15, s70, 184320
  buffer_load_dwordx4 v28, s[56:59], s15 offen offset:0 lds
  buffer_load_dwordx4 v29, s[56:59], s15 offen offset:960 lds
  s_mov_b64 exec, s[68:69]
  buffer_load_dwordx4 v30, s[56:59], s15 offen offset:1920 lds
  s_mov_b64 exec, -1
  s_mov_b32 m0, 163808
  s_mov_b64 exec, 1
  buffer_load_dword v7, s[48:51], 0 offen lds
  s_mov_b64 exec, -1
  s_branch k_hB2
k_lA:
  s_mov_b32 s11, 49152
  s_mov_b32 s100, 49152
  s_mov_b32 s101, -98304
  s_mov_b32 s72, 49152
ld_10:
  s_and_b32 s12, s96, 15
  s_add_u32 s12, s12, s79
  s_cmp_ge_u32 s12, 10
  s_cselect_b32 s9, 10, 0
  s_sub_u32 s12, s12, s9
  s_lshr_b64 s[96:97], s[96:97], 4
  s_lshl_b32 s13, s12, 7
  s_mul_i32 s71, s12, 245760
  s_add_u32 s71, s71, s75
  s_add_u32 s74, s64, s13
  s_mov_b32 s14, 0
  s_cmp_lt_u32 s10, 6
  s_cbranch_scc0 lp_12
  s_cmp_lt_u32 s10, 3
  s_cbranch_scc1 lpok_13
  s_bitcmp0_b32 s10, 0
  s_cbranch_scc1 lpok_13
  s_sub_u32 s9, s77, 12
  v_mov_b32 v22, s9
  s_mov_b32 s14, 0
lz_15:
  ds_read_b32 v16, v22 offset:0
  s_waitcnt lgkmcnt(0)
  v_readfirstlane_b32 s9, v16
  s_nop 0
  s_cmp_eq_u32 s9, 0
  s_cbranch_scc1 lzok_16
  s_sleep 1
  s_add_u32 s14, s14, 1
  s_cmp_lt_u32 s14, 1048576
  s_cbranch_scc1 lz_15
lzok_16:
  s_branch lpok_13
lp_12:
  ds_read_b128 v[16:19], v0 offset:16
  ds_read_b64 v[20:21], v0 offset:32
  s_waitcnt lgkmcnt(0)
  v_min3_u32 v16, v16, v17, v18
  v_min3_u32 v16, v16, v19, v20
  v_min_u32 v16, v16, v21
  s_nop 0
  v_readfirstlane_b32 s9, v16
  s_nop 0
  s_add_u32 s9, s9, 5
  s_cmp_ge_u32 s9, s10
  s_cbranch_scc1 lpok_13
  s_add_u32 s14, s14, 1
  s_cmp_lt_u32 s14, 1048576
  s_cbranch_scc1 lp_12
lpok_13:
  s_cmp_eq_u32 s8, 4
  s_cbranch_scc0 nx_11
  s_add_u32 m0, s11, 0
  s_add_u32 s15, s65, s13
  buffer_load_dwordx4 v24, s[36:39], s15 offen offset:0 lds
  buffer_load_dwordx4 v25, s[36:39], s15 offen offset:1024 lds
  s_add_u32 m0, s11, 2048
  s_add_u32 s15, s64, s13
  buffer_load_dwordx4 v24, s[36:39], s15 offen offset:0 lds
  buffer_load_dwordx4 v25, s[36:39], s15 offen offset:1024 lds
  buffer_load_dwordx4 v26, s[36:39], s15 offen offset:2048 lds
  buffer_load_dwordx4 v27, s[36:39], s15 offen offset:3072 lds
  s_add_u32 m0, s11, 6144
  s_add_u32 s15, s74, 40960
  buffer_load_dwordx4 v24, s[36:39], s15 offen offset:0 lds
  buffer_load_dwordx4 v25, s[36:39], s15 offen offset:1024 lds
  buffer_load_dwordx4 v26, s[36:39], s15 offen offset:2048 lds
  buffer_load_dwordx4 v27, s[36:39], s15 offen offset:3072 lds
  s_add_u32 m0, s11, 10240
  s_add_u32 s15, s74, 81920
  buffer_load_dwordx4 v24, s[36:39], s15 offen offset:0 lds
  buffer_load_dwordx4 v25, s[36:39], s15 offen offset:1024 lds
  buffer_load_dwordx4 v26, s[36:39], s15 offen offset:2048 lds
  buffer_load_dwordx4 v27, s[36:39], s15 offen offset:3072 lds
  s_add_u32 m0, s11, 14336
  s_add_u32 s15, s74, 122880
  buffer_load_dwordx4 v24, s[36:39], s15 offen offset:0 lds
  buffer_load_dwordx4 v25, s[36:39], s15 offen offset:1024 lds
  buffer_load_dwordx4 v26, s[36:39], s15 offen offset:2048 lds
  buffer_load_dwordx4 v27, s[36:39], s15 offen offset:3072 lds
nx_11:
  s_mov_b64 exec, s[68:69]
  s_add_u32 s76, s11, s73
  s_add_u32 m0, s76, 18432
  s_add_u32 s15, s71, 0
  buffer_load_dwordx4 v32, s[40:43], s15 offen offset:0 lds
  buffer_load_dwordx4 v33, s[40:43], s15 offen offset:640 lds
  buffer_load_dwordx4 v34, s[40:43], s15 offen offset:1280 lds
  buffer_load_dwordx4 v35, s[40:43], s15 offen offset:1920 lds
  s_add_u32 m0, s76, 20992
  s_add_u32 s15, s71, 61440
  buffer_load_dwordx4 v32, s[40:43], s15 offen offset:0 lds
  buffer_load_dwordx4 v33, s[40:43], s15 offen offset:640 lds
  buffer_load_dwordx4 v34, s[40:43], s15 offen offset:1280 lds
  buffer_load_dwordx4 v35, s[40:43], s15 offen offset:1920 lds
  s_add_u32 m0, s76, 28672
  s_add_u32 s15, s71, 1280
  buffer_load_dwordx4 v32, s[40:43], s15 offen offset:0 lds
  buffer_load_dwordx4 v33, s[40:43], s15 offen offset:640 lds
  buffer_load_dwordx4 v34, s[40:43], s15 offen offset:1280 lds
  buffer_load_dwordx4 v35, s[40:43], s15 offen offset:1920 lds
  s_add_u32 m0, s76, 31232
  s_add_u32 s15, s71, 62720
  buffer_load_dwordx4 v32, s[40:43], s15 offen offset:0 lds
  buffer_load_dwordx4 v33, s[40:43], s15 offen offset:640 lds
  buffer_load_dwordx4 v34, s[40:43], s15 offen offset:1280 lds
  buffer_load_dwordx4 v35, s[40:43], s15 offen offset:1920 lds
  s_add_u32 m0, s76, 38912
  s_add_u32 s15, s71, 2560
  buffer_load_dwordx4 v32, s[40:43], s15 offen offset:0 lds
  buffer_load_dwordx4 v33, s[40:43], s15 offen offset:640 lds
  buffer_load_dwordx4 v34, s[40:43], s15 offen offset:1280 lds
  buffer_load_dwordx4 v35, s[40:43], s15 offen offset:1920 lds
  s_add_u32 m0, s76, 41472
  s_add_u32 s15, s71, 64000
  buffer_load_dwordx4 v32, s[40:43], s15 offen offset:0 lds
  buffer_load_dwordx4 v33, s[40:43], s15 offen offset:640 lds
  buffer_load_dwordx4 v34, s[40:43], s15 offen offset:1280 lds
  buffer_load_dwordx4 v35, s[40:43], s15 offen offset:1920 lds
  s_mov_b32 m0, s77
  s_mov_b64 exec, 1
  buffer_load_dword v7, s[48:51], 0 offen lds
  s_mov_b64 exec, -1
  s_add_u32 s77, s77, 8
  s_add_u32 s10, s10, 2
  s_add_u32 s12, s12, 1
  s_cmp_eq_u32 s12, 10
  s_cselect_b32 s12, 0, s12
  s_add_u32 s11, s11, s100
  s_mov_b32 s9, s100
  s_mov_b32 s100, s101
  s_mov_b32 s101, s72
  s_mov_b32 s72, s9
  s_cmp_lt_u32 s10, 20
  s_cbranch_scc1 ld_10
  s_cmp_eq_u32 s8, 4
  s_cbranch_scc0 k_end
  s_cmp_eq_u32 s5, 0
  s_cselect_b32 s56, s20, s28
  s_cselect_b32 s57, s21, s29
  s_mov_b32 s58, 819200
  s_mov_b32 s59, 0x20000
  s_mov_b32 s44, s34
  s_mov_b32 s45, s35
  s_mov_b32 s46, 268435456
  s_mov_b32 s47, 0x20000
  s_mov_b32 s48, s32
  s_mov_b32 s49, s33
  s_mov_b32 s50, 256
  s_mov_b32 s51, 0x20000
  s_mov_b32 s52, s26
  s_mov_b32 s53, s27
  s_mov_b32 s54, 25600
  s_mov_b32 s55, 0x20000
  s_mov_b32 s60, s30
  s_mov_b32 s61, s31
  s_mov_b32 s62, 5242880
  s_mov_b32 s63, 0x20000
  v_mul_u32_u24 v28, 1280, v8
  v_add_u32 v28, v28, v9
  v_add_u32 v29, 6720, v28
  v_add_u32 v30, 13440, v28
  v_add_u32 v31, 20160, v28
  s_mov_b32 s14, 0
lw_17:
  ds_read_b128 v[16:19], v0 offset:16
  s_waitcnt lgkmcnt(0)
  v_min3_u32 v16, v16, v17, v18
  v_min_u32 v16, v16, v19
  s_nop 0
  v_readfirstlane_b32 s9, v16
  s_nop 0
  s_cmp_ge_u32 s9, 18
  s_cbranch_scc1 lwok_18
  s_sleep 1
  s_add_u32 s14, s14, 1
  s_cmp_lt_u32 s14, 1048576
  s_cbranch_scc1 lw_17
lwok_18:
  s_mov_b64 exec, s[66:67]
  s_mov_b32 m0, 77824
  s_add_u32 s15, s70, 0
  buffer_load_dwordx4 v28, s[56:59], s15 offen offset:0 lds
  buffer_load_dwordx4 v29, s[56:59], s15 offen offset:960 lds
  buffer_load_dwordx4 v30, s[56:59], s15 offen offset:1920 lds
  buffer_load_dwordx4 v31, s[56:59], s15 offen offset:2880 lds
  s_mov_b32 m0, 81664
  s_add_u32 s15, s70, 30720
  buffer_load_dwordx4 v28, s[56:59], s15 offen offset:0 lds
  buffer_load_dwordx4 v29, s[56:59], s15 offen offset:960 lds
  buffer_load_dwordx4 v30, s[56:59], s15 offen offset:1920 lds
  buffer_load_dwordx4 v31, s[56:59], s15 offen offset:2880 lds
  s_mov_b32 m0, 85504
  s_add_u32 s15, s70, 61440
  buffer_load_dwordx4 v28, s[56:59], s15 offen offset:0 lds
  buffer_load_dwordx4 v29, s[56:59], s15 offen offset:960 lds
  buffer_load_dwordx4 v30, s[56:59], s15 offen offset:1920 lds
  buffer_load_dwordx4 v31, s[56:59], s15 offen offset:2880 lds
  s_mov_b32 m0, 89344
  s_add_u32 s15, s70, 92160
  buffer_load_dwordx4 v28, s[56:59], s15 offen offset:0 lds
  buffer_load_dwordx4 v29, s[56:59], s15 offen offset:960 lds
  buffer_load_dwordx4 v30, s[56:59], s15 offen offset:1920 lds
  buffer_load_dwordx4 v31, s[56:59], s15 offen offset:2880 lds
  s_mov_b32 m0, 93184
  s_add_u32 s15, s70, 122880
  buffer_load_dwordx4 v28, s[56:59], s15 offen offset:0 lds
  buffer_load_dwordx4 v29, s[56:59], s15 offen offset:960 lds
  buffer_load_dwordx4 v30, s[56:59], s15 offen offset:1920 lds
  buffer_load_dwordx4 v31, s[56:59], s15 offen offset:2880 lds
  s_mov_b32 m0, 97024
  s_add_u32 s15, s70, 153600
  buffer_load_dwordx4 v28, s[56:59], s15 offen offset:0 lds
  buffer_load_dwordx4 v29, s[56:59], s15 offen offset:960 lds
  buffer_load_dwordx4 v30, s[56:59], s15 offen offset:1920 lds
  buffer_load_dwordx4 v31, s[56:59], s15 offen offset:2880 lds
  s_mov_b32 m0, 100864
  s_add_u32 s15, s70, 184320
  buffer_load_dwordx4 v28, s[56:59], s15 offen offset:0 lds
  buffer_load_dwordx4 v29, s[56:59], s15 offen offset:960 lds
  s_mov_b64 exec, s[68:69]
  buffer_load_dwordx4 v30, s[56:59], s15 offen offset:1920 lds
  s_mov_b64 exec, -1
  s_mov_b64 exec, s[66:67]
  s_mov_b32 m0, 103424
  s_add_u32 s15, s70, 204800
  buffer_load_dwordx4 v28, s[56:59], s15 offen offset:0 lds
  buffer_load_dwordx4 v29, s[56:59], s15 offen offset:960 lds
  buffer_load_dwordx4 v30, s[56:59], s15 offen offset:1920 lds
  buffer_load_dwordx4 v31, s[56:59], s15 offen offset:2880 lds
  s_mov_b32 m0, 107264
  s_add_u32 s15, s70, 235520
  buffer_load_dwordx4 v28, s[56:59], s15 offen offset:0 lds
  buffer_load_dwordx4 v29, s[56:59], s15 offen offset:960 lds
  buffer_load_dwordx4 v30, s[56:59], s15 offen offset:1920 lds
  buffer_load_dwordx4 v31, s[56:59], s15 offen offset:2880 lds
  s_mov_b32 m0, 111104
  s_add_u32 s15, s70, 266240
  buffer_load_dwordx4 v28, s[56:59], s15 offen offset:0 lds
  buffer_load_dwordx4 v29, s[56:59], s15 offen offset:960 lds
  buffer_load_dwordx4 v30, s[56:59], s15 offen offset:1920 lds
  buffer_load_dwordx4 v31, s[56:59], s15 offen offset:2880 lds
  s_mov_b32 m0, 114944
  s_add_u32 s15, s70, 296960
  buffer_load_dwordx4 v28, s[56:59], s15 offen offset:0 lds
  buffer_load_dwordx4 v29, s[56:59], s15 offen offset:960 lds
  buffer_load_dwordx4 v30, s[56:59], s15 offen offset:1920 lds
  buffer_load_dwordx4 v31, s[56:59], s15 offen offset:2880 lds
  s_mov_b32 m0, 118784
  s_add_u32 s15, s70, 327680
  buffer_load_dwordx4 v28, s[56:59], s15 offen offset:0 lds
  buffer_load_dwordx4 v29, s[56:59], s15 offen offset:960 lds
  buffer_load_dwordx4 v30, s[56:59], s15 offen offset:1920 lds
  buffer_load_dwordx4 v31, s[56:59], s15 offen offset:2880 lds
  s_mov_b32 m0, 122624
  s_add_u32 s15, s70, 358400
  buffer_load_dwordx4 v28, s[56:59], s15 offen offset:0 lds
  buffer_load_dwordx4 v29, s[56:59], s15 offen offset:960 lds
  buffer_load_dwordx4 v30, s[56:59], s15 offen offset:1920 lds
  buffer_load_dwordx4 v31, s[56:59], s15 offen offset:2880 lds
  s_mov_b32 m0, 126464
  s_add_u32 s15, s70, 389120
  buffer_load_dwordx4 v28, s[56:59], s15 offen offset:0 lds
  buffer_load_dwordx4 v29, s[56:59], s15 offen offset:960 lds
  s_mov_b64 exec, s[68:69]
  buffer_load_dwordx4 v30, s[56:59], s15 offen offset:1920 lds
  s_mov_b64 exec, -1
  s_mov_b64 exec, s[66:67]
  s_mov_b32 m0, 129024
  s_add_u32 s15, s70, 409600
  buffer_load_dwordx4 v28, s[56:59], s15 offen offset:0 lds
  buffer_load_dwordx4 v29, s[56:59], s15 offen offset:960 lds
  buffer_load_dwordx4 v30, s[56:59], s15 offen offset:1920 lds
  buffer_load_dwordx4 v31, s[56:59], s15 offen offset:2880 lds
  s_mov_b32 m0, 132864
  s_add_u32 s15, s70, 440320
  buffer_load_dwordx4 v28, s[56:59], s15 offen offset:0 lds
  buffer_load_dwordx4 v29, s[56:59], s15 offen offset:960 lds
  buffer_load_dwordx4 v30, s[56:59], s15 offen offset:1920 lds
  buffer_load_dwordx4 v31, s[56:59], s15 offen offset:2880 lds
  s_mov_b32 m0, 136704
  s_add_u32 s15, s70, 471040
  buffer_load_dwordx4 v28, s[56:59], s15 offen offset:0 lds
  buffer_load_dwordx4 v29, s[56:59], s15 offen offset:960 lds
  buffer_load_dwordx4 v30, s[56:59], s15 offen offset:1920 lds
  buffer_load_dwordx4 v31, s[56:59], s15 offen offset:2880 lds
  s_mov_b32 m0, 140544
  s_add_u32 s15, s70, 501760
  buffer_load_dwordx4 v28, s[56:59], s15 offen offset:0 lds
  buffer_load_dwordx4 v29, s[56:59], s15 offen offset:960 lds
  buffer_load_dwordx4 v30, s[56:59], s15 offen offset:1920 lds
  buffer_load_dwordx4 v31, s[56:59], s15 offen offset:2880 lds
  s_mov_b32 m0, 144384
  s_add_u32 s15, s70, 532480
  buffer_load_dwordx4 v28, s[56:59], s15 offen offset:0 lds
  buffer_load_dwordx4 v29, s[56:59], s15 offen offset:960 lds
  buffer_load_dwordx4 v30, s[56:59], s15 offen offset:1920 lds
  buffer_load_dwordx4 v31, s[56:59], s15 offen offset:2880 lds
  s_mov_b32 m0, 148224
  s_add_u32 s15, s70, 563200
  buffer_load_dwordx4 v28, s[56:59], s15 offen offset:0 lds
  buffer_load_dwordx4 v29, s[56:59], s15 offen offset:960 lds
  buffer_load_dwordx4 v30, s[56:59], s15 offen offset:1920 lds
  buffer_load_dwordx4 v31, s[56:59], s15 offen offset:2880 lds
  s_mov_b32 m0, 152064
  s_add_u32 s15, s70, 593920
  buffer_load_dwordx4 v28, s[56:59], s15 offen offset:0 lds
  buffer_load_dwordx4 v29, s[56:59], s15 offen offset:960 lds
  s_mov_b64 exec, s[68:69]
  buffer_load_dwordx4 v30, s[56:59], s15 offen offset:1920 lds
  s_mov_b64 exec, -1
  s_mov_b32 s14, 0
lw_19:
  ds_read_b128 v[16:19], v0 offset:16
  s_waitcnt lgkmcnt(0)
  v_min3_u32 v16, v16, v17, v18
  v_min_u32 v16, v16, v19
  s_nop 0
  v_readfirstlane_b32 s9, v16
  s_nop 0
  s_cmp_ge_u32 s9, 20
  s_cbranch_scc1 lwok_20
  s_sleep 1
  s_add_u32 s14, s14, 1
  s_cmp_lt_u32 s14, 1048576
  s_cbranch_scc1 lw_19
lwok_20:
  s_mov_b64 exec, s[66:67]
  s_mov_b32 m0, 0
  s_add_u32 s15, s70, 614400
  buffer_load_dwordx4 v28, s[56:59], s15 offen offset:0 lds
  buffer_load_dwordx4 v29, s[56:59], s15 offen offset:960 lds
  buffer_load_dwordx4 v30, s[56:59], s15 offen offset:1920 lds
  buffer_load_dwordx4 v31, s[56:59], s15 offen offset:2880 lds
  s_mov_b32 m0, 3840
  s_add_u32 s15, s70, 645120
  buffer_load_dwordx4 v28, s[56:59], s15 offen offset:0 lds
  buffer_load_dwordx4 v29, s[56:59], s15 offen offset:960 lds
  buffer_load_dwordx4 v30, s[56:59], s15 offen offset:1920 lds
  buffer_load_dwordx4 v31, s[56:59], s15 offen offset:2880 lds
  s_mov_b32 m0, 7680
  s_add_u32 s15, s70, 675840
  buffer_load_dwordx4 v28, s[56:59], s15 offen offset:0 lds
  buffer_load_dwordx4 v29, s[56:59], s15 offen offset:960 lds
  buffer_load_dwordx4 v30, s[56:59], s15 offen offset:1920 lds
  buffer_load_dwordx4 v31, s[56:59], s15 offen offset:2880 lds
  s_mov_b32 m0, 11520
  s_add_u32 s15, s70, 706560
  buffer_load_dwordx4 v28, s[56:59], s15 offen offset:0 lds
  buffer_load_dwordx4 v29, s[56:59], s15 offen offset:960 lds
  buffer_load_dwordx4 v30, s[56:59], s15 offen offset:1920 lds
  buffer_load_dwordx4 v31, s[56:59], s15 offen offset:2880 lds
  s_mov_b32 m0, 15360
  s_add_u32 s15, s70, 737280
  buffer_load_dwordx4 v28, s[56:59], s15 offen offset:0 lds
  buffer_load_dwordx4 v29, s[56:59], s15 offen offset:960 lds
  buffer_load_dwordx4 v30, s[56:59], s15 offen offset:1920 lds
  buffer_load_dwordx4 v31, s[56:59], s15 offen offset:2880 lds
  s_mov_b32 m0, 19200
  s_add_u32 s15, s70, 768000
  buffer_load_dwordx4 v28, s[56:59], s15 offen offset:0 lds
  buffer_load_dwordx4 v29, s[56:59], s15 offen offset:960 lds
  buffer_load_dwordx4 v30, s[56:59], s15 offen offset:1920 lds
  buffer_load_dwordx4 v31, s[56:59], s15 offen offset:2880 lds
  s_mov_b32 m0, 23040
  s_add_u32 s15, s70, 798720
  buffer_load_dwordx4 v28, s[56:59], s15 offen offset:0 lds
  buffer_load_dwordx4 v29, s[56:59], s15 offen offset:960 lds
  s_mov_b64 exec, s[68:69]
  buffer_load_dwordx4 v30, s[56:59], s15 offen offset:1920 lds
  s_mov_b64 exec, -1
  s_mov_b32 m0, 163800
  s_mov_b64 exec, 1
  buffer_load_dword v7, s[48:51], 0 offen lds
  s_mov_b64 exec, -1
  s_mov_b32 s56, s28
  s_mov_b32 s57, s29
  s_and_b32 s10, s7, 3
  s_mov_b32 s11, 0
  s_mov_b32 s12, 25600
k_wb:
  s_mov_b32 s14, 0
lw_21:
  ds_read_b128 v[16:19], v0 offset:0
  s_waitcnt lgkmcnt(0)
  v_min3_u32 v16, v16, v17, v18
  v_min_u32 v16, v16, v19
  s_nop 0
  v_readfirstlane_b32 s9, v16
  s_nop 0
  s_cmp_ge_u32 s9, s11
  s_cbranch_scc1 lwok_22
  s_sleep 2
  s_add_u32 s14, s14, 1
  s_cmp_lt_u32 s14, 1048576
  s_cbranch_scc1 lw_21
lwok_22:
  s_mul_i32 s13, s10, 204800
  s_add_u32 s13, s13, s70
  s_mov_b64 exec, s[66:67]
  s_add_u32 m0, s12, 0
  s_add_u32 s15, s13, 0
  buffer_load_dwordx4 v28, s[56:59], s15 offen offset:0 lds
  buffer_load_dwordx4 v29, s[56:59], s15 offen offset:960 lds
  buffer_load_dwordx4 v30, s[56:59], s15 offen offset:1920 lds
  buffer_load_dwordx4 v31, s[56:59], s15 offen offset:2880 lds
  s_add_u32 m0, s12, 3840
  s_add_u32 s15, s13, 30720
  buffer_load_dwordx4 v28, s[56:59], s15 offen offset:0 lds
  buffer_load_dwordx4 v29, s[56:59], s15 offen offset:960 lds
  buffer_load_dwordx4 v30, s[56:59], s15 offen offset:1920 lds
  buffer_load_dwordx4 v31, s[56:59], s15 offen offset:2880 lds
  s_add_u32 m0, s12, 7680
  s_add_u32 s15, s13, 61440
  buffer_load_dwordx4 v28, s[56:59], s15 offen offset:0 lds
  buffer_load_dwordx4 v29, s[56:59], s15 offen offset:960 lds
  buffer_load_dwordx4 v30, s[56:59], s15 offen offset:1920 lds
  buffer_load_dwordx4 v31, s[56:59], s15 offen offset:2880 lds
  s_add_u32 m0, s12, 11520
  s_add_u32 s15, s13, 92160
  buffer_load_dwordx4 v28, s[56:59], s15 offen offset:0 lds
  buffer_load_dwordx4 v29, s[56:59], s15 offen offset:960 lds
  buffer_load_dwordx4 v30, s[56:59], s15 offen offset:1920 lds
  buffer_load_dwordx4 v31, s[56:59], s15 offen offset:2880 lds
  s_add_u32 m0, s12, 15360
  s_add_u32 s15, s13, 122880
  buffer_load_dwordx4 v28, s[56:59], s15 offen offset:0 lds
  buffer_load_dwordx4 v29, s[56:59], s15 offen offset:960 lds
  buffer_load_dwordx4 v30, s[56:59], s15 offen offset:1920 lds
  buffer_load_dwordx4 v31, s[56:59], s15 offen offset:2880 lds
  s_add_u32 m0, s12, 19200
  s_add_u32 s15, s13, 153600
  buffer_load_dwordx4 v28, s[56:59], s15 offen offset:0 lds
  buffer_load_dwordx4 v29, s[56:59], s15 offen offset:960 lds
  buffer_load_dwordx4 v30, s[56:59], s15 offen offset:1920 lds
  buffer_load_dwordx4 v31, s[56:59], s15 offen offset:2880 lds
  s_add_u32 m0, s12, 23040
  s_add_u32 s15, s13, 184320
  buffer_load_dwordx4 v28, s[56:59], s15 offen offset:0 lds
  buffer_load_dwordx4 v29, s[56:59], s15 offen offset:960 lds
  s_mov_b64 exec, s[68:69]
  buffer_load_dwordx4 v30, s[56:59], s15 offen offset:1920 lds
  s_add_u32 s9, s10, 3
  s_and_b32 s9, s9, 3
  s_mul_i32 s12, s9, 25600
  s_add_u32 s12, s12, 77824
  s_cmp_eq_u32 s9, 3
  s_cselect_b32 s12, 0, s12
  s_cmp_eq_u32 s11, 0
  s_cselect_b32 s12, 51200, s12
  s_mov_b64 exec, -1
  s_add_u32 s10, s10, 1
  s_and_b32 s10, s10, 3
  s_add_u32 s11, s11, 1
  s_cmp_lt_u32 s11, 4
  s_cbranch_scc1 k_wb
  s_mov_b32 m0, 163824
  s_mov_b64 exec, 1
  buffer_load_dword v7, s[48:51], 0 offen lds
  s_endpgm
k_pf_start:
k_notld:
  v_bfe_u32 v8, v1, 2, 2
  v_and_b32 v9, 3, v1
  v_lshrrev_b32 v10, 1, v2
  v_lshlrev_b32 v10, 4, v10
  v_and_b32 v11, 1, v2
  v_lshl_add_u32 v10, v11, 2, v10
  v_add_u32 v10, v10, v8
  v_mul_u32_u24 v11, 160, v10
  v_mad_u32_u24 v4, v9, 40, v11
  v_lshl_add_u32 v5, v9, 3, v11
  s_lshl_b32 s9, s8, 5
  s_cmp_eq_u32 s5, 0
  s_cselect_b32 s9, 0, s9
  v_lshrrev_b32 v11, 1, v3
  v_xor_b32 v11, v11, v2
  v_lshlrev_b32 v11, 4, v11
  v_add_u32 v12, s9, v3
  v_lshl_add_u32 v6, v12, 7, v11
  v_xor_b32 v7, 64, v6
  s_lshl_b32 s9, s8, 2
  s_add_u32 s9, s9, 16
  v_add_u32 v14, s9, v0
  v_mov_b32 v16, 0
  v_mov_b32 v17, 0
  v_pk_mov_b32 v[128:129], v[16:17], v[16:17]
  v_pk_mov_b32 v[130:131], v[16:17], v[16:17]
  v_pk_mov_b32 v[132:133], v[16:17], v[16:17]
  v_pk_mov_b32 v[134:135], v[16:17], v[16:17]
  v_pk_mov_b32 v[136:137], v[16:17], v[16:17]
  v_pk_mov_b32 v[138:139], v[16:17], v[16:17]
  v_pk_mov_b32 v[140:141], v[16:17], v[16:17]
  v_pk_mov_b32 v[142:143], v[16:17], v[16:17]
  v_pk_mov_b32 v[144:145], v[16:17], v[16:17]
  v_pk_mov_b32 v[146:147], v[16:17], v[16:17]
  v_pk_mov_b32 v[148:149], v[16:17], v[16:17]
  v_pk_mov_b32 v[150:151], v[16:17], v[16:17]
  v_pk_mov_b32 v[152:153], v[16:17], v[16:17]
  v_pk_mov_b32 v[154:155], v[16:17], v[16:17]
  v_pk_mov_b32 v[156:157], v[16:17], v[16:17]
  v_pk_mov_b32 v[158:159], v[16:17], v[16:17]
  v_pk_mov_b32 v[160:161], v[16:17], v[16:17]
  v_pk_mov_b32 v[162:163], v[16:17], v[16:17]
  v_pk_mov_b32 v[164:165], v[16:17], v[16:17]
  v_pk_mov_b32 v[166:167], v[16:17], v[16:17]
  v_pk_mov_b32 v[168:169], v[16:17], v[16:17]
  v_pk_mov_b32 v[170:171], v[16:17], v[16:17]
  v_pk_mov_b32 v[172:173], v[16:17], v[16:17]
  v_pk_mov_b32 v[174:175], v[16:17], v[16:17]
  v_pk_mov_b32 v[176:177], v[16:17], v[16:17]
  v_pk_mov_b32 v[178:179], v[16:17], v[16:17]
  v_pk_mov_b32 v[180:181], v[16:17], v[16:17]
  v_pk_mov_b32 v[182:183], v[16:17], v[16:17]
  v_pk_mov_b32 v[184:185], v[16:17], v[16:17]
  v_pk_mov_b32 v[186:187], v[16:17], v[16:17]
  v_pk_mov_b32 v[188:189], v[16:17], v[16:17]
  v_pk_mov_b32 v[190:191], v[16:17], v[16:17]
  v_pk_mov_b32 v[192:193], v[16:17], v[16:17]
  v_pk_mov_b32 v[194:195], v[16:17], v[16:17]
  v_pk_mov_b32 v[196:197], v[16:17], v[16:17]
  v_pk_mov_b32 v[198:199], v[16:17], v[16:17]
  v_pk_mov_b32 v[200:201], v[16:17], v[16:17]
  v_pk_mov_b32 v[202:203], v[16:17], v[16:17]
  v_pk_mov_b32 v[204:205], v[16:17], v[16:17]
  v_pk_mov_b32 v[206:207], v[16:17], v[16:17]
  v_pk_mov_b32 v[208:209], v[16:17], v[16:17]
  v_pk_mov_b32 v[210:211], v[16:17], v[16:17]
  v_pk_mov_b32 v[212:213], v[16:17], v[16:17]
  v_pk_mov_b32 v[214:215], v[16:17], v[16:17]
  v_pk_mov_b32 v[216:217], v[16:17], v[16:17]
  v_pk_mov_b32 v[218:219], v[16:17], v[16:17]
  v_pk_mov_b32 v[220:221], v[16:17], v[16:17]
  v_pk_mov_b32 v[222:223], v[16:17], v[16:17]
  v_pk_mov_b32 v[224:225], v[16:17], v[16:17]
  v_pk_mov_b32 v[226:227], v[16:17], v[16:17]
  v_pk_mov_b32 v[228:229], v[16:17], v[16:17]
  v_pk_mov_b32 v[230:231], v[16:17], v[16:17]
  v_pk_mov_b32 v[232:233], v[16:17], v[16:17]
  v_pk_mov_b32 v[234:235], v[16:17], v[16:17]
  v_pk_mov_b32 v[236:237], v[16:17], v[16:17]
  v_pk_mov_b32 v[238:239], v[16:17], v[16:17]
  v_pk_mov_b32 v[240:241], v[16:17], v[16:17]
  v_pk_mov_b32 v[242:243], v[16:17], v[16:17]
  v_pk_mov_b32 v[244:245], v[16:17], v[16:17]
  v_pk_mov_b32 v[246:247], v[16:17], v[16:17]
  s_waitcnt lgkmcnt(0)
  s_cmp_eq_u32 s5, 0
  s_cselect_b32 s56, s20, s28
  s_cselect_b32 s57, s21, s29
  s_mov_b32 s58, 819200
  s_mov_b32 s59, 0x20000
  s_mov_b32 s44, s34
  s_mov_b32 s45, s35
  s_mov_b32 s46, 268435456
  s_mov_b32 s47, 0x20000
  s_mov_b32 s48, s32
  s_mov_b32 s49, s33
  s_mov_b32 s50, 256
  s_mov_b32 s51, 0x20000
  s_mov_b32 s52, s26
  s_mov_b32 s53, s27
  s_mov_b32 s54, 25600
  s_mov_b32 s55, 0x20000
  s_mov_b32 s60, s30
  s_mov_b32 s61, s31
  s_mov_b32 s62, 5242880
  s_mov_b32 s63, 0x20000
  s_lshl_b32 s77, s5, 4
  s_add_u32 s77, s77, s6
  s_lshl_b32 s76, s77, 2
  s_add_u32 s76, s76, s8
  s_lshl_b32 s76, s76, 8
  s_add_u32 s76, s76, 9437184
  s_lshl_b32 s77, s77, 2
  s_add_u32 s77, s77, 0
  s_mov_b32 s10, 0
  v_mov_b32 v74, 0
  v_add_u32 v73, 132, v0
  s_mov_b32 s100, 47104
  s_mov_b32 s101, 47104
  s_mov_b32 s11, -94208
  s_mov_b32 s14, 0
lw_24:
  ds_read_b64 v[248:249], v0 offset:32
  s_waitcnt lgkmcnt(0)
  v_min_u32 v248, v248, v249
  s_nop 0
  v_readfirstlane_b32 s9, v248
  s_nop 0
  s_cmp_ge_u32 s9, 1
  s_cbranch_scc1 lwok_25
  s_sleep 1
  s_add_u32 s14, s14, 1
  s_cmp_lt_u32 s14, 1048576
  s_cbranch_scc1 lw_24
lwok_25:
  v_bfe_u32 v8, v1, 2, 2
  v_and_b32 v9, 3, v1
  v_mul_u32_u24 v10, 800, v2
  v_mad_u32_u24 v10, v8, 40, v10
  v_add_u32 v10, 159744, v10
  v_mov_b32 v11, 162944
  v_cmp_eq_u32 vcc, v9, v2
  v_add_u32 v12, 640, v10
  s_nop 0
  v_cndmask_b32 v10, v11, v10, vcc
  v_cndmask_b32 v11, v11, v12, vcc
  ds_read_b64_tr_b16 v[84:85], v11 offset:0
  ds_read_b64_tr_b16 v[94:95], v11 offset:8
  ds_read_b64_tr_b16 v[104:105], v11 offset:16
  ds_read_b64_tr_b16 v[114:115], v11 offset:24
  ds_read_b64_tr_b16 v[124:125], v11 offset:32
  ds_read_b64_tr_b16 v[76:77], v10 offset:0
  ds_read_b64_tr_b16 v[78:79], v10 offset:160
  ds_read_b64_tr_b16 v[80:81], v10 offset:320
  ds_read_b64_tr_b16 v[82:83], v10 offset:480
  ds_read_b64_tr_b16 v[86:87], v10 offset:8
  ds_read_b64_tr_b16 v[88:89], v10 offset:168
  ds_read_b64_tr_b16 v[90:91], v10 offset:328
  ds_read_b64_tr_b16 v[92:93], v10 offset:488
  ds_read_b64_tr_b16 v[96:97], v10 offset:16
  ds_read_b64_tr_b16 v[98:99], v10 offset:176
  ds_read_b64_tr_b16 v[100:101], v10 offset:336
  ds_read_b64_tr_b16 v[102:103], v10 offset:496
  ds_read_b64_tr_b16 v[106:107], v10 offset:24
  ds_read_b64_tr_b16 v[108:109], v10 offset:184
  ds_read_b64_tr_b16 v[110:111], v10 offset:344
  ds_read_b64_tr_b16 v[112:113], v10 offset:504
  ds_read_b64_tr_b16 v[116:117], v10 offset:32
  ds_read_b64_tr_b16 v[118:119], v10 offset:192
  ds_read_b64_tr_b16 v[120:121], v10 offset:352
  ds_read_b64_tr_b16 v[122:123], v10 offset:512
  s_lshl_b32 s9, s8, 5
  s_add_u32 s9, s9, 0
  v_add_u32 v12, s9, v3
  v_mul_u32_u24 v12, 544, v12
  v_add_u32 v12, 90112, v12
  v_mul_u32_u24 v13, 80, v2
  v_add_u32 v126, v13, v12
  v_mad_u32_u24 v127, v2, 48, v12
  s_mul_i32 s9, s8, 3072
  s_add_u32 s9, s9, 76800
  v_lshlrev_b32 v13, 4, v1
  v_add_u32 v13, s9, v13
  s_mov_b32 s64, 0x3fb8aa3b
  s_mov_b32 s65, 0x3fb8aa3b
  s_mov_b32 s14, 0
lz_26:
  ds_read_b32 v72, v0 offset:128
  s_waitcnt lgkmcnt(0)
  v_readfirstlane_b32 s9, v72
  s_nop 0
  s_cmp_eq_u32 s9, 0
  s_cbranch_scc1 lzok_27
  s_sleep 1
  s_add_u32 s14, s14, 1
  s_cmp_lt_u32 s14, 1048576
  s_cbranch_scc1 lz_26
lzok_27:
  ds_read_b128 v[56:59], v6 offset:0
  ds_read_b128 v[60:63], v6 offset:2048
  ds_read_b64_tr_b16 v[16:17], v4 offset:16384
  ds_read_b64_tr_b16 v[18:19], v4 offset:17664
  ds_read_b64_tr_b16 v[20:21], v4 offset:16392
  ds_read_b64_tr_b16 v[22:23], v4 offset:17672
  ds_read_b64_tr_b16 v[24:25], v4 offset:16400
  ds_read_b64_tr_b16 v[26:27], v4 offset:17680
  ds_read_b64_tr_b16 v[28:29], v4 offset:16408
  ds_read_b64_tr_b16 v[30:31], v4 offset:17688
  ds_read_b64_tr_b16 v[32:33], v4 offset:16416
  ds_read_b64_tr_b16 v[34:35], v4 offset:17696
.p2align 3
gl_23:
  s_waitcnt lgkmcnt(6)
  v_mfma_f32_16x16x32_bf16 v[128:131], v[16:19], v[56:59], v[128:131]
  ds_read_b64_tr_b16 v[36:37], v4 offset:26624
  ds_read_b128 v[64:67], v7 offset:0
  v_mfma_f32_16x16x32_bf16 v[132:135], v[16:19], v[60:63], v[132:135]
  ds_read_b64_tr_b16 v[38:39], v4 offset:27904
  ds_read_b128 v[68:71], v7 offset:2048
  v_mfma_f32_16x16x32_bf16 v[136:139], v[20:23], v[56:59], v[136:139]
  ds_read_b64_tr_b16 v[40:41], v4 offset:26632
  s_mov_b32 s13, s100
  v_mfma_f32_16x16x32_bf16 v[140:143], v[20:23], v[60:63], v[140:143]
  ds_read_b64_tr_b16 v[42:43], v4 offset:27912
  s_waitcnt lgkmcnt(8)
  v_mfma_f32_16x16x32_bf16 v[144:147], v[24:27], v[56:59], v[144:147]
  ds_read_b64_tr_b16 v[44:45], v4 offset:26640
  v_add_u32 v74, 1, v74
  v_mfma_f32_16x16x32_bf16 v[148:151], v[24:27], v[60:63], v[148:151]
  ds_read_b64_tr_b16 v[46:47], v4 offset:27920
  s_mov_b32 s100, s101
  v_mfma_f32_16x16x32_bf16 v[152:155], v[28:31], v[56:59], v[152:155]
  ds_read_b64_tr_b16 v[48:49], v4 offset:26648
  s_mov_b32 s101, s11
  v_mfma_f32_16x16x32_bf16 v[156:159], v[28:31], v[60:63], v[156:159]
  ds_read_b64_tr_b16 v[50:51], v4 offset:27928
  s_waitcnt lgkmcnt(7)
  v_mfma_f32_16x16x32_bf16 v[160:163], v[32:35], v[56:59], v[160:163]
  ds_read_b64_tr_b16 v[52:53], v4 offset:26656
  ds_read_b32 v75, v73
  v_mfma_f32_16x16x32_bf16 v[164:167], v[32:35], v[60:63], v[164:167]
  ds_read_b64_tr_b16 v[54:55], v4 offset:27936
  s_mov_b32 s11, s13
  v_mfma_f32_16x16x32_bf16 v[168:171], v[36:39], v[56:59], v[168:171]
  ds_read_b64_tr_b16 v[16:17], v4 offset:36864
  v_add_u32 v6, s13, v6
  v_mfma_f32_16x16x32_bf16 v[172:175], v[36:39], v[60:63], v[172:175]
  ds_read_b64_tr_b16 v[18:19], v4 offset:38144
  s_waitcnt lgkmcnt(7)
  v_mfma_f32_16x16x32_bf16 v[176:179], v[40:43], v[56:59], v[176:179]
  ds_read_b64_tr_b16 v[20:21], v4 offset:36872
  v_add_u32 v7, s13, v7
  v_mfma_f32_16x16x32_bf16 v[180:183], v[40:43], v[60:63], v[180:183]
  ds_read_b64_tr_b16 v[22:23], v4 offset:38152
  v_mfma_f32_16x16x32_bf16 v[184:187], v[44:47], v[56:59], v[184:187]
  ds_read_b64_tr_b16 v[24:25], v4 offset:36880
  v_mfma_f32_16x16x32_bf16 v[188:191], v[44:47], v[60:63], v[188:191]
  ds_read_b64_tr_b16 v[26:27], v4 offset:38160
  s_waitcnt lgkmcnt(6)
  v_mfma_f32_16x16x32_bf16 v[192:195], v[48:51], v[56:59], v[192:195]
  ds_read_b64_tr_b16 v[28:29], v4 offset:36888
  v_readfirstlane_b32 s12, v75
  v_mfma_f32_16x16x32_bf16 v[196:199], v[48:51], v[60:63], v[196:199]
  ds_read_b64_tr_b16 v[30:31], v4 offset:38168
  v_mfma_f32_16x16x32_bf16 v[200:203], v[52:55], v[56:59], v[200:203]
  ds_read_b64_tr_b16 v[32:33], v4 offset:36896
  v_mfma_f32_16x16x32_bf16 v[204:207], v[52:55], v[60:63], v[204:207]
  ds_read_b64_tr_b16 v[34:35], v4 offset:38176
  s_cmp_eq_u32 s12, 0
  s_cbranch_scc0 slowb_30
backb_31:
  s_waitcnt lgkmcnt(6)
  v_mfma_f32_16x16x32_bf16 v[208:211], v[16:19], v[56:59], v[208:211]
  ds_read_b64_tr_b16 v[36:37], v4 offset:21504
  v_mfma_f32_16x16x32_bf16 v[212:215], v[16:19], v[60:63], v[212:215]
  ds_read_b64_tr_b16 v[38:39], v4 offset:22784
  v_mfma_f32_16x16x32_bf16 v[216:219], v[20:23], v[56:59], v[216:219]
  ds_read_b64_tr_b16 v[40:41], v4 offset:21512
  v_mfma_f32_16x16x32_bf16 v[220:223], v[20:23], v[60:63], v[220:223]
  ds_read_b64_tr_b16 v[42:43], v4 offset:22792
  s_waitcnt lgkmcnt(6)
  v_mfma_f32_16x16x32_bf16 v[224:227], v[24:27], v[56:59], v[224:227]
  ds_read_b64_tr_b16 v[44:45], v4 offset:21520
  v_mfma_f32_16x16x32_bf16 v[228:231], v[24:27], v[60:63], v[228:231]
  ds_read_b64_tr_b16 v[46:47], v4 offset:22800
  v_mfma_f32_16x16x32_bf16 v[232:235], v[28:31], v[56:59], v[232:235]
  ds_read_b64_tr_b16 v[48:49], v4 offset:21528
  v_mfma_f32_16x16x32_bf16 v[236:239], v[28:31], v[60:63], v[236:239]
  ds_read_b64_tr_b16 v[50:51], v4 offset:22808
  s_waitcnt lgkmcnt(6)
  v_mfma_f32_16x16x32_bf16 v[240:243], v[32:35], v[56:59], v[240:243]
  ds_read_b64_tr_b16 v[52:53], v4 offset:21536
  ds_write_b32 v14, v74
  v_mfma_f32_16x16x32_bf16 v[244:247], v[32:35], v[60:63], v[244:247]
  ds_read_b64_tr_b16 v[54:55], v4 offset:22816
  v_mfma_f32_16x16x32_bf16 v[128:131], v[36:39], v[64:67], v[128:131]
  ds_read_b64_tr_b16 v[16:17], v4 offset:31744
  v_add_u32 v74, 1, v74
  v_mfma_f32_16x16x32_bf16 v[132:135], v[36:39], v[68:71], v[132:135]
  ds_read_b64_tr_b16 v[18:19], v4 offset:33024
  s_waitcnt lgkmcnt(7)
  v_mfma_f32_16x16x32_bf16 v[136:139], v[40:43], v[64:67], v[136:139]
  ds_read_b64_tr_b16 v[20:21], v4 offset:31752
  v_mfma_f32_16x16x32_bf16 v[140:143], v[40:43], v[68:71], v[140:143]
  ds_read_b64_tr_b16 v[22:23], v4 offset:33032
  v_mfma_f32_16x16x32_bf16 v[144:147], v[44:47], v[64:67], v[144:147]
  ds_read_b64_tr_b16 v[24:25], v4 offset:31760
  v_mfma_f32_16x16x32_bf16 v[148:151], v[44:47], v[68:71], v[148:151]
  ds_read_b64_tr_b16 v[26:27], v4 offset:33040
  s_waitcnt lgkmcnt(6)
  v_mfma_f32_16x16x32_bf16 v[152:155], v[48:51], v[64:67], v[152:155]
  ds_read_b64_tr_b16 v[28:29], v4 offset:31768
  v_mfma_f32_16x16x32_bf16 v[156:159], v[48:51], v[68:71], v[156:159]
  ds_read_b64_tr_b16 v[30:31], v4 offset:33048
  v_mfma_f32_16x16x32_bf16 v[160:163], v[52:55], v[64:67], v[160:163]
  ds_read_b64_tr_b16 v[32:33], v4 offset:31776
  v_mfma_f32_16x16x32_bf16 v[164:167], v[52:55], v[68:71], v[164:167]
  ds_read_b64_tr_b16 v[34:35], v4 offset:33056
  s_waitcnt lgkmcnt(6)
  v_mfma_f32_16x16x32_bf16 v[168:171], v[16:19], v[64:67], v[168:171]
  ds_read_b64_tr_b16 v[36:37], v4 offset:41984
  ds_read_b32 v72, v73 offset:4
  v_mfma_f32_16x16x32_bf16 v[172:175], v[16:19], v[68:71], v[172:175]
  ds_read_b64_tr_b16 v[38:39], v4 offset:43264
  v_mfma_f32_16x16x32_bf16 v[176:179], v[20:23], v[64:67], v[176:179]
  ds_read_b64_tr_b16 v[40:41], v4 offset:41992
  v_mfma_f32_16x16x32_bf16 v[180:183], v[20:23], v[68:71], v[180:183]
  ds_read_b64_tr_b16 v[42:43], v4 offset:43272
  s_waitcnt lgkmcnt(7)
  v_mfma_f32_16x16x32_bf16 v[184:187], v[24:27], v[64:67], v[184:187]
  ds_read_b64_tr_b16 v[44:45], v4 offset:42000
  v_mfma_f32_16x16x32_bf16 v[188:191], v[24:27], v[68:71], v[188:191]
  ds_read_b64_tr_b16 v[46:47], v4 offset:43280
  v_mfma_f32_16x16x32_bf16 v[192:195], v[28:31], v[64:67], v[192:195]
  ds_read_b64_tr_b16 v[48:49], v4 offset:42008
  v_mfma_f32_16x16x32_bf16 v[196:199], v[28:31], v[68:71], v[196:199]
  ds_read_b64_tr_b16 v[50:51], v4 offset:43288
  s_waitcnt lgkmcnt(6)
  v_mfma_f32_16x16x32_bf16 v[200:203], v[32:35], v[64:67], v[200:203]
  ds_read_b64_tr_b16 v[52:53], v4 offset:42016
  v_readfirstlane_b32 s9, v72
  v_mfma_f32_16x16x32_bf16 v[204:207], v[32:35], v[68:71], v[204:207]
  ds_read_b64_tr_b16 v[54:55], v4 offset:43296
  v_add_u32 v4, s13, v4
  s_cmp_eq_u32 s9, 0
  s_cbranch_scc0 slow_28
back_29:
  v_mfma_f32_16x16x32_bf16 v[208:211], v[36:39], v[64:67], v[208:211]
  ds_read_b64_tr_b16 v[16:17], v4 offset:16384
  ds_read_b128 v[56:59], v6 offset:0
  ds_read_b128 v[60:63], v6 offset:2048
  v_mfma_f32_16x16x32_bf16 v[212:215], v[36:39], v[68:71], v[212:215]
  ds_read_b64_tr_b16 v[18:19], v4 offset:17664
  s_waitcnt lgkmcnt(8)
  v_mfma_f32_16x16x32_bf16 v[216:219], v[40:43], v[64:67], v[216:219]
  ds_read_b64_tr_b16 v[20:21], v4 offset:16392
  v_add_u32 v73, 8, v73
  v_mfma_f32_16x16x32_bf16 v[220:223], v[40:43], v[68:71], v[220:223]
  ds_read_b64_tr_b16 v[22:23], v4 offset:17672
  s_add_u32 s10, s10, 1
  v_mfma_f32_16x16x32_bf16 v[224:227], v[44:47], v[64:67], v[224:227]
  ds_read_b64_tr_b16 v[24:25], v4 offset:16400
  v_mfma_f32_16x16x32_bf16 v[228:231], v[44:47], v[68:71], v[228:231]
  ds_read_b64_tr_b16 v[26:27], v4 offset:17680
  s_waitcnt lgkmcnt(8)
  v_mfma_f32_16x16x32_bf16 v[232:235], v[48:51], v[64:67], v[232:235]
  ds_read_b64_tr_b16 v[28:29], v4 offset:16408
  ds_write_b32 v14, v74
  v_mfma_f32_16x16x32_bf16 v[236:239], v[48:51], v[68:71], v[236:239]
  ds_read_b64_tr_b16 v[30:31], v4 offset:17688
  v_mfma_f32_16x16x32_bf16 v[240:243], v[52:55], v[64:67], v[240:243]
  ds_read_b64_tr_b16 v[32:33], v4 offset:16416
  v_mfma_f32_16x16x32_bf16 v[244:247], v[52:55], v[68:71], v[244:247]
  ds_read_b64_tr_b16 v[34:35], v4 offset:17696
  s_cmp_lt_u32 s10, 10
  s_cbranch_scc1 gl_23
  s_waitcnt lgkmcnt(0)
  s_branch gd_32
slow_28:
  s_mov_b32 s14, 0
lz_33:
  ds_read_b32 v72, v73 offset:4
  s_waitcnt lgkmcnt(0)
  v_readfirstlane_b32 s9, v72
  s_nop 0
  s_cmp_eq_u32 s9, 0
  s_cbranch_scc1 lzok_34
  s_add_u32 s14, s14, 1
  s_cmp_lt_u32 s14, 1048576
  s_cbranch_scc1 lz_33
lzok_34:
  s_branch back_29
slowb_30:
  s_mov_b32 s14, 0
lz_35:
  ds_read_b32 v72, v73 offset:0
  s_waitcnt lgkmcnt(0)
  v_readfirstlane_b32 s9, v72
  s_nop 0
  s_cmp_eq_u32 s9, 0
  s_cbranch_scc1 lzok_36
  s_add_u32 s14, s14, 1
  s_cmp_lt_u32 s14, 1048576
  s_cbranch_scc1 lz_35
lzok_36:
  s_branch backb_31
gd_32:
  v_cvt_pk_bf16_f32 v16, v172, v173
  v_cvt_pk_bf16_f32 v17, v174, v175
  v_cvt_pk_bf16_f32 v18, v180, v181
  v_cvt_pk_bf16_f32 v19, v182, v183
  v_cvt_pk_bf16_f32 v20, v188, v189
  v_cvt_pk_bf16_f32 v21, v190, v191
  v_cvt_pk_bf16_f32 v22, v196, v197
  v_cvt_pk_bf16_f32 v23, v198, v199
  v_cvt_pk_bf16_f32 v24, v204, v205
  v_cvt_pk_bf16_f32 v25, v206, v207
  s_mov_b32 s14, 0
lw_37:
  ds_read_b128 v[248:251], v0 offset:16
  s_waitcnt lgkmcnt(0)
  v_min3_u32 v248, v248, v249, v250
  v_min_u32 v248, v248, v251
  s_nop 0
  v_readfirstlane_b32 s9, v248
  s_nop 0
  s_cmp_ge_u32 s9, 18
  s_cbranch_scc1 lwok_38
  s_sleep 1
  s_add_u32 s14, s14, 1
  s_cmp_lt_u32 s14, 1048576
  s_cbranch_scc1 lw_37
lwok_38:
  ds_write_b128 v13, v[16:19] offset:0
  ds_write_b128 v13, v[20:23] offset:1024
  ds_write_b128 v13, v[24:27] offset:2048
  v_mov_b32 v12, 1
  ds_write_b32 v14, v12 offset:64
  v_cvt_pk_bf16_f32 v28, v168, v169
  v_cvt_pk_bf16_f32 v29, v170, v171
  v_cvt_pk_bf16_f32 v30, v176, v177
  v_cvt_pk_bf16_f32 v31, v178, v179
  v_cvt_pk_bf16_f32 v32, v184, v185
  v_cvt_pk_bf16_f32 v33, v186, v187
  v_cvt_pk_bf16_f32 v34, v192, v193
  v_cvt_pk_bf16_f32 v35, v194, v195
  v_cvt_pk_bf16_f32 v36, v200, v201
  v_cvt_pk_bf16_f32 v37, v202, v203
  s_nop 1
  v_mfma_f32_16x16x16_bf16 v[168:171], v[84:85], v[36:37], 0
  v_mfma_f32_16x16x16_bf16 v[172:175], v[94:95], v[36:37], 0
  v_mfma_f32_16x16x16_bf16 v[176:179], v[104:105], v[36:37], 0
  v_mfma_f32_16x16x16_bf16 v[180:183], v[114:115], v[36:37], 0
  v_mfma_f32_16x16x16_bf16 v[184:187], v[124:125], v[36:37], 0
  s_nop 1
  v_mfma_f32_16x16x32_bf16 v[168:171], v[76:79], v[28:31], v[168:171]
  v_mfma_f32_16x16x32_bf16 v[172:175], v[86:89], v[28:31], v[172:175]
  v_mfma_f32_16x16x32_bf16 v[176:179], v[96:99], v[28:31], v[176:179]
  v_mfma_f32_16x16x32_bf16 v[180:183], v[106:109], v[28:31], v[180:183]
  v_mfma_f32_16x16x32_bf16 v[184:187], v[116:119], v[28:31], v[184:187]
  v_mfma_f32_16x16x32_bf16 v[168:171], v[80:83], v[32:35], v[168:171]
  v_mfma_f32_16x16x32_bf16 v[172:175], v[90:93], v[32:35], v[172:175]
  v_mfma_f32_16x16x32_bf16 v[176:179], v[100:103], v[32:35], v[176:179]
  v_mfma_f32_16x16x32_bf16 v[180:183], v[110:113], v[32:35], v[180:183]
  v_mfma_f32_16x16x32_bf16 v[184:187], v[120:123], v[32:35], v[184:187]
  v_mov_b32 v50, 0x3f803f80
  v_mov_b32 v51, 0x3f803f80
  v_mov_b32 v62, 0x3f803f80
  v_mov_b32 v63, 0x3f803f80
  v_cvt_pk_bf16_f32 v40, v208, v209
  v_cvt_pk_bf16_f32 v41, v210, v211
  v_cvt_pk_bf16_f32 v42, v216, v217
  v_cvt_pk_bf16_f32 v43, v218, v219
  v_cvt_pk_bf16_f32 v44, v224, v225
  v_cvt_pk_bf16_f32 v45, v226, v227
  v_cvt_pk_bf16_f32 v46, v232, v233
  v_cvt_pk_bf16_f32 v47, v234, v235
  v_cvt_pk_bf16_f32 v48, v240, v241
  v_cvt_pk_bf16_f32 v49, v242, v243
  ds_write_b128 v127, v[40:43] offset:320
  ds_write_b128 v127, v[44:47] offset:336
  ds_write_b128 v127, v[48:51] offset:352
  v_cvt_pk_bf16_f32 v52, v212, v213
  v_cvt_pk_bf16_f32 v53, v214, v215
  v_cvt_pk_bf16_f32 v54, v220, v221
  v_cvt_pk_bf16_f32 v55, v222, v223
  v_cvt_pk_bf16_f32 v56, v228, v229
  v_cvt_pk_bf16_f32 v57, v230, v231
  v_cvt_pk_bf16_f32 v58, v236, v237
  v_cvt_pk_bf16_f32 v59, v238, v239
  v_cvt_pk_bf16_f32 v60, v244, v245
  v_cvt_pk_bf16_f32 v61, v246, v247
  ds_write_b128 v127, v[52:55] offset:9024
  ds_write_b128 v127, v[56:59] offset:9040
  ds_write_b128 v127, v[60:63] offset:9056
  v_max3_f32 v248, v168, v169, v170
  v_min3_f32 v250, v168, v169, v170
  v_max3_f32 v249, v171, v172, v173
  v_min3_f32 v251, v171, v172, v173
  v_max3_f32 v248, v248, v174, v175
  v_min3_f32 v250, v250, v174, v175
  v_max3_f32 v249, v249, v176, v177
  v_min3_f32 v251, v251, v176, v177
  v_max3_f32 v248, v248, v178, v179
  v_min3_f32 v250, v250, v178, v179
  v_max3_f32 v249, v249, v180, v181
  v_min3_f32 v251, v251, v180, v181
  v_max3_f32 v248, v248, v182, v183
  v_min3_f32 v250, v250, v182, v183
  v_max3_f32 v249, v249, v184, v185
  v_min3_f32 v251, v251, v184, v185
  v_max3_f32 v248, v248, v186, v187
  v_min3_f32 v250, v250, v186, v187
  v_max_f32 v248, v248, v249
  v_min_f32 v250, v250, v251
  v_mul_f32 v248, s64, v248
  v_mul_f32 v250, s64, v250
  v_pk_fma_f32 v[208:209], v[168:169], s[64:65], v[250:251] op_sel_hi:[1,1,0] neg_lo:[1,0,0] neg_hi:[1,0,0]
  v_pk_fma_f32 v[168:169], v[168:169], s[64:65], v[248:249] op_sel_hi:[1,1,0] neg_lo:[0,0,1] neg_hi:[0,0,1]
  v_pk_fma_f32 v[210:211], v[170:171], s[64:65], v[250:251] op_sel_hi:[1,1,0] neg_lo:[1,0,0] neg_hi:[1,0,0]
  v_pk_fma_f32 v[170:171], v[170:171], s[64:65], v[248:249] op_sel_hi:[1,1,0] neg_lo:[0,0,1] neg_hi:[0,0,1]
  v_pk_fma_f32 v[212:213], v[172:173], s[64:65], v[250:251] op_sel_hi:[1,1,0] neg_lo:[1,0,0] neg_hi:[1,0,0]
  v_pk_fma_f32 v[172:173], v[172:173], s[64:65], v[248:249] op_sel_hi:[1,1,0] neg_lo:[0,0,1] neg_hi:[0,0,1]
  v_pk_fma_f32 v[214:215], v[174:175], s[64:65], v[250:251] op_sel_hi:[1,1,0] neg_lo:[1,0,0] neg_hi:[1,0,0]
  v_pk_fma_f32 v[174:175], v[174:175], s[64:65], v[248:249] op_sel_hi:[1,1,0] neg_lo:[0,0,1] neg_hi:[0,0,1]
  v_pk_fma_f32 v[216:217], v[176:177], s[64:65], v[250:251] op_sel_hi:[1,1,0] neg_lo:[1,0,0] neg_hi:[1,0,0]
  v_pk_fma_f32 v[176:177], v[176:177], s[64:65], v[248:249] op_sel_hi:[1,1,0] neg_lo:[0,0,1] neg_hi:[0,0,1]
  v_pk_fma_f32 v[218:219], v[178:179], s[64:65], v[250:251] op_sel_hi:[1,1,0] neg_lo:[1,0,0] neg_hi:[1,0,0]
  v_pk_fma_f32 v[178:179], v[178:179], s[64:65], v[248:249] op_sel_hi:[1,1,0] neg_lo:[0,0,1] neg_hi:[0,0,1]
  v_pk_fma_f32 v[220:221], v[180:181], s[64:65], v[250:251] op_sel_hi:[1,1,0] neg_lo:[1,0,0] neg_hi:[1,0,0]
  v_pk_fma_f32 v[180:181], v[180:181], s[64:65], v[248:249] op_sel_hi:[1,1,0] neg_lo:[0,0,1] neg_hi:[0,0,1]
  v_pk_fma_f32 v[222:223], v[182:183], s[64:65], v[250:251] op_sel_hi:[1,1,0] neg_lo:[1,0,0] neg_hi:[1,0,0]
  v_pk_fma_f32 v[182:183], v[182:183], s[64:65], v[248:249] op_sel_hi:[1,1,0] neg_lo:[0,0,1] neg_hi:[0,0,1]
  v_pk_fma_f32 v[224:225], v[184:185], s[64:65], v[250:251] op_sel_hi:[1,1,0] neg_lo:[1,0,0] neg_hi:[1,0,0]
  v_pk_fma_f32 v[184:185], v[184:185], s[64:65], v[248:249] op_sel_hi:[1,1,0] neg_lo:[0,0,1] neg_hi:[0,0,1]
  v_pk_fma_f32 v[226:227], v[186:187], s[64:65], v[250:251] op_sel_hi:[1,1,0] neg_lo:[1,0,0] neg_hi:[1,0,0]
  v_pk_fma_f32 v[186:187], v[186:187], s[64:65], v[248:249] op_sel_hi:[1,1,0] neg_lo:[0,0,1] neg_hi:[0,0,1]
  v_exp_f32 v168, v168
  v_exp_f32 v169, v169
  v_exp_f32 v170, v170
  v_exp_f32 v171, v171
  v_exp_f32 v172, v172
  v_exp_f32 v173, v173
  v_exp_f32 v174, v174
  v_exp_f32 v175, v175
  v_exp_f32 v176, v176
  v_exp_f32 v177, v177
  v_exp_f32 v178, v178
  v_exp_f32 v179, v179
  v_exp_f32 v180, v180
  v_exp_f32 v181, v181
  v_exp_f32 v182, v182
  v_exp_f32 v183, v183
  v_exp_f32 v184, v184
  v_exp_f32 v185, v185
  v_exp_f32 v186, v186
  v_exp_f32 v187, v187
  v_exp_f32 v208, v208
  v_pk_add_f32 v[248:249], v[168:169], v[170:171]
  v_exp_f32 v209, v209
  v_pk_add_f32 v[248:249], v[248:249], v[172:173]
  v_exp_f32 v210, v210
  v_pk_add_f32 v[248:249], v[248:249], v[174:175]
  v_exp_f32 v211, v211
  v_pk_add_f32 v[248:249], v[248:249], v[176:177]
  v_exp_f32 v212, v212
  v_pk_add_f32 v[248:249], v[248:249], v[178:179]
  v_exp_f32 v213, v213
  v_pk_add_f32 v[248:249], v[248:249], v[180:181]
  v_exp_f32 v214, v214
  v_pk_add_f32 v[248:249], v[248:249], v[182:183]
  v_exp_f32 v215, v215
  v_pk_add_f32 v[248:249], v[248:249], v[184:185]
  v_exp_f32 v216, v216
  v_pk_add_f32 v[248:249], v[248:249], v[186:187]
  v_exp_f32 v217, v217
  v_add_f32 v248, v248, v249
  v_exp_f32 v218, v218
  v_rcp_f32 v248, v248
  v_exp_f32 v219, v219
  v_exp_f32 v220, v220
  v_exp_f32 v221, v221
  v_exp_f32 v222, v222
  v_exp_f32 v223, v223
  v_exp_f32 v224, v224
  v_exp_f32 v225, v225
  v_exp_f32 v226, v226
  v_exp_f32 v227, v227
  v_pk_add_f32 v[250:251], v[208:209], v[210:211]
  v_pk_mul_f32 v[168:169], v[168:169], v[248:249] op_sel_hi:[1,0]
  v_pk_add_f32 v[250:251], v[250:251], v[212:213]
  v_pk_mul_f32 v[170:171], v[170:171], v[248:249] op_sel_hi:[1,0]
  v_pk_add_f32 v[250:251], v[250:251], v[214:215]
  v_pk_mul_f32 v[172:173], v[172:173], v[248:249] op_sel_hi:[1,0]
  v_pk_add_f32 v[250:251], v[250:251], v[216:217]
  v_pk_mul_f32 v[174:175], v[174:175], v[248:249] op_sel_hi:[1,0]
  v_pk_add_f32 v[250:251], v[250:251], v[218:219]
  v_pk_mul_f32 v[176:177], v[176:177], v[248:249] op_sel_hi:[1,0]
  v_pk_add_f32 v[250:251], v[250:251], v[220:221]
  v_pk_mul_f32 v[178:179], v[178:179], v[248:249] op_sel_hi:[1,0]
  v_pk_add_f32 v[250:251], v[250:251], v[222:223]
  v_pk_mul_f32 v[180:181], v[180:181], v[248:249] op_sel_hi:[1,0]
  v_pk_add_f32 v[250:251], v[250:251], v[224:225]
  v_pk_mul_f32 v[182:183], v[182:183], v[248:249] op_sel_hi:[1,0]
  v_pk_add_f32 v[250:251], v[250:251], v[226:227]
  v_pk_mul_f32 v[184:185], v[184:185], v[248:249] op_sel_hi:[1,0]
  v_add_f32 v250, v250, v251
  v_pk_mul_f32 v[186:187], v[186:187], v[248:249] op_sel_hi:[1,0]
  v_rcp_f32 v250, v250
  v_cvt_pk_bf16_f32 v16, v168, v169
  v_cvt_pk_bf16_f32 v17, v170, v171
  v_cvt_pk_bf16_f32 v18, v172, v173
  v_cvt_pk_bf16_f32 v19, v174, v175
  ds_write_b128 v126, v[16:19] offset:0
  v_cvt_pk_bf16_f32 v20, v176, v177
  v_cvt_pk_bf16_f32 v21, v178, v179
  v_cvt_pk_bf16_f32 v22, v180, v181
  v_cvt_pk_bf16_f32 v23, v182, v183
  ds_write_b128 v126, v[20:23] offset:16
  v_cvt_pk_bf16_f32 v24, v184, v185
  v_cvt_pk_bf16_f32 v25, v186, v187
  v_pk_mul_f32 v[208:209], v[208:209], v[250:251] op_sel_hi:[1,0]
  v_pk_mul_f32 v[210:211], v[210:211], v[250:251] op_sel_hi:[1,0]
  v_pk_mul_f32 v[212:213], v[212:213], v[250:251] op_sel_hi:[1,0]
  v_pk_mul_f32 v[214:215], v[214:215], v[250:251] op_sel_hi:[1,0]
  v_pk_mul_f32 v[216:217], v[216:217], v[250:251] op_sel_hi:[1,0]
  v_pk_mul_f32 v[218:219], v[218:219], v[250:251] op_sel_hi:[1,0]
  v_pk_mul_f32 v[220:221], v[220:221], v[250:251] op_sel_hi:[1,0]
  v_pk_mul_f32 v[222:223], v[222:223], v[250:251] op_sel_hi:[1,0]
  v_pk_mul_f32 v[224:225], v[224:225], v[250:251] op_sel_hi:[1,0]
  v_pk_mul_f32 v[226:227], v[226:227], v[250:251] op_sel_hi:[1,0]
  v_cvt_pk_bf16_f32 v26, v208, v209
  v_cvt_pk_bf16_f32 v27, v210, v211
  ds_write_b128 v126, v[24:27] offset:32
  v_cvt_pk_bf16_f32 v28, v212, v213
  v_cvt_pk_bf16_f32 v29, v214, v215
  v_cvt_pk_bf16_f32 v30, v216, v217
  v_cvt_pk_bf16_f32 v31, v218, v219
  ds_write_b128 v126, v[28:31] offset:48
  v_cvt_pk_bf16_f32 v32, v220, v221
  v_cvt_pk_bf16_f32 v33, v222, v223
  v_cvt_pk_bf16_f32 v34, v224, v225
  v_cvt_pk_bf16_f32 v35, v226, v227
  ds_write_b128 v126, v[32:35] offset:64
  v_mov_b32 v12, 1
  ds_write_b32 v14, v12 offset:32
  v_mul_u32_u24 v8, 26, v1
  v_lshrrev_b32 v8, 8, v8
  v_mul_u32_u24 v9, 10, v8
  v_sub_u32 v9, v1, v9
  v_lshlrev_b32 v9, 4, v9
  v_mov_b32 v7, 0x7fffff00
  s_mov_b32 s66, -1
  s_mov_b32 s67, 0x0fffffff
  s_mov_b32 s68, -1
  s_mov_b32 s69, 0xff
  s_mul_i32 s70, s7, 160
  v_mul_u32_u24 v60, 1280, v8
  v_add_u32 v60, v60, v9
  v_add_u32 v61, 6720, v60
  v_add_u32 v62, 13440, v60
  v_add_u32 v63, 20160, v60
  s_cmp_lt_u32 s8, 2
  s_cbranch_scc0 k_nw12
  s_mov_b32 s14, 0
lw_39:
  ds_read_b128 v[248:251], v0 offset:16
  s_waitcnt lgkmcnt(0)
  v_min3_u32 v248, v248, v249, v250
  v_min_u32 v248, v248, v251
  s_nop 0
  v_readfirstlane_b32 s9, v248
  s_nop 0
  s_cmp_ge_u32 s9, 20
  s_cbranch_scc1 lwok_40
  s_sleep 1
  s_add_u32 s14, s14, 1
  s_cmp_lt_u32 s14, 1048576
  s_cbranch_scc1 lw_39
lwok_40:
  s_mul_i32 s12, s8, 25600
  s_add_u32 s13, s8, 1
  s_lshl_b32 s10, s13, 2
  s_add_u32 s10, s10, 163808
  s_mul_i32 s13, s13, 204800
  s_add_u32 s13, s13, s70
  s_mov_b64 exec, s[66:67]
  s_add_u32 m0, s12, 0
  s_add_u32 s15, s13, 0
  buffer_load_dwordx4 v60, s[56:59], s15 offen offset:0 lds
  buffer_load_dwordx4 v61, s[56:59], s15 offen offset:960 lds
  buffer_load_dwordx4 v62, s[56:59], s15 offen offset:1920 lds
  buffer_load_dwordx4 v63, s[56:59], s15 offen offset:2880 lds
  s_add_u32 m0, s12, 3840
  s_add_u32 s15, s13, 30720
  buffer_load_dwordx4 v60, s[56:59], s15 offen offset:0 lds
  buffer_load_dwordx4 v61, s[56:59], s15 offen offset:960 lds
  buffer_load_dwordx4 v62, s[56:59], s15 offen offset:1920 lds
  buffer_load_dwordx4 v63, s[56:59], s15 offen offset:2880 lds
  s_add_u32 m0, s12, 7680
  s_add_u32 s15, s13, 61440
  buffer_load_dwordx4 v60, s[56:59], s15 offen offset:0 lds
  buffer_load_dwordx4 v61, s[56:59], s15 offen offset:960 lds
  buffer_load_dwordx4 v62, s[56:59], s15 offen offset:1920 lds
  buffer_load_dwordx4 v63, s[56:59], s15 offen offset:2880 lds
  s_add_u32 m0, s12, 11520
  s_add_u32 s15, s13, 92160
  buffer_load_dwordx4 v60, s[56:59], s15 offen offset:0 lds
  buffer_load_dwordx4 v61, s[56:59], s15 offen offset:960 lds
  buffer_load_dwordx4 v62, s[56:59], s15 offen offset:1920 lds
  buffer_load_dwordx4 v63, s[56:59], s15 offen offset:2880 lds
  s_add_u32 m0, s12, 15360
  s_add_u32 s15, s13, 122880
  buffer_load_dwordx4 v60, s[56:59], s15 offen offset:0 lds
  buffer_load_dwordx4 v61, s[56:59], s15 offen offset:960 lds
  buffer_load_dwordx4 v62, s[56:59], s15 offen offset:1920 lds
  buffer_load_dwordx4 v63, s[56:59], s15 offen offset:2880 lds
  s_add_u32 m0, s12, 19200
  s_add_u32 s15, s13, 153600
  buffer_load_dwordx4 v60, s[56:59], s15 offen offset:0 lds
  buffer_load_dwordx4 v61, s[56:59], s15 offen offset:960 lds
  buffer_load_dwordx4 v62, s[56:59], s15 offen offset:1920 lds
  buffer_load_dwordx4 v63, s[56:59], s15 offen offset:2880 lds
  s_add_u32 m0, s12, 23040
  s_add_u32 s15, s13, 184320
  buffer_load_dwordx4 v60, s[56:59], s15 offen offset:0 lds
  buffer_load_dwordx4 v61, s[56:59], s15 offen offset:960 lds
  s_mov_b64 exec, s[68:69]
  buffer_load_dwordx4 v62, s[56:59], s15 offen offset:1920 lds
  s_mov_b32 m0, s10
  s_mov_b64 exec, 1
  buffer_load_dword v7, s[48:51], 0 offen lds
  s_mov_b64 exec, -1
k_nw12:
  s_mul_i32 s20, s8, 80
  s_add_u32 s20, s20, 90112
  v_mov_b32 v10, v1
  v_min_u32 v10, 104, v10
  v_mul_u32_u24 v8, 205, v10
  v_lshrrev_b32 v8, 10, v8
  v_min_u32 v8, 22, v8
  v_mul_u32_u24 v9, 5, v8
  v_sub_u32 v9, v10, v9
  v_min_u32 v9, 4, v9
  v_mul_u32_u24 v74, 544, v8
  v_lshl_add_u32 v74, v9, 4, v74
  v_add_u32 v74, s20, v74
  v_add_u32 v10, 64, v1
  v_min_u32 v10, 104, v10
  v_mul_u32_u24 v8, 205, v10
  v_lshrrev_b32 v8, 10, v8
  v_min_u32 v8, 22, v8
  v_mul_u32_u24 v9, 5, v8
  v_sub_u32 v9, v10, v9
  v_min_u32 v9, 4, v9
  v_mul_u32_u24 v75, 544, v8
  v_lshl_add_u32 v75, v9, 4, v75
  v_add_u32 v75, s20, v75
  v_lshrrev_b32 v10, 1, v2
  v_lshl_add_u32 v10, v10, 4, v3
  v_add_u32 v10, 0, v10
  v_mul_u32_u24 v8, 205, v10
  v_lshrrev_b32 v8, 10, v8
  v_min_u32 v8, 22, v8
  v_mul_u32_u24 v9, 5, v8
  v_sub_u32 v9, v10, v9
  v_min_u32 v9, 4, v9
  v_mul_u32_u24 v70, 544, v8
  v_lshl_add_u32 v70, v9, 4, v70
  v_add_u32 v70, s20, v70
  v_and_b32 v10, 1, v2
  v_lshl_add_u32 v70, v10, 3, v70
  v_lshrrev_b32 v10, 1, v2
  v_lshl_add_u32 v10, v10, 4, v3
  v_add_u32 v10, 32, v10
  v_mul_u32_u24 v8, 205, v10
  v_lshrrev_b32 v8, 10, v8
  v_min_u32 v8, 22, v8
  v_mul_u32_u24 v9, 5, v8
  v_sub_u32 v9, v10, v9
  v_min_u32 v9, 4, v9
  v_mul_u32_u24 v71, 544, v8
  v_lshl_add_u32 v71, v9, 4, v71
  v_add_u32 v71, s20, v71
  v_and_b32 v10, 1, v2
  v_lshl_add_u32 v71, v10, 3, v71
  v_lshrrev_b32 v10, 1, v2
  v_lshl_add_u32 v10, v10, 4, v3
  v_add_u32 v10, 64, v10
  v_mul_u32_u24 v8, 205, v10
  v_lshrrev_b32 v8, 10, v8
  v_min_u32 v8, 22, v8
  v_mul_u32_u24 v9, 5, v8
  v_sub_u32 v9, v10, v9
  v_min_u32 v9, 4, v9
  v_mul_u32_u24 v72, 544, v8
  v_lshl_add_u32 v72, v9, 4, v72
  v_add_u32 v72, s20, v72
  v_and_b32 v10, 1, v2
  v_lshl_add_u32 v72, v10, 3, v72
  v_lshrrev_b32 v10, 1, v2
  v_lshl_add_u32 v10, v10, 4, v3
  v_add_u32 v10, 96, v10
  v_mul_u32_u24 v8, 205, v10
  v_lshrrev_b32 v8, 10, v8
  v_min_u32 v8, 22, v8
  v_mul_u32_u24 v9, 5, v8
  v_sub_u32 v9, v10, v9
  v_min_u32 v9, 4, v9
  v_mul_u32_u24 v73, 544, v8
  v_lshl_add_u32 v73, v9, 4, v73
  v_add_u32 v73, s20, v73
  v_and_b32 v10, 1, v2
  v_lshl_add_u32 v73, v10, 3, v73
  v_and_b32 v8, 1, v3
  v_mov_b32 v9, 0x3f80
  v_mov_b32 v10, 0x3f800000
  v_cmp_eq_u32 vcc, 1, v8
  s_nop 1
  v_cndmask_b32 v9, v9, v10, vcc
  v_lshrrev_b32 v8, 1, v3
  v_lshl_add_u32 v10, v2, 2, 0
  v_cmp_eq_u32 vcc, v10, v8
  s_nop 1
  v_cndmask_b32 v240, v15, v9, vcc
  v_lshl_add_u32 v10, v2, 2, 1
  v_cmp_eq_u32 vcc, v10, v8
  s_nop 1
  v_cndmask_b32 v241, v15, v9, vcc
  v_lshl_add_u32 v10, v2, 2, 2
  v_cmp_eq_u32 vcc, v10, v8
  s_nop 1
  v_cndmask_b32 v242, v15, v9, vcc
  v_lshl_add_u32 v10, v2, 2, 3
  v_cmp_eq_u32 vcc, v10, v8
  s_nop 1
  v_cndmask_b32 v243, v15, v9, vcc
  v_lshl_add_u32 v10, v2, 2, -8
  v_cmp_eq_u32 vcc, v10, v8
  s_nop 1
  v_cndmask_b32 v244, v15, v9, vcc
  v_lshl_add_u32 v10, v2, 2, -7
  v_cmp_eq_u32 vcc, v10, v8
  s_nop 1
  v_cndmask_b32 v245, v15, v9, vcc
  v_lshl_add_u32 v10, v2, 2, -6
  v_cmp_eq_u32 vcc, v10, v8
  s_nop 1
  v_cndmask_b32 v246, v15, v9, vcc
  v_lshl_add_u32 v10, v2, 2, -5
  v_cmp_eq_u32 vcc, v10, v8
  s_nop 1
  v_cndmask_b32 v247, v15, v9, vcc
  s_lshl_b32 s18, s7, 2
  s_add_u32 s18, s18, s8
  s_lshl_b32 s17, s18, 15
  s_add_u32 s17, s17, 8388608
  s_lshl_b32 s18, s18, 8
  s_add_u32 s18, s18, 9469952
  v_lshrrev_b32 v8, 2, v3
  v_and_b32 v9, 3, v3
  v_mul_u32_u24 v10, 80, v2
  v_add_u32 v10, 90112, v10
  v_mul_u32_u24 v11, 544, v9
  v_add_u32 v11, v11, v10
  v_add_u32 v10, 10880, v10
  v_mov_b32 v12, 162944
  v_cmp_eq_u32 vcc, v8, v2
  s_nop 1
  v_cndmask_b32 v69, v12, v10, vcc
  v_cndmask_b32 v64, v12, v11, vcc
  v_add_u32 v11, 2176, v11
  v_cndmask_b32 v65, v12, v11, vcc
  v_add_u32 v11, 2176, v11
  v_cndmask_b32 v66, v12, v11, vcc
  v_add_u32 v11, 2176, v11
  v_cndmask_b32 v67, v12, v11, vcc
  v_add_u32 v11, 2176, v11
  v_cndmask_b32 v68, v12, v11, vcc
  v_cvt_pk_bf16_f32 v40, v132, v133
  v_cvt_pk_bf16_f32 v41, v134, v135
  v_cvt_pk_bf16_f32 v42, v140, v141
  v_cvt_pk_bf16_f32 v43, v142, v143
  v_cvt_pk_bf16_f32 v44, v148, v149
  v_cvt_pk_bf16_f32 v45, v150, v151
  v_cvt_pk_bf16_f32 v46, v156, v157
  v_cvt_pk_bf16_f32 v47, v158, v159
  v_cvt_pk_bf16_f32 v48, v164, v165
  v_cvt_pk_bf16_f32 v49, v166, v167
  v_cvt_pk_bf16_f32 v50, v128, v129
  v_cvt_pk_bf16_f32 v51, v130, v131
  v_cvt_pk_bf16_f32 v52, v136, v137
  v_cvt_pk_bf16_f32 v53, v138, v139
  v_cvt_pk_bf16_f32 v54, v144, v145
  v_cvt_pk_bf16_f32 v55, v146, v147
  v_cvt_pk_bf16_f32 v56, v152, v153
  v_cvt_pk_bf16_f32 v57, v154, v155
  v_cvt_pk_bf16_f32 v58, v160, v161
  v_cvt_pk_bf16_f32 v59, v162, v163
  s_mov_b32 s14, 0
lw_41:
  ds_read_b32 v248, v14 offset:48
  s_waitcnt lgkmcnt(0)
  v_readfirstlane_b32 s9, v248
  s_nop 0
  s_cmp_ge_u32 s9, 1
  s_cbranch_scc1 lwok_42
  s_sleep 1
  s_add_u32 s14, s14, 1
  s_cmp_lt_u32 s14, 1048576
  s_cbranch_scc1 lw_41
lwok_42:
  ds_write_b128 v13, v[40:43] offset:0
  ds_write_b128 v13, v[44:47] offset:1024
  ds_write_b128 v13, v[48:51] offset:2048
  v_mov_b32 v12, 2
  ds_write_b32 v14, v12 offset:64
  s_mov_b32 s78, 1
  v_mfma_f32_16x16x16_bf16 v[16:19], v[84:85], v[58:59], 0
  v_mfma_f32_16x16x16_bf16 v[20:23], v[94:95], v[58:59], 0
  v_mfma_f32_16x16x16_bf16 v[24:27], v[104:105], v[58:59], 0
  v_mfma_f32_16x16x16_bf16 v[28:31], v[114:115], v[58:59], 0
  v_mfma_f32_16x16x16_bf16 v[32:35], v[124:125], v[58:59], 0
  s_nop 1
  v_mfma_f32_16x16x32_bf16 v[16:19], v[76:79], v[50:53], v[16:19]
  v_mfma_f32_16x16x32_bf16 v[20:23], v[86:89], v[50:53], v[20:23]
  v_mfma_f32_16x16x32_bf16 v[24:27], v[96:99], v[50:53], v[24:27]
  v_mfma_f32_16x16x32_bf16 v[28:31], v[106:109], v[50:53], v[28:31]
  v_mfma_f32_16x16x32_bf16 v[32:35], v[116:119], v[50:53], v[32:35]
  v_mfma_f32_16x16x32_bf16 v[16:19], v[80:83], v[54:57], v[16:19]
  v_mfma_f32_16x16x32_bf16 v[20:23], v[90:93], v[54:57], v[20:23]
  v_mfma_f32_16x16x32_bf16 v[24:27], v[100:103], v[54:57], v[24:27]
  v_mfma_f32_16x16x32_bf16 v[28:31], v[110:113], v[54:57], v[28:31]
  v_mfma_f32_16x16x32_bf16 v[32:35], v[120:123], v[54:57], v[32:35]
  v_subrev_u32 v10, 16, v14
  v_lshlrev_b32 v8, 4, v1
  s_lshl_b32 s13, 1, s6
  s_mov_b32 s19, 0
  s_mov_b32 s14, 0
lw_43:
  ds_read_b128 v[248:251], v0 offset:48
  ds_read_b128 v[252:255], v0 offset:64
  s_waitcnt lgkmcnt(0)
  v_min3_u32 v248, v248, v249, v250
  v_min3_u32 v251, v251, v252, v253
  v_min3_u32 v248, v248, v254, v255
  v_min_u32 v248, v248, v251
  s_nop 0
  v_readfirstlane_b32 s9, v248
  s_nop 0
  s_cmp_ge_u32 s9, 1
  s_cbranch_scc1 lwok_44
  s_sleep 1
  s_add_u32 s14, s14, 1
  s_cmp_lt_u32 s14, 1048576
  s_cbranch_scc1 lw_43
lwok_44:
  s_load_dword s11, s[34:35], s18 glc
  s_mov_b32 s14, 0
lw_45:
  ds_read_b32 v248, v10 offset:0
  s_waitcnt lgkmcnt(0)
  v_readfirstlane_b32 s9, v248
  s_nop 0
  s_cmp_ge_u32 s9, 1
  s_cbranch_scc1 lwok_46
  s_add_u32 s14, s14, 1
  s_cmp_lt_u32 s14, 1048576
  s_cbranch_scc1 lw_45
lwok_46:
  ds_read_b128 v[232:235], v74
  ds_read_b128 v[236:239], v75
  s_mov_b32 s14, 0
k_g_top:
  s_and_b32 s11, s11, 0xffff
  s_andn2_b32 s12, s11, s13
  s_cbranch_scc1 k_g_go
  s_mov_b32 s10, 0
  s_cmp_eq_u32 s19, 0
  s_cbranch_scc1 k_g_pl
  s_sleep 1
  s_load_dword s11, s[34:35], s18 glc
  s_waitcnt lgkmcnt(0)
  s_add_u32 s14, s14, 1
  s_cmp_lt_u32 s14, 65536
  s_cbranch_scc1 k_g_top
  s_branch k_g_done
k_g_go:
  s_or_b32 s13, s13, s12
  s_bcnt1_i32_b32 s10, s12
  s_cmp_eq_u32 s10, 1
  s_cbranch_scc1 k_gi14
  s_cmp_eq_u32 s10, 2
  s_cbranch_scc1 k_gi13
  s_cmp_eq_u32 s10, 3
  s_cbranch_scc1 k_gi12
  s_cmp_eq_u32 s10, 4
  s_cbranch_scc1 k_gi11
  s_cmp_eq_u32 s10, 5
  s_cbranch_scc1 k_gi10
  s_cmp_eq_u32 s10, 6
  s_cbranch_scc1 k_gi9
  s_cmp_eq_u32 s10, 7
  s_cbranch_scc1 k_gi8
  s_cmp_eq_u32 s10, 8
  s_cbranch_scc1 k_gi7
  s_cmp_eq_u32 s10, 9
  s_cbranch_scc1 k_gi6
  s_cmp_eq_u32 s10, 10
  s_cbranch_scc1 k_gi5
  s_cmp_eq_u32 s10, 11
  s_cbranch_scc1 k_gi4
  s_cmp_eq_u32 s10, 12
  s_cbranch_scc1 k_gi3
  s_cmp_eq_u32 s10, 13
  s_cbranch_scc1 k_gi2
  s_cmp_eq_u32 s10, 14
  s_cbranch_scc1 k_gi1
k_gi0:
  s_ff1_i32_b32 s9, s12
  s_bitset0_b32 s12, s9
  s_lshl_b32 s9, s9, 11
  s_add_u32 s9, s9, s17
  buffer_load_dwordx4 v[112:115], v8, s[44:47], s9 offen sc1
  buffer_load_dwordx4 v[116:119], v8, s[44:47], s9 offen offset:1024 sc1
k_gi1:
  s_ff1_i32_b32 s9, s12
  s_bitset0_b32 s12, s9
  s_lshl_b32 s9, s9, 11
  s_add_u32 s9, s9, s17
  buffer_load_dwordx4 v[120:123], v8, s[44:47], s9 offen sc1
  buffer_load_dwordx4 v[124:127], v8, s[44:47], s9 offen offset:1024 sc1
k_gi2:
  s_ff1_i32_b32 s9, s12
  s_bitset0_b32 s12, s9
  s_lshl_b32 s9, s9, 11
  s_add_u32 s9, s9, s17
  buffer_load_dwordx4 v[128:131], v8, s[44:47], s9 offen sc1
  buffer_load_dwordx4 v[132:135], v8, s[44:47], s9 offen offset:1024 sc1
k_gi3:
  s_ff1_i32_b32 s9, s12
  s_bitset0_b32 s12, s9
  s_lshl_b32 s9, s9, 11
  s_add_u32 s9, s9, s17
  buffer_load_dwordx4 v[136:139], v8, s[44:47], s9 offen sc1
  buffer_load_dwordx4 v[140:143], v8, s[44:47], s9 offen offset:1024 sc1
k_gi4:
  s_ff1_i32_b32 s9, s12
  s_bitset0_b32 s12, s9
  s_lshl_b32 s9, s9, 11
  s_add_u32 s9, s9, s17
  buffer_load_dwordx4 v[144:147], v8, s[44:47], s9 offen sc1
  buffer_load_dwordx4 v[148:151], v8, s[44:47], s9 offen offset:1024 sc1
k_gi5:
  s_ff1_i32_b32 s9, s12
  s_bitset0_b32 s12, s9
  s_lshl_b32 s9, s9, 11
  s_add_u32 s9, s9, s17
  buffer_load_dwordx4 v[152:155], v8, s[44:47], s9 offen sc1
  buffer_load_dwordx4 v[156:159], v8, s[44:47], s9 offen offset:1024 sc1
k_gi6:
  s_ff1_i32_b32 s9, s12
  s_bitset0_b32 s12, s9
  s_lshl_b32 s9, s9, 11
  s_add_u32 s9, s9, s17
  buffer_load_dwordx4 v[160:163], v8, s[44:47], s9 offen sc1
  buffer_load_dwordx4 v[164:167], v8, s[44:47], s9 offen offset:1024 sc1
k_gi7:
  s_ff1_i32_b32 s9, s12
  s_bitset0_b32 s12, s9
  s_lshl_b32 s9, s9, 11
  s_add_u32 s9, s9, s17
  buffer_load_dwordx4 v[168:171], v8, s[44:47], s9 offen sc1
  buffer_load_dwordx4 v[172:175], v8, s[44:47], s9 offen offset:1024 sc1
k_gi8:
  s_ff1_i32_b32 s9, s12
  s_bitset0_b32 s12, s9
  s_lshl_b32 s9, s9, 11
  s_add_u32 s9, s9, s17
  buffer_load_dwordx4 v[176:179], v8, s[44:47], s9 offen sc1
  buffer_load_dwordx4 v[180:183], v8, s[44:47], s9 offen offset:1024 sc1
k_gi9:
  s_ff1_i32_b32 s9, s12
  s_bitset0_b32 s12, s9
  s_lshl_b32 s9, s9, 11
  s_add_u32 s9, s9, s17
  buffer_load_dwordx4 v[184:187], v8, s[44:47], s9 offen sc1
  buffer_load_dwordx4 v[188:191], v8, s[44:47], s9 offen offset:1024 sc1
k_gi10:
  s_ff1_i32_b32 s9, s12
  s_bitset0_b32 s12, s9
  s_lshl_b32 s9, s9, 11
  s_add_u32 s9, s9, s17
  buffer_load_dwordx4 v[192:195], v8, s[44:47], s9 offen sc1
  buffer_load_dwordx4 v[196:199], v8, s[44:47], s9 offen offset:1024 sc1
k_gi11:
  s_ff1_i32_b32 s9, s12
  s_bitset0_b32 s12, s9
  s_lshl_b32 s9, s9, 11
  s_add_u32 s9, s9, s17
  buffer_load_dwordx4 v[200:203], v8, s[44:47], s9 offen sc1
  buffer_load_dwordx4 v[204:207], v8, s[44:47], s9 offen offset:1024 sc1
k_gi12:
  s_ff1_i32_b32 s9, s12
  s_bitset0_b32 s12, s9
  s_lshl_b32 s9, s9, 11
  s_add_u32 s9, s9, s17
  buffer_load_dwordx4 v[208:211], v8, s[44:47], s9 offen sc1
  buffer_load_dwordx4 v[212:215], v8, s[44:47], s9 offen offset:1024 sc1
k_gi13:
  s_ff1_i32_b32 s9, s12
  s_bitset0_b32 s12, s9
  s_lshl_b32 s9, s9, 11
  s_add_u32 s9, s9, s17
  buffer_load_dwordx4 v[216:219], v8, s[44:47], s9 offen sc1
  buffer_load_dwordx4 v[220:223], v8, s[44:47], s9 offen offset:1024 sc1
k_gi14:
  s_ff1_i32_b32 s9, s12
  s_bitset0_b32 s12, s9
  s_lshl_b32 s9, s9, 11
  s_add_u32 s9, s9, s17
  buffer_load_dwordx4 v[224:227], v8, s[44:47], s9 offen sc1
  buffer_load_dwordx4 v[228:231], v8, s[44:47], s9 offen offset:1024 sc1
k_g_pl:
  s_cmp_eq_u32 s19, 0
  s_cbranch_scc0 k_g_nsm
  s_waitcnt lgkmcnt(0)
  v_mfma_f32_16x16x32_bf16 v[96:99], v[240:243], v[232:235], 0
  v_mfma_f32_16x16x32_bf16 v[100:103], v[244:247], v[232:235], 0
  v_mfma_f32_16x16x32_bf16 v[104:107], v[240:243], v[236:239], 0
  v_mfma_f32_16x16x32_bf16 v[108:111], v[244:247], v[236:239], 0
  v_max3_f32 v248, v16, v17, v18
  v_min3_f32 v250, v16, v17, v18
  v_max3_f32 v249, v19, v20, v21
  v_min3_f32 v251, v19, v20, v21
  v_max3_f32 v248, v248, v22, v23
  v_min3_f32 v250, v250, v22, v23
  v_max3_f32 v249, v249, v24, v25
  v_min3_f32 v251, v251, v24, v25
  v_max3_f32 v248, v248, v26, v27
  v_min3_f32 v250, v250, v26, v27
  v_max3_f32 v249, v249, v28, v29
  v_min3_f32 v251, v251, v28, v29
  v_max3_f32 v248, v248, v30, v31
  v_min3_f32 v250, v250, v30, v31
  v_max3_f32 v249, v249, v32, v33
  v_min3_f32 v251, v251, v32, v33
  v_max3_f32 v248, v248, v34, v35
  v_min3_f32 v250, v250, v34, v35
  v_max_f32 v248, v248, v249
  v_min_f32 v250, v250, v251
  v_mul_f32 v248, s64, v248
  v_mul_f32 v250, s64, v250
  v_pk_fma_f32 v[40:41], v[16:17], s[64:65], v[250:251] op_sel_hi:[1,1,0] neg_lo:[1,0,0] neg_hi:[1,0,0]
  v_pk_fma_f32 v[16:17], v[16:17], s[64:65], v[248:249] op_sel_hi:[1,1,0] neg_lo:[0,0,1] neg_hi:[0,0,1]
  v_pk_fma_f32 v[42:43], v[18:19], s[64:65], v[250:251] op_sel_hi:[1,1,0] neg_lo:[1,0,0] neg_hi:[1,0,0]
  v_pk_fma_f32 v[18:19], v[18:19], s[64:65], v[248:249] op_sel_hi:[1,1,0] neg_lo:[0,0,1] neg_hi:[0,0,1]
  v_pk_fma_f32 v[44:45], v[20:21], s[64:65], v[250:251] op_sel_hi:[1,1,0] neg_lo:[1,0,0] neg_hi:[1,0,0]
  v_pk_fma_f32 v[20:21], v[20:21], s[64:65], v[248:249] op_sel_hi:[1,1,0] neg_lo:[0,0,1] neg_hi:[0,0,1]
  v_pk_fma_f32 v[46:47], v[22:23], s[64:65], v[250:251] op_sel_hi:[1,1,0] neg_lo:[1,0,0] neg_hi:[1,0,0]
  v_pk_fma_f32 v[22:23], v[22:23], s[64:65], v[248:249] op_sel_hi:[1,1,0] neg_lo:[0,0,1] neg_hi:[0,0,1]
  v_pk_fma_f32 v[48:49], v[24:25], s[64:65], v[250:251] op_sel_hi:[1,1,0] neg_lo:[1,0,0] neg_hi:[1,0,0]
  v_pk_fma_f32 v[24:25], v[24:25], s[64:65], v[248:249] op_sel_hi:[1,1,0] neg_lo:[0,0,1] neg_hi:[0,0,1]
  v_pk_fma_f32 v[50:51], v[26:27], s[64:65], v[250:251] op_sel_hi:[1,1,0] neg_lo:[1,0,0] neg_hi:[1,0,0]
  v_pk_fma_f32 v[26:27], v[26:27], s[64:65], v[248:249] op_sel_hi:[1,1,0] neg_lo:[0,0,1] neg_hi:[0,0,1]
  v_pk_fma_f32 v[52:53], v[28:29], s[64:65], v[250:251] op_sel_hi:[1,1,0] neg_lo:[1,0,0] neg_hi:[1,0,0]
  v_pk_fma_f32 v[28:29], v[28:29], s[64:65], v[248:249] op_sel_hi:[1,1,0] neg_lo:[0,0,1] neg_hi:[0,0,1]
  v_pk_fma_f32 v[54:55], v[30:31], s[64:65], v[250:251] op_sel_hi:[1,1,0] neg_lo:[1,0,0] neg_hi:[1,0,0]
  v_pk_fma_f32 v[30:31], v[30:31], s[64:65], v[248:249] op_sel_hi:[1,1,0] neg_lo:[0,0,1] neg_hi:[0,0,1]
  v_pk_fma_f32 v[56:57], v[32:33], s[64:65], v[250:251] op_sel_hi:[1,1,0] neg_lo:[1,0,0] neg_hi:[1,0,0]
  v_pk_fma_f32 v[32:33], v[32:33], s[64:65], v[248:249] op_sel_hi:[1,1,0] neg_lo:[0,0,1] neg_hi:[0,0,1]
  v_pk_fma_f32 v[58:59], v[34:35], s[64:65], v[250:251] op_sel_hi:[1,1,0] neg_lo:[1,0,0] neg_hi:[1,0,0]
  v_pk_fma_f32 v[34:35], v[34:35], s[64:65], v[248:249] op_sel_hi:[1,1,0] neg_lo:[0,0,1] neg_hi:[0,0,1]
  v_exp_f32 v16, v16
  v_exp_f32 v17, v17
  v_exp_f32 v18, v18
  v_exp_f32 v19, v19
  v_exp_f32 v20, v20
  v_exp_f32 v21, v21
  v_exp_f32 v22, v22
  v_exp_f32 v23, v23
  v_exp_f32 v24, v24
  v_exp_f32 v25, v25
  v_exp_f32 v26, v26
  v_exp_f32 v27, v27
  v_exp_f32 v28, v28
  v_exp_f32 v29, v29
  v_exp_f32 v30, v30
  v_exp_f32 v31, v31
  v_exp_f32 v32, v32
  v_exp_f32 v33, v33
  v_exp_f32 v34, v34
  v_exp_f32 v35, v35
  v_exp_f32 v40, v40
  v_pk_add_f32 v[248:249], v[16:17], v[18:19]
  v_exp_f32 v41, v41
  v_pk_add_f32 v[248:249], v[248:249], v[20:21]
  v_exp_f32 v42, v42
  v_pk_add_f32 v[248:249], v[248:249], v[22:23]
  v_exp_f32 v43, v43
  v_pk_add_f32 v[248:249], v[248:249], v[24:25]
  v_exp_f32 v44, v44
  v_pk_add_f32 v[248:249], v[248:249], v[26:27]
  s_load_dword s11, s[34:35], s18 glc
  v_exp_f32 v45, v45
  v_pk_add_f32 v[248:249], v[248:249], v[28:29]
  v_exp_f32 v46, v46
  v_pk_add_f32 v[248:249], v[248:249], v[30:31]
  v_exp_f32 v47, v47
  v_pk_add_f32 v[248:249], v[248:249], v[32:33]
  v_exp_f32 v48, v48
  v_pk_add_f32 v[248:249], v[248:249], v[34:35]
  v_exp_f32 v49, v49
  v_add_f32 v248, v248, v249
  v_exp_f32 v50, v50
  v_rcp_f32 v248, v248
  v_exp_f32 v51, v51
  v_exp_f32 v52, v52
  v_exp_f32 v53, v53
  v_exp_f32 v54, v54
  v_exp_f32 v55, v55
  v_exp_f32 v56, v56
  v_exp_f32 v57, v57
  v_exp_f32 v58, v58
  v_exp_f32 v59, v59
  v_pk_add_f32 v[250:251], v[40:41], v[42:43]
  v_pk_mul_f32 v[16:17], v[16:17], v[248:249] op_sel_hi:[1,0]
  v_pk_add_f32 v[250:251], v[250:251], v[44:45]
  v_pk_mul_f32 v[18:19], v[18:19], v[248:249] op_sel_hi:[1,0]
  v_pk_add_f32 v[250:251], v[250:251], v[46:47]
  v_pk_mul_f32 v[20:21], v[20:21], v[248:249] op_sel_hi:[1,0]
  v_pk_add_f32 v[250:251], v[250:251], v[48:49]
  v_pk_mul_f32 v[22:23], v[22:23], v[248:249] op_sel_hi:[1,0]
  v_pk_add_f32 v[250:251], v[250:251], v[50:51]
  v_pk_mul_f32 v[24:25], v[24:25], v[248:249] op_sel_hi:[1,0]
  v_pk_add_f32 v[250:251], v[250:251], v[52:53]
  v_pk_mul_f32 v[26:27], v[26:27], v[248:249] op_sel_hi:[1,0]
  v_pk_add_f32 v[250:251], v[250:251], v[54:55]
  v_pk_mul_f32 v[28:29], v[28:29], v[248:249] op_sel_hi:[1,0]
  v_pk_add_f32 v[250:251], v[250:251], v[56:57]
  v_pk_mul_f32 v[30:31], v[30:31], v[248:249] op_sel_hi:[1,0]
  v_pk_add_f32 v[250:251], v[250:251], v[58:59]
  v_pk_mul_f32 v[32:33], v[32:33], v[248:249] op_sel_hi:[1,0]
  v_add_f32 v250, v250, v251
  v_pk_mul_f32 v[34:35], v[34:35], v[248:249] op_sel_hi:[1,0]
  v_rcp_f32 v250, v250
  v_cvt_pk_bf16_f32 v76, v16, v17
  v_cvt_pk_bf16_f32 v77, v18, v19
  v_cvt_pk_bf16_f32 v78, v20, v21
  v_cvt_pk_bf16_f32 v79, v22, v23
  v_cvt_pk_bf16_f32 v80, v24, v25
  v_cvt_pk_bf16_f32 v81, v26, v27
  v_cvt_pk_bf16_f32 v82, v28, v29
  v_cvt_pk_bf16_f32 v83, v30, v31
  v_cvt_pk_bf16_f32 v84, v32, v33
  v_cvt_pk_bf16_f32 v85, v34, v35
  v_pk_mul_f32 v[40:41], v[40:41], v[250:251] op_sel_hi:[1,0]
  v_pk_mul_f32 v[42:43], v[42:43], v[250:251] op_sel_hi:[1,0]
  v_pk_mul_f32 v[44:45], v[44:45], v[250:251] op_sel_hi:[1,0]
  v_pk_mul_f32 v[46:47], v[46:47], v[250:251] op_sel_hi:[1,0]
  v_pk_mul_f32 v[48:49], v[48:49], v[250:251] op_sel_hi:[1,0]
  v_pk_mul_f32 v[50:51], v[50:51], v[250:251] op_sel_hi:[1,0]
  v_pk_mul_f32 v[52:53], v[52:53], v[250:251] op_sel_hi:[1,0]
  v_pk_mul_f32 v[54:55], v[54:55], v[250:251] op_sel_hi:[1,0]
  v_pk_mul_f32 v[56:57], v[56:57], v[250:251] op_sel_hi:[1,0]
  v_pk_mul_f32 v[58:59], v[58:59], v[250:251] op_sel_hi:[1,0]
  v_cvt_pk_bf16_f32 v86, v40, v41
  v_cvt_pk_bf16_f32 v87, v42, v43
  v_cvt_pk_bf16_f32 v88, v44, v45
  v_cvt_pk_bf16_f32 v89, v46, v47
  v_cvt_pk_bf16_f32 v90, v48, v49
  v_cvt_pk_bf16_f32 v91, v50, v51
  v_cvt_pk_bf16_f32 v92, v52, v53
  v_cvt_pk_bf16_f32 v93, v54, v55
  v_cvt_pk_bf16_f32 v94, v56, v57
  v_cvt_pk_bf16_f32 v95, v58, v59
  s_mov_b32 s19, 1
  s_branch k_g_lad
k_g_nsm:
  s_load_dword s11, s[34:35], s18 glc
k_g_lad:
  s_cmp_eq_u32 s10, 0
  s_cbranch_scc1 k_g_end
  s_cmp_eq_u32 s10, 1
  s_cbranch_scc1 k_gm14
  s_cmp_eq_u32 s10, 2
  s_cbranch_scc1 k_gm13
  s_cmp_eq_u32 s10, 3
  s_cbranch_scc1 k_gm12
  s_cmp_eq_u32 s10, 4
  s_cbranch_scc1 k_gm11
  s_cmp_eq_u32 s10, 5
  s_cbranch_scc1 k_gm10
  s_cmp_eq_u32 s10, 6
  s_cbranch_scc1 k_gm9
  s_cmp_eq_u32 s10, 7
  s_cbranch_scc1 k_gm8
  s_cmp_eq_u32 s10, 8
  s_cbranch_scc1 k_gm7
  s_cmp_eq_u32 s10, 9
  s_cbranch_scc1 k_gm6
  s_cmp_eq_u32 s10, 10
  s_cbranch_scc1 k_gm5
  s_cmp_eq_u32 s10, 11
  s_cbranch_scc1 k_gm4
  s_cmp_eq_u32 s10, 12
  s_cbranch_scc1 k_gm3
  s_cmp_eq_u32 s10, 13
  s_cbranch_scc1 k_gm2
  s_cmp_eq_u32 s10, 14
  s_cbranch_scc1 k_gm1
k_gm0:
  s_waitcnt vmcnt(28)
  v_mfma_f32_16x16x32_bf16 v[96:99], v[240:243], v[112:115], v[96:99]
  v_mfma_f32_16x16x32_bf16 v[100:103], v[244:247], v[112:115], v[100:103]
  v_mfma_f32_16x16x32_bf16 v[104:107], v[240:243], v[116:119], v[104:107]
  v_mfma_f32_16x16x32_bf16 v[108:111], v[244:247], v[116:119], v[108:111]
k_gm1:
  s_waitcnt vmcnt(26)
  v_mfma_f32_16x16x32_bf16 v[96:99], v[240:243], v[120:123], v[96:99]
  v_mfma_f32_16x16x32_bf16 v[100:103], v[244:247], v[120:123], v[100:103]
  v_mfma_f32_16x16x32_bf16 v[104:107], v[240:243], v[124:127], v[104:107]
  v_mfma_f32_16x16x32_bf16 v[108:111], v[244:247], v[124:127], v[108:111]
k_gm2:
  s_waitcnt vmcnt(24)
  v_mfma_f32_16x16x32_bf16 v[96:99], v[240:243], v[128:131], v[96:99]
  v_mfma_f32_16x16x32_bf16 v[100:103], v[244:247], v[128:131], v[100:103]
  v_mfma_f32_16x16x32_bf16 v[104:107], v[240:243], v[132:135], v[104:107]
  v_mfma_f32_16x16x32_bf16 v[108:111], v[244:247], v[132:135], v[108:111]
k_gm3:
  s_waitcnt vmcnt(22)
  v_mfma_f32_16x16x32_bf16 v[96:99], v[240:243], v[136:139], v[96:99]
  v_mfma_f32_16x16x32_bf16 v[100:103], v[244:247], v[136:139], v[100:103]
  v_mfma_f32_16x16x32_bf16 v[104:107], v[240:243], v[140:143], v[104:107]
  v_mfma_f32_16x16x32_bf16 v[108:111], v[244:247], v[140:143], v[108:111]
k_gm4:
  s_waitcnt vmcnt(20)
  v_mfma_f32_16x16x32_bf16 v[96:99], v[240:243], v[144:147], v[96:99]
  v_mfma_f32_16x16x32_bf16 v[100:103], v[244:247], v[144:147], v[100:103]
  v_mfma_f32_16x16x32_bf16 v[104:107], v[240:243], v[148:151], v[104:107]
  v_mfma_f32_16x16x32_bf16 v[108:111], v[244:247], v[148:151], v[108:111]
k_gm5:
  s_waitcnt vmcnt(18)
  v_mfma_f32_16x16x32_bf16 v[96:99], v[240:243], v[152:155], v[96:99]
  v_mfma_f32_16x16x32_bf16 v[100:103], v[244:247], v[152:155], v[100:103]
  v_mfma_f32_16x16x32_bf16 v[104:107], v[240:243], v[156:159], v[104:107]
  v_mfma_f32_16x16x32_bf16 v[108:111], v[244:247], v[156:159], v[108:111]
k_gm6:
  s_waitcnt vmcnt(16)
  v_mfma_f32_16x16x32_bf16 v[96:99], v[240:243], v[160:163], v[96:99]
  v_mfma_f32_16x16x32_bf16 v[100:103], v[244:247], v[160:163], v[100:103]
  v_mfma_f32_16x16x32_bf16 v[104:107], v[240:243], v[164:167], v[104:107]
  v_mfma_f32_16x16x32_bf16 v[108:111], v[244:247], v[164:167], v[108:111]
k_gm7:
  s_waitcnt vmcnt(14)
  v_mfma_f32_16x16x32_bf16 v[96:99], v[240:243], v[168:171], v[96:99]
  v_mfma_f32_16x16x32_bf16 v[100:103], v[244:247], v[168:171], v[100:103]
  v_mfma_f32_16x16x32_bf16 v[104:107], v[240:243], v[172:175], v[104:107]
  v_mfma_f32_16x16x32_bf16 v[108:111], v[244:247], v[172:175], v[108:111]
k_gm8:
  s_waitcnt vmcnt(12)
  v_mfma_f32_16x16x32_bf16 v[96:99], v[240:243], v[176:179], v[96:99]
  v_mfma_f32_16x16x32_bf16 v[100:103], v[244:247], v[176:179], v[100:103]
  v_mfma_f32_16x16x32_bf16 v[104:107], v[240:243], v[180:183], v[104:107]
  v_mfma_f32_16x16x32_bf16 v[108:111], v[244:247], v[180:183], v[108:111]
k_gm9:
  s_waitcnt vmcnt(10)
  v_mfma_f32_16x16x32_bf16 v[96:99], v[240:243], v[184:187], v[96:99]
  v_mfma_f32_16x16x32_bf16 v[100:103], v[244:247], v[184:187], v[100:103]
  v_mfma_f32_16x16x32_bf16 v[104:107], v[240:243], v[188:191], v[104:107]
  v_mfma_f32_16x16x32_bf16 v[108:111], v[244:247], v[188:191], v[108:111]
k_gm10:
  s_waitcnt vmcnt(8)
  v_mfma_f32_16x16x32_bf16 v[96:99], v[240:243], v[192:195], v[96:99]
  v_mfma_f32_16x16x32_bf16 v[100:103], v[244:247], v[192:195], v[100:103]
  v_mfma_f32_16x16x32_bf16 v[104:107], v[240:243], v[196:199], v[104:107]
  v_mfma_f32_16x16x32_bf16 v[108:111], v[244:247], v[196:199], v[108:111]
k_gm11:
  s_waitcnt vmcnt(6)
  v_mfma_f32_16x16x32_bf16 v[96:99], v[240:243], v[200:203], v[96:99]
  v_mfma_f32_16x16x32_bf16 v[100:103], v[244:247], v[200:203], v[100:103]
  v_mfma_f32_16x16x32_bf16 v[104:107], v[240:243], v[204:207], v[104:107]
  v_mfma_f32_16x16x32_bf16 v[108:111], v[244:247], v[204:207], v[108:111]
k_gm12:
  s_waitcnt vmcnt(4)
  v_mfma_f32_16x16x32_bf16 v[96:99], v[240:243], v[208:211], v[96:99]
  v_mfma_f32_16x16x32_bf16 v[100:103], v[244:247], v[208:211], v[100:103]
  v_mfma_f32_16x16x32_bf16 v[104:107], v[240:243], v[212:215], v[104:107]
  v_mfma_f32_16x16x32_bf16 v[108:111], v[244:247], v[212:215], v[108:111]
k_gm13:
  s_waitcnt vmcnt(2)
  v_mfma_f32_16x16x32_bf16 v[96:99], v[240:243], v[216:219], v[96:99]
  v_mfma_f32_16x16x32_bf16 v[100:103], v[244:247], v[216:219], v[100:103]
  v_mfma_f32_16x16x32_bf16 v[104:107], v[240:243], v[220:223], v[104:107]
  v_mfma_f32_16x16x32_bf16 v[108:111], v[244:247], v[220:223], v[108:111]
k_gm14:
  s_waitcnt vmcnt(0)
  v_mfma_f32_16x16x32_bf16 v[96:99], v[240:243], v[224:227], v[96:99]
  v_mfma_f32_16x16x32_bf16 v[100:103], v[244:247], v[224:227], v[100:103]
  v_mfma_f32_16x16x32_bf16 v[104:107], v[240:243], v[228:231], v[104:107]
  v_mfma_f32_16x16x32_bf16 v[108:111], v[244:247], v[228:231], v[108:111]
k_g_end:
  s_cmp_eq_u32 s13, 0xffff
  s_cbranch_scc1 k_g_done
  s_waitcnt lgkmcnt(0)
  s_branch k_g_top
k_g_done:
  s_nop 7
  v_cvt_pk_bf16_f32 v112, v96, v97
  v_cvt_pk_bf16_f32 v113, v98, v99
  v_cvt_pk_bf16_f32 v114, v100, v101
  v_cvt_pk_bf16_f32 v115, v102, v103
  v_cvt_pk_bf16_f32 v116, v104, v105
  v_cvt_pk_bf16_f32 v117, v106, v107
  v_cvt_pk_bf16_f32 v118, v108, v109
  v_cvt_pk_bf16_f32 v119, v110, v111
  ds_write_b64 v70, v[112:113]
  ds_write_b64 v71, v[114:115]
  ds_write_b64 v72, v[116:117]
  ds_write_b64 v73, v[118:119]
  v_mov_b32 v12, 1
  ds_write_b32 v14, v12 offset:80
  s_cmp_eq_u32 s8, 3
  s_cbranch_scc0 k_nw3
  s_mov_b32 s14, 0
lw_47:
  ds_read_b128 v[248:251], v0 offset:112
  s_waitcnt lgkmcnt(0)
  v_min3_u32 v248, v248, v249, v250
  v_min_u32 v248, v248, v251
  s_nop 0
  v_readfirstlane_b32 s9, v248
  s_nop 0
  s_cmp_ge_u32 s9, 1
  s_cbranch_scc1 lwok_48
  s_sleep 1
  s_add_u32 s14, s14, 1
  s_cmp_lt_u32 s14, 1048576
  s_cbranch_scc1 lw_47
lwok_48:
  s_mov_b32 s12, 102624
  s_mov_b32 s10, 163820
  s_add_u32 s13, s70, 614400
  s_mov_b64 exec, s[66:67]
  s_add_u32 m0, s12, 0
  s_add_u32 s15, s13, 0
  buffer_load_dwordx4 v60, s[56:59], s15 offen offset:0 lds
  buffer_load_dwordx4 v61, s[56:59], s15 offen offset:960 lds
  buffer_load_dwordx4 v62, s[56:59], s15 offen offset:1920 lds
  buffer_load_dwordx4 v63, s[56:59], s15 offen offset:2880 lds
  s_add_u32 m0, s12, 3840
  s_add_u32 s15, s13, 30720
  buffer_load_dwordx4 v60, s[56:59], s15 offen offset:0 lds
  buffer_load_dwordx4 v61, s[56:59], s15 offen offset:960 lds
  buffer_load_dwordx4 v62, s[56:59], s15 offen offset:1920 lds
  buffer_load_dwordx4 v63, s[56:59], s15 offen offset:2880 lds
  s_add_u32 m0, s12, 7680
  s_add_u32 s15, s13, 61440
  buffer_load_dwordx4 v60, s[56:59], s15 offen offset:0 lds
  buffer_load_dwordx4 v61, s[56:59], s15 offen offset:960 lds
  buffer_load_dwordx4 v62, s[56:59], s15 offen offset:1920 lds
  buffer_load_dwordx4 v63, s[56:59], s15 offen offset:2880 lds
  s_add_u32 m0, s12, 11520
  s_add_u32 s15, s13, 92160
  buffer_load_dwordx4 v60, s[56:59], s15 offen offset:0 lds
  buffer_load_dwordx4 v61, s[56:59], s15 offen offset:960 lds
  buffer_load_dwordx4 v62, s[56:59], s15 offen offset:1920 lds
  buffer_load_dwordx4 v63, s[56:59], s15 offen offset:2880 lds
  s_add_u32 m0, s12, 15360
  s_add_u32 s15, s13, 122880
  buffer_load_dwordx4 v60, s[56:59], s15 offen offset:0 lds
  buffer_load_dwordx4 v61, s[56:59], s15 offen offset:960 lds
  buffer_load_dwordx4 v62, s[56:59], s15 offen offset:1920 lds
  buffer_load_dwordx4 v63, s[56:59], s15 offen offset:2880 lds
  s_add_u32 m0, s12, 19200
  s_add_u32 s15, s13, 153600
  buffer_load_dwordx4 v60, s[56:59], s15 offen offset:0 lds
  buffer_load_dwordx4 v61, s[56:59], s15 offen offset:960 lds
  buffer_load_dwordx4 v62, s[56:59], s15 offen offset:1920 lds
  buffer_load_dwordx4 v63, s[56:59], s15 offen offset:2880 lds
  s_add_u32 m0, s12, 23040
  s_add_u32 s15, s13, 184320
  buffer_load_dwordx4 v60, s[56:59], s15 offen offset:0 lds
  buffer_load_dwordx4 v61, s[56:59], s15 offen offset:960 lds
  s_mov_b64 exec, s[68:69]
  buffer_load_dwordx4 v62, s[56:59], s15 offen offset:1920 lds
  s_mov_b32 m0, s10
  s_mov_b64 exec, 1
  buffer_load_dword v7, s[48:51], 0 offen lds
  s_mov_b64 exec, -1
k_nw3:
  v_lshlrev_b32 v8, 4, v1
  v_lshlrev_b32 v9, 3, v1
  s_lshl_b32 s9, s6, 2
  s_add_u32 s9, s9, s8
  s_mul_i32 s9, s9, 40960
  s_mul_i32 s10, s5, 2621440
  s_add_u32 s15, s9, s10
  s_mul_i32 s10, s7, 5120
  s_add_u32 s12, s15, s10
  s_add_u32 s13, s12, 2560
  s_mov_b32 s14, 0
lw_49:
  ds_read_b128 v[248:251], v0 offset:96
  s_waitcnt lgkmcnt(0)
  v_min3_u32 v248, v248, v249, v250
  v_min_u32 v248, v248, v251
  s_nop 0
  v_readfirstlane_b32 s9, v248
  s_nop 0
  s_cmp_ge_u32 s9, 1
  s_cbranch_scc1 lwok_50
  s_sleep 1
  s_add_u32 s14, s14, 1
  s_cmp_lt_u32 s14, 1048576
  s_cbranch_scc1 lw_49
lwok_50:
  ds_read_b128 v[16:19], v69 offset:0
  ds_read_b128 v[20:23], v64 offset:0
  ds_read_b128 v[24:27], v65 offset:0
  ds_read_b128 v[28:31], v66 offset:0
  ds_read_b128 v[32:35], v67 offset:0
  ds_read_b128 v[36:39], v68 offset:0
  ds_read_b128 v[40:43], v69 offset:16
  ds_read_b128 v[44:47], v64 offset:16
  ds_read_b128 v[48:51], v65 offset:16
  ds_read_b128 v[52:55], v66 offset:16
  s_waitcnt lgkmcnt(8)
  v_mfma_f32_16x16x32_bf16 v[148:151], v[16:19], v[76:79], 0
  ds_read_b128 v[56:59], v67 offset:16
  v_mfma_f32_16x16x32_bf16 v[128:131], v[20:23], v[76:79], 0
  ds_read_b128 v[16:19], v68 offset:16
  s_waitcnt lgkmcnt(8)
  v_mfma_f32_16x16x32_bf16 v[132:135], v[24:27], v[76:79], 0
  ds_read_b128 v[20:23], v69 offset:32
  v_mfma_f32_16x16x32_bf16 v[136:139], v[28:31], v[76:79], 0
  ds_read_b128 v[24:27], v64 offset:32
  s_waitcnt lgkmcnt(8)
  v_mfma_f32_16x16x32_bf16 v[140:143], v[32:35], v[76:79], 0
  ds_read_b128 v[28:31], v65 offset:32
  v_mfma_f32_16x16x32_bf16 v[144:147], v[36:39], v[76:79], 0
  ds_read_b128 v[32:35], v66 offset:32
  s_waitcnt lgkmcnt(8)
  v_mfma_f32_16x16x32_bf16 v[148:151], v[40:43], v[80:83], v[148:151]
  ds_read_b128 v[36:39], v67 offset:32
  v_mfma_f32_16x16x32_bf16 v[128:131], v[44:47], v[80:83], v[128:131]
  ds_read_b128 v[40:43], v68 offset:32
  s_waitcnt lgkmcnt(8)
  v_mfma_f32_16x16x32_bf16 v[132:135], v[48:51], v[80:83], v[132:135]
  ds_read_b128 v[44:47], v69 offset:48
  v_mfma_f32_16x16x32_bf16 v[136:139], v[52:55], v[80:83], v[136:139]
  ds_read_b128 v[48:51], v64 offset:48
  s_waitcnt lgkmcnt(8)
  v_mfma_f32_16x16x32_bf16 v[140:143], v[56:59], v[80:83], v[140:143]
  ds_read_b128 v[52:55], v65 offset:48
  v_mfma_f32_16x16x32_bf16 v[144:147], v[16:19], v[80:83], v[144:147]
  ds_read_b128 v[56:59], v66 offset:48
  s_waitcnt lgkmcnt(8)
  v_mfma_f32_16x16x32_bf16 v[148:151], v[20:23], v[84:87], v[148:151]
  ds_read_b128 v[16:19], v67 offset:48
  v_mfma_f32_16x16x32_bf16 v[128:131], v[24:27], v[84:87], v[128:131]
  ds_read_b128 v[20:23], v68 offset:48
  s_waitcnt lgkmcnt(8)
  v_mfma_f32_16x16x32_bf16 v[132:135], v[28:31], v[84:87], v[132:135]
  ds_read_b128 v[24:27], v69 offset:64
  v_mfma_f32_16x16x32_bf16 v[136:139], v[32:35], v[84:87], v[136:139]
  ds_read_b128 v[28:31], v64 offset:64
  s_waitcnt lgkmcnt(8)
  v_mfma_f32_16x16x32_bf16 v[140:143], v[36:39], v[84:87], v[140:143]
  ds_read_b128 v[32:35], v65 offset:64
  v_mfma_f32_16x16x32_bf16 v[144:147], v[40:43], v[84:87], v[144:147]
  ds_read_b128 v[36:39], v66 offset:64
  s_waitcnt lgkmcnt(8)
  v_mfma_f32_16x16x32_bf16 v[148:151], v[44:47], v[88:91], v[148:151]
  ds_read_b128 v[40:43], v67 offset:64
  v_mfma_f32_16x16x32_bf16 v[128:131], v[48:51], v[88:91], v[128:131]
  ds_read_b128 v[44:47], v68 offset:64
  s_waitcnt lgkmcnt(8)
  v_mfma_f32_16x16x32_bf16 v[132:135], v[52:55], v[88:91], v[132:135]
  v_mfma_f32_16x16x32_bf16 v[136:139], v[56:59], v[88:91], v[136:139]
  s_waitcnt lgkmcnt(6)
  v_mfma_f32_16x16x32_bf16 v[140:143], v[16:19], v[88:91], v[140:143]
  v_mfma_f32_16x16x32_bf16 v[144:147], v[20:23], v[88:91], v[144:147]
  s_waitcnt lgkmcnt(4)
  v_mfma_f32_16x16x32_bf16 v[148:151], v[24:27], v[92:95], v[148:151]
  v_mfma_f32_16x16x32_bf16 v[128:131], v[28:31], v[92:95], v[128:131]
  s_waitcnt lgkmcnt(2)
  v_mfma_f32_16x16x32_bf16 v[132:135], v[32:35], v[92:95], v[132:135]
  v_mfma_f32_16x16x32_bf16 v[136:139], v[36:39], v[92:95], v[136:139]
  s_waitcnt lgkmcnt(0)
  v_mfma_f32_16x16x32_bf16 v[140:143], v[40:43], v[92:95], v[140:143]
  v_mfma_f32_16x16x32_bf16 v[144:147], v[44:47], v[92:95], v[144:147]
  s_nop 0
  v_add_f32 v10, 0x358637bd, v148
  v_rcp_f32 v10, v10
  s_nop 0
  v_pk_mul_f32 v[128:129], v[128:129], v[10:11] op_sel_hi:[1,0]
  v_pk_mul_f32 v[130:131], v[130:131], v[10:11] op_sel_hi:[1,0]
  v_pk_mul_f32 v[132:133], v[132:133], v[10:11] op_sel_hi:[1,0]
  v_pk_mul_f32 v[134:135], v[134:135], v[10:11] op_sel_hi:[1,0]
  v_pk_mul_f32 v[136:137], v[136:137], v[10:11] op_sel_hi:[1,0]
  v_pk_mul_f32 v[138:139], v[138:139], v[10:11] op_sel_hi:[1,0]
  v_pk_mul_f32 v[140:141], v[140:141], v[10:11] op_sel_hi:[1,0]
  v_pk_mul_f32 v[142:143], v[142:143], v[10:11] op_sel_hi:[1,0]
  v_pk_mul_f32 v[144:145], v[144:145], v[10:11] op_sel_hi:[1,0]
  v_pk_mul_f32 v[146:147], v[146:147], v[10:11] op_sel_hi:[1,0]
  v_cvt_pk_bf16_f32 v232, v128, v129
  v_cvt_pk_bf16_f32 v233, v130, v131
  v_cvt_pk_bf16_f32 v234, v132, v133
  v_cvt_pk_bf16_f32 v235, v134, v135
  v_cvt_pk_bf16_f32 v236, v136, v137
  v_cvt_pk_bf16_f32 v237, v138, v139
  v_cvt_pk_bf16_f32 v238, v140, v141
  v_cvt_pk_bf16_f32 v239, v142, v143
  v_cvt_pk_bf16_f32 v240, v144, v145
  v_cvt_pk_bf16_f32 v241, v146, v147
  buffer_store_dwordx4 v[232:235], v8, s[44:47], s12 offen sc1
  buffer_store_dwordx4 v[236:239], v8, s[44:47], s12 offen offset:1024 sc1
  buffer_store_dwordx2 v[240:241], v9, s[44:47], s12 offen offset:2048 sc1
  s_mov_b32 s66, 51200
  s_mov_b32 s67, 0
  s_mov_b32 s68, 25600
  s_mov_b32 s69, 102624
  s_mov_b32 s70, 1280
  s_mov_b32 s71, 640
  s_mov_b32 s78, 1
  s_mov_b32 s72, 1280
  s_waitcnt vmcnt(0)
  v_mov_b32 v12, 1
  s_mov_b64 exec, 1
  buffer_atomic_add v12, v15, s[44:47], s76 offen sc1
  s_mov_b64 exec, -1
  v_add_u32 v11, 224, v0
  s_mov_b32 s79, 0
k_P2h:
  v_bfe_u32 v5, v1, 2, 2
  v_and_b32 v6, 3, v1
  v_mad_u32_u24 v7, v2, 20, v5
  v_mul_u32_u24 v7, 160, v7
  v_lshl_add_u32 v252, v6, 3, v7
  v_lshl_add_u32 v7, v2, 2, v5
  v_mul_u32_u24 v7, 160, v7
  v_lshl_add_u32 v253, v6, 3, v7
  s_cmp_eq_u32 s78, 0
  s_cselect_b64 vcc, -1, 0
  v_cndmask_b32 v248, v252, v253, vcc
  s_and_b32 s74, s7, 3
  s_cmp_eq_u32 s74, 0
  s_cbranch_scc1 k_rot_doneh
k_roth:
  s_mov_b32 s9, s66
  s_mov_b32 s66, s67
  s_mov_b32 s67, s68
  s_mov_b32 s68, s69
  s_mov_b32 s69, s9
  s_sub_u32 s74, s74, 1
  s_cmp_lg_u32 s74, 0
  s_cbranch_scc1 k_roth
k_rot_doneh:
  s_sub_u32 s69, s69, s68
  s_sub_u32 s68, s68, s67
  s_sub_u32 s67, s67, s66
  s_and_b32 s74, s7, 3
  v_add_u32 v248, s66, v248
  v_add_u32 v252, s66, v252
  v_add_u32 v249, s71, v248
  v_add_u32 v250, s70, v248
  v_add_u32 v251, s70, v249
  v_mov_b32 v48, 0
  v_mov_b32 v49, 0
  v_mov_b32 v50, 0
  v_mov_b32 v51, 0
  v_mov_b32 v52, 0
  v_mov_b32 v53, 0
  v_mov_b32 v54, 0
  v_mov_b32 v55, 0
  v_mov_b32 v56, 0
  v_mov_b32 v57, 0
  v_mov_b32 v58, 0
  v_mov_b32 v59, 0
  v_mov_b32 v60, 0
  v_mov_b32 v61, 0
  v_mov_b32 v62, 0
  v_mov_b32 v63, 0
  v_mov_b32 v64, 0
  v_mov_b32 v65, 0
  v_mov_b32 v66, 0
  v_mov_b32 v67, 0
  s_lshl_b32 s9, s6, 7
  s_lshl_b32 s10, s8, 5
  s_add_u32 s9, s9, s10
  v_add_u32 v4, s9, v3
  v_mul_u32_u24 v4, 2560, v4
  s_mul_i32 s10, s7, 160
  s_add_u32 s72, s72, s10
  s_add_u32 s73, s72, 40960
  v_and_b32 v5, 1, v2
  v_lshlrev_b32 v5, 5, v5
  v_lshrrev_b32 v6, 1, v2
  v_lshl_add_u32 v5, v6, 4, v5
  v_add_u32 v5, v5, v4
  v_lshl_add_u32 v6, v2, 3, v4
  v_mov_b32 v12, 1
  s_add_u32 s9, s74, 0
  s_and_b32 s9, s9, 3
  s_mul_i32 s9, s9, 10240
  s_add_u32 s16, s9, s15
  s_add_u32 s18, s16, 5120
  s_add_u32 s9, s74, 1
  s_and_b32 s9, s9, 3
  s_mul_i32 s9, s9, 10240
  s_add_u32 s20, s9, s15
  s_add_u32 s22, s20, 5120
  s_add_u32 s9, s74, 2
  s_and_b32 s9, s9, 3
  s_mul_i32 s9, s9, 10240
  s_add_u32 s24, s9, s15
  s_add_u32 s26, s24, 5120
  s_add_u32 s9, s74, 3
  s_and_b32 s9, s9, 3
  s_mul_i32 s9, s9, 10240
  s_add_u32 s28, s9, s15
  s_add_u32 s30, s28, 5120
  s_mov_b32 s14, 0
lz_51:
  ds_read_b128 v[40:43], v11
  s_waitcnt lgkmcnt(0)
  v_or3_b32 v40, v40, v41, v42
  v_or_b32 v40, v40, v43
  s_nop 0
  v_readfirstlane_b32 s9, v40
  s_nop 0
  s_cmp_eq_u32 s9, 0
  s_cbranch_scc1 lzok_52
  s_sleep 1
  s_add_u32 s14, s14, 1
  s_cmp_lt_u32 s14, 1048576
  s_cbranch_scc1 lz_51
lzok_52:
  ds_read_b64_tr_b16 v[16:17], v248 offset:0
  ds_read_b64_tr_b16 v[18:19], v249 offset:0
  ds_read_b64_tr_b16 v[20:21], v248 offset:32
  ds_read_b64_tr_b16 v[22:23], v249 offset:32
  ds_read_b64_tr_b16 v[24:25], v248 offset:64
  ds_read_b64_tr_b16 v[26:27], v249 offset:64
  ds_read_b64_tr_b16 v[28:29], v248 offset:96
  ds_read_b64_tr_b16 v[30:31], v249 offset:96
  ds_read_b64_tr_b16 v[32:33], v248 offset:128
  ds_read_b64_tr_b16 v[34:35], v249 offset:128
  ds_read_b64_tr_b16 v[36:37], v250 offset:0
  ds_read_b64_tr_b16 v[38:39], v251 offset:0
  s_mov_b32 s14, 0
gw_53:
  s_load_dword s9, s[34:35], s76 glc
  s_waitcnt lgkmcnt(0)
  s_cmp_ge_u32 s9, 8
  s_cbranch_scc1 gwok_54
  s_sleep 1
  s_add_u32 s14, s14, 1
  s_cmp_lt_u32 s14, 65536
  s_cbranch_scc1 gw_53
gwok_54:
  buffer_load_dwordx4 v[88:91], v8, s[44:47], s16 offen offset:0 sc1
  buffer_load_dwordx4 v[92:95], v8, s[44:47], s16 offen offset:1024 sc1
  buffer_load_dwordx4 v[96:99], v8, s[44:47], s18 offen offset:0 sc1
  buffer_load_dwordx4 v[100:103], v8, s[44:47], s18 offen offset:1024 sc1
  buffer_load_dwordx2 v[104:105], v9, s[44:47], s16 offen offset:2048 sc1
  buffer_load_dwordx2 v[106:107], v9, s[44:47], s18 offen offset:2048 sc1
  buffer_load_dwordx4 v[108:111], v8, s[44:47], s20 offen offset:0 sc1
  buffer_load_dwordx4 v[112:115], v8, s[44:47], s20 offen offset:1024 sc1
  buffer_load_dwordx4 v[116:119], v8, s[44:47], s22 offen offset:0 sc1
  buffer_load_dwordx4 v[120:123], v8, s[44:47], s22 offen offset:1024 sc1
  s_waitcnt vmcnt(9)
  v_mfma_f32_16x16x32_bf16 v[48:51], v[16:19], v[88:91], v[48:51]
  ds_read_b64_tr_b16 v[40:41], v250 offset:32
  ds_read_b64_tr_b16 v[42:43], v251 offset:32
  v_mfma_f32_16x16x32_bf16 v[52:55], v[20:23], v[88:91], v[52:55]
  ds_read_b64_tr_b16 v[44:45], v250 offset:64
  ds_read_b64_tr_b16 v[46:47], v251 offset:64
  buffer_load_dwordx2 v[124:125], v9, s[44:47], s20 offen offset:2048 sc1
  v_mfma_f32_16x16x32_bf16 v[56:59], v[24:27], v[88:91], v[56:59]
  ds_read_b64_tr_b16 v[16:17], v250 offset:96
  ds_read_b64_tr_b16 v[18:19], v251 offset:96
  v_mfma_f32_16x16x32_bf16 v[60:63], v[28:31], v[88:91], v[60:63]
  ds_read_b64_tr_b16 v[20:21], v250 offset:128
  ds_read_b64_tr_b16 v[22:23], v251 offset:128
  buffer_load_dwordx2 v[126:127], v9, s[44:47], s22 offen offset:2048 sc1
  v_mfma_f32_16x16x32_bf16 v[64:67], v[32:35], v[88:91], v[64:67]
  ds_read_b64_tr_b16 v[24:25], v248 offset:12800
  ds_read_b64_tr_b16 v[26:27], v249 offset:12800
  s_waitcnt vmcnt(10)
  v_mfma_f32_16x16x32_bf16 v[48:51], v[36:39], v[92:95], v[48:51]
  ds_read_b64_tr_b16 v[28:29], v248 offset:12832
  ds_read_b64_tr_b16 v[30:31], v249 offset:12832
  buffer_load_dwordx4 v[128:131], v8, s[44:47], s24 offen offset:0 sc1
  s_waitcnt lgkmcnt(8)
  v_mfma_f32_16x16x32_bf16 v[52:55], v[40:43], v[92:95], v[52:55]
  ds_read_b64_tr_b16 v[32:33], v248 offset:12864
  ds_read_b64_tr_b16 v[34:35], v249 offset:12864
  v_mfma_f32_16x16x32_bf16 v[56:59], v[44:47], v[92:95], v[56:59]
  ds_read_b64_tr_b16 v[36:37], v248 offset:12896
  ds_read_b64_tr_b16 v[38:39], v249 offset:12896
  buffer_load_dwordx4 v[132:135], v8, s[44:47], s24 offen offset:1024 sc1
  s_waitcnt lgkmcnt(8)
  v_mfma_f32_16x16x32_bf16 v[60:63], v[16:19], v[92:95], v[60:63]
  ds_read_b64_tr_b16 v[40:41], v248 offset:12928
  ds_read_b64_tr_b16 v[42:43], v249 offset:12928
  v_add_u32 v248, s67, v248
  v_add_u32 v249, s67, v249
  v_mfma_f32_16x16x32_bf16 v[64:67], v[20:23], v[92:95], v[64:67]
  ds_read_b64_tr_b16 v[44:45], v250 offset:12800
  ds_read_b64_tr_b16 v[46:47], v251 offset:12800
  buffer_load_dwordx4 v[136:139], v8, s[44:47], s26 offen offset:0 sc1
  s_waitcnt vmcnt(12)
  s_waitcnt lgkmcnt(8)
  v_mfma_f32_16x16x32_bf16 v[48:51], v[24:27], v[96:99], v[48:51]
  ds_read_b64_tr_b16 v[16:17], v250 offset:12832
  ds_read_b64_tr_b16 v[18:19], v251 offset:12832
  v_mfma_f32_16x16x32_bf16 v[52:55], v[28:31], v[96:99], v[52:55]
  ds_read_b64_tr_b16 v[20:21], v250 offset:12864
  ds_read_b64_tr_b16 v[22:23], v251 offset:12864
  buffer_load_dwordx4 v[140:143], v8, s[44:47], s26 offen offset:1024 sc1
  s_waitcnt lgkmcnt(8)
  v_mfma_f32_16x16x32_bf16 v[56:59], v[32:35], v[96:99], v[56:59]
  ds_read_b64_tr_b16 v[24:25], v250 offset:12896
  ds_read_b64_tr_b16 v[26:27], v251 offset:12896
  v_mfma_f32_16x16x32_bf16 v[60:63], v[36:39], v[96:99], v[60:63]
  ds_read_b64_tr_b16 v[28:29], v250 offset:12928
  ds_read_b64_tr_b16 v[30:31], v251 offset:12928
  buffer_load_dwordx2 v[144:145], v9, s[44:47], s24 offen offset:2048 sc1
  v_add_u32 v250, s67, v250
  v_add_u32 v251, s67, v251
  s_waitcnt lgkmcnt(8)
  v_mfma_f32_16x16x32_bf16 v[64:67], v[40:43], v[96:99], v[64:67]
  ds_read_b64_tr_b16 v[32:33], v252 offset:2560
  ds_read_b64_tr_b16 v[34:35], v252 offset:15360
  s_waitcnt vmcnt(13)
  v_mfma_f32_16x16x32_bf16 v[48:51], v[44:47], v[100:103], v[48:51]
  ds_read_b64_tr_b16 v[36:37], v252 offset:2592
  ds_read_b64_tr_b16 v[38:39], v252 offset:15392
  buffer_load_dwordx2 v[146:147], v9, s[44:47], s26 offen offset:2048 sc1
  s_waitcnt lgkmcnt(8)
  v_mfma_f32_16x16x32_bf16 v[52:55], v[16:19], v[100:103], v[52:55]
  ds_read_b64_tr_b16 v[40:41], v252 offset:2624
  ds_read_b64_tr_b16 v[42:43], v252 offset:15424
  v_mfma_f32_16x16x32_bf16 v[56:59], v[20:23], v[100:103], v[56:59]
  ds_read_b64_tr_b16 v[44:45], v252 offset:2656
  ds_read_b64_tr_b16 v[46:47], v252 offset:15456
  buffer_load_dwordx4 v[148:151], v8, s[44:47], s28 offen offset:0 sc1
  s_waitcnt lgkmcnt(8)
  v_mfma_f32_16x16x32_bf16 v[60:63], v[24:27], v[100:103], v[60:63]
  ds_read_b64_tr_b16 v[16:17], v252 offset:2688
  ds_read_b64_tr_b16 v[18:19], v252 offset:15488
  v_add_u32 v252, s67, v252
  v_mfma_f32_16x16x32_bf16 v[64:67], v[28:31], v[100:103], v[64:67]
  ds_read_b64_tr_b16 v[20:21], v248 offset:0
  ds_read_b64_tr_b16 v[22:23], v249 offset:0
  buffer_load_dwordx4 v[152:155], v8, s[44:47], s28 offen offset:1024 sc1
  s_waitcnt vmcnt(14)
  s_waitcnt lgkmcnt(8)
  v_mfma_f32_16x16x32_bf16 v[48:51], v[32:35], v[104:107], v[48:51]
  ds_read_b64_tr_b16 v[24:25], v248 offset:32
  ds_read_b64_tr_b16 v[26:27], v249 offset:32
  v_mfma_f32_16x16x32_bf16 v[52:55], v[36:39], v[104:107], v[52:55]
  ds_read_b64_tr_b16 v[28:29], v248 offset:64
  ds_read_b64_tr_b16 v[30:31], v249 offset:64
  buffer_load_dwordx4 v[156:159], v8, s[44:47], s30 offen offset:0 sc1
  s_waitcnt lgkmcnt(8)
  v_mfma_f32_16x16x32_bf16 v[56:59], v[40:43], v[104:107], v[56:59]
  ds_read_b64_tr_b16 v[32:33], v248 offset:96
  ds_read_b64_tr_b16 v[34:35], v249 offset:96
  v_mfma_f32_16x16x32_bf16 v[60:63], v[44:47], v[104:107], v[60:63]
  ds_read_b64_tr_b16 v[36:37], v248 offset:128
  ds_read_b64_tr_b16 v[38:39], v249 offset:128
  buffer_load_dwordx4 v[160:163], v8, s[44:47], s30 offen offset:1024 sc1
  s_waitcnt lgkmcnt(8)
  v_mfma_f32_16x16x32_bf16 v[64:67], v[16:19], v[104:107], v[64:67]
  ds_read_b64_tr_b16 v[40:41], v250 offset:0
  ds_read_b64_tr_b16 v[42:43], v251 offset:0
  s_waitcnt vmcnt(15)
  v_mfma_f32_16x16x32_bf16 v[48:51], v[20:23], v[108:111], v[48:51]
  ds_read_b64_tr_b16 v[44:45], v250 offset:32
  ds_read_b64_tr_b16 v[46:47], v251 offset:32
  buffer_load_dwordx2 v[164:165], v9, s[44:47], s28 offen offset:2048 sc1
  s_waitcnt lgkmcnt(8)
  v_mfma_f32_16x16x32_bf16 v[52:55], v[24:27], v[108:111], v[52:55]
  ds_read_b64_tr_b16 v[16:17], v250 offset:64
  ds_read_b64_tr_b16 v[18:19], v251 offset:64
  v_mfma_f32_16x16x32_bf16 v[56:59], v[28:31], v[108:111], v[56:59]
  ds_read_b64_tr_b16 v[20:21], v250 offset:96
  ds_read_b64_tr_b16 v[22:23], v251 offset:96
  buffer_load_dwordx2 v[166:167], v9, s[44:47], s30 offen offset:2048 sc1
  s_waitcnt lgkmcnt(8)
  v_mfma_f32_16x16x32_bf16 v[60:63], v[32:35], v[108:111], v[60:63]
  ds_read_b64_tr_b16 v[24:25], v250 offset:128
  ds_read_b64_tr_b16 v[26:27], v251 offset:128
  v_mfma_f32_16x16x32_bf16 v[64:67], v[36:39], v[108:111], v[64:67]
  ds_read_b64_tr_b16 v[28:29], v248 offset:12800
  ds_read_b64_tr_b16 v[30:31], v249 offset:12800
  s_waitcnt vmcnt(16)
  s_waitcnt lgkmcnt(8)
  v_mfma_f32_16x16x32_bf16 v[48:51], v[40:43], v[112:115], v[48:51]
  ds_read_b64_tr_b16 v[32:33], v248 offset:12832
  ds_read_b64_tr_b16 v[34:35], v249 offset:12832
  v_mfma_f32_16x16x32_bf16 v[52:55], v[44:47], v[112:115], v[52:55]
  ds_read_b64_tr_b16 v[36:37], v248 offset:12864
  ds_read_b64_tr_b16 v[38:39], v249 offset:12864
  s_waitcnt lgkmcnt(8)
  v_mfma_f32_16x16x32_bf16 v[56:59], v[16:19], v[112:115], v[56:59]
  ds_read_b64_tr_b16 v[40:41], v248 offset:12896
  ds_read_b64_tr_b16 v[42:43], v249 offset:12896
  v_mfma_f32_16x16x32_bf16 v[60:63], v[20:23], v[112:115], v[60:63]
  ds_read_b64_tr_b16 v[44:45], v248 offset:12928
  ds_read_b64_tr_b16 v[46:47], v249 offset:12928
  v_add_u32 v248, s68, v248
  v_add_u32 v249, s68, v249
  s_waitcnt lgkmcnt(8)
  v_mfma_f32_16x16x32_bf16 v[64:67], v[24:27], v[112:115], v[64:67]
  ds_read_b64_tr_b16 v[16:17], v250 offset:12800
  ds_read_b64_tr_b16 v[18:19], v251 offset:12800
  s_waitcnt vmcnt(15)
  v_mfma_f32_16x16x32_bf16 v[48:51], v[28:31], v[116:119], v[48:51]
  ds_read_b64_tr_b16 v[20:21], v250 offset:12832
  ds_read_b64_tr_b16 v[22:23], v251 offset:12832
  s_waitcnt lgkmcnt(8)
  v_mfma_f32_16x16x32_bf16 v[52:55], v[32:35], v[116:119], v[52:55]
  ds_read_b64_tr_b16 v[24:25], v250 offset:12864
  ds_read_b64_tr_b16 v[26:27], v251 offset:12864
  v_mfma_f32_16x16x32_bf16 v[56:59], v[36:39], v[116:119], v[56:59]
  ds_read_b64_tr_b16 v[28:29], v250 offset:12896
  ds_read_b64_tr_b16 v[30:31], v251 offset:12896
  s_waitcnt lgkmcnt(8)
  v_mfma_f32_16x16x32_bf16 v[60:63], v[40:43], v[116:119], v[60:63]
  ds_read_b64_tr_b16 v[32:33], v250 offset:12928
  ds_read_b64_tr_b16 v[34:35], v251 offset:12928
  v_add_u32 v250, s68, v250
  v_add_u32 v251, s68, v251
  v_mfma_f32_16x16x32_bf16 v[64:67], v[44:47], v[116:119], v[64:67]
  ds_read_b64_tr_b16 v[36:37], v252 offset:2560
  ds_read_b64_tr_b16 v[38:39], v252 offset:15360
  s_waitcnt vmcnt(14)
  s_waitcnt lgkmcnt(8)
  v_mfma_f32_16x16x32_bf16 v[48:51], v[16:19], v[120:123], v[48:51]
  ds_read_b64_tr_b16 v[40:41], v252 offset:2592
  ds_read_b64_tr_b16 v[42:43], v252 offset:15392
  v_mfma_f32_16x16x32_bf16 v[52:55], v[20:23], v[120:123], v[52:55]
  ds_read_b64_tr_b16 v[44:45], v252 offset:2624
  ds_read_b64_tr_b16 v[46:47], v252 offset:15424
  s_waitcnt lgkmcnt(8)
  v_mfma_f32_16x16x32_bf16 v[56:59], v[24:27], v[120:123], v[56:59]
  ds_read_b64_tr_b16 v[16:17], v252 offset:2656
  ds_read_b64_tr_b16 v[18:19], v252 offset:15456
  v_mfma_f32_16x16x32_bf16 v[60:63], v[28:31], v[120:123], v[60:63]
  ds_read_b64_tr_b16 v[20:21], v252 offset:2688
  ds_read_b64_tr_b16 v[22:23], v252 offset:15488
  v_add_u32 v252, s68, v252
  s_waitcnt lgkmcnt(8)
  v_mfma_f32_16x16x32_bf16 v[64:67], v[32:35], v[120:123], v[64:67]
  ds_read_b64_tr_b16 v[24:25], v248 offset:0
  ds_read_b64_tr_b16 v[26:27], v249 offset:0
  s_waitcnt vmcnt(12)
  v_mfma_f32_16x16x32_bf16 v[48:51], v[36:39], v[124:127], v[48:51]
  ds_read_b64_tr_b16 v[28:29], v248 offset:32
  ds_read_b64_tr_b16 v[30:31], v249 offset:32
  s_waitcnt lgkmcnt(8)
  v_mfma_f32_16x16x32_bf16 v[52:55], v[40:43], v[124:127], v[52:55]
  ds_read_b64_tr_b16 v[32:33], v248 offset:64
  ds_read_b64_tr_b16 v[34:35], v249 offset:64
  v_mfma_f32_16x16x32_bf16 v[56:59], v[44:47], v[124:127], v[56:59]
  ds_read_b64_tr_b16 v[36:37], v248 offset:96
  ds_read_b64_tr_b16 v[38:39], v249 offset:96
  s_waitcnt lgkmcnt(8)
  v_mfma_f32_16x16x32_bf16 v[60:63], v[16:19], v[124:127], v[60:63]
  ds_read_b64_tr_b16 v[40:41], v248 offset:128
  ds_read_b64_tr_b16 v[42:43], v249 offset:128
  v_mfma_f32_16x16x32_bf16 v[64:67], v[20:23], v[124:127], v[64:67]
  ds_read_b64_tr_b16 v[44:45], v250 offset:0
  ds_read_b64_tr_b16 v[46:47], v251 offset:0
  s_waitcnt vmcnt(11)
  s_waitcnt lgkmcnt(8)
  v_mfma_f32_16x16x32_bf16 v[48:51], v[24:27], v[128:131], v[48:51]
  ds_read_b64_tr_b16 v[16:17], v250 offset:32
  ds_read_b64_tr_b16 v[18:19], v251 offset:32
  v_mfma_f32_16x16x32_bf16 v[52:55], v[28:31], v[128:131], v[52:55]
  ds_read_b64_tr_b16 v[20:21], v250 offset:64
  ds_read_b64_tr_b16 v[22:23], v251 offset:64
  s_waitcnt lgkmcnt(8)
  v_mfma_f32_16x16x32_bf16 v[56:59], v[32:35], v[128:131], v[56:59]
  ds_read_b64_tr_b16 v[24:25], v250 offset:96
  ds_read_b64_tr_b16 v[26:27], v251 offset:96
  v_mfma_f32_16x16x32_bf16 v[60:63], v[36:39], v[128:131], v[60:63]
  ds_read_b64_tr_b16 v[28:29], v250 offset:128
  ds_read_b64_tr_b16 v[30:31], v251 offset:128
  s_waitcnt lgkmcnt(8)
  v_mfma_f32_16x16x32_bf16 v[64:67], v[40:43], v[128:131], v[64:67]
  ds_read_b64_tr_b16 v[32:33], v248 offset:12800
  ds_read_b64_tr_b16 v[34:35], v249 offset:12800
  s_waitcnt vmcnt(10)
  v_mfma_f32_16x16x32_bf16 v[48:51], v[44:47], v[132:135], v[48:51]
  ds_read_b64_tr_b16 v[36:37], v248 offset:12832
  ds_read_b64_tr_b16 v[38:39], v249 offset:12832
  s_waitcnt lgkmcnt(8)
  v_mfma_f32_16x16x32_bf16 v[52:55], v[16:19], v[132:135], v[52:55]
  ds_read_b64_tr_b16 v[40:41], v248 offset:12864
  ds_read_b64_tr_b16 v[42:43], v249 offset:12864
  v_mfma_f32_16x16x32_bf16 v[56:59], v[20:23], v[132:135], v[56:59]
  ds_read_b64_tr_b16 v[44:45], v248 offset:12896
  ds_read_b64_tr_b16 v[46:47], v249 offset:12896
  s_waitcnt lgkmcnt(8)
  v_mfma_f32_16x16x32_bf16 v[60:63], v[24:27], v[132:135], v[60:63]
  ds_read_b64_tr_b16 v[16:17], v248 offset:12928
  ds_read_b64_tr_b16 v[18:19], v249 offset:12928
  v_add_u32 v248, s69, v248
  v_add_u32 v249, s69, v249
  v_mfma_f32_16x16x32_bf16 v[64:67], v[28:31], v[132:135], v[64:67]
  ds_read_b64_tr_b16 v[20:21], v250 offset:12800
  ds_read_b64_tr_b16 v[22:23], v251 offset:12800
  s_waitcnt vmcnt(9)
  s_waitcnt lgkmcnt(8)
  v_mfma_f32_16x16x32_bf16 v[48:51], v[32:35], v[136:139], v[48:51]
  ds_read_b64_tr_b16 v[24:25], v250 offset:12832
  ds_read_b64_tr_b16 v[26:27], v251 offset:12832
  v_mfma_f32_16x16x32_bf16 v[52:55], v[36:39], v[136:139], v[52:55]
  ds_read_b64_tr_b16 v[28:29], v250 offset:12864
  ds_read_b64_tr_b16 v[30:31], v251 offset:12864
  s_waitcnt lgkmcnt(8)
  v_mfma_f32_16x16x32_bf16 v[56:59], v[40:43], v[136:139], v[56:59]
  ds_read_b64_tr_b16 v[32:33], v250 offset:12896
  ds_read_b64_tr_b16 v[34:35], v251 offset:12896
  v_mfma_f32_16x16x32_bf16 v[60:63], v[44:47], v[136:139], v[60:63]
  ds_read_b64_tr_b16 v[36:37], v250 offset:12928
  ds_read_b64_tr_b16 v[38:39], v251 offset:12928
  v_add_u32 v250, s69, v250
  v_add_u32 v251, s69, v251
  s_waitcnt lgkmcnt(8)
  v_mfma_f32_16x16x32_bf16 v[64:67], v[16:19], v[136:139], v[64:67]
  ds_read_b64_tr_b16 v[40:41], v252 offset:2560
  ds_read_b64_tr_b16 v[42:43], v252 offset:15360
  s_waitcnt vmcnt(8)
  v_mfma_f32_16x16x32_bf16 v[48:51], v[20:23], v[140:143], v[48:51]
  ds_read_b64_tr_b16 v[44:45], v252 offset:2592
  ds_read_b64_tr_b16 v[46:47], v252 offset:15392
  s_waitcnt lgkmcnt(8)
  v_mfma_f32_16x16x32_bf16 v[52:55], v[24:27], v[140:143], v[52:55]
  ds_read_b64_tr_b16 v[16:17], v252 offset:2624
  ds_read_b64_tr_b16 v[18:19], v252 offset:15424
  v_mfma_f32_16x16x32_bf16 v[56:59], v[28:31], v[140:143], v[56:59]
  ds_read_b64_tr_b16 v[20:21], v252 offset:2656
  ds_read_b64_tr_b16 v[22:23], v252 offset:15456
  s_waitcnt lgkmcnt(8)
  v_mfma_f32_16x16x32_bf16 v[60:63], v[32:35], v[140:143], v[60:63]
  ds_read_b64_tr_b16 v[24:25], v252 offset:2688
  ds_read_b64_tr_b16 v[26:27], v252 offset:15488
  v_add_u32 v252, s69, v252
  v_mfma_f32_16x16x32_bf16 v[64:67], v[36:39], v[140:143], v[64:67]
  ds_read_b64_tr_b16 v[28:29], v248 offset:0
  ds_read_b64_tr_b16 v[30:31], v249 offset:0
  s_waitcnt vmcnt(6)
  s_waitcnt lgkmcnt(8)
  v_mfma_f32_16x16x32_bf16 v[48:51], v[40:43], v[144:147], v[48:51]
  ds_read_b64_tr_b16 v[32:33], v248 offset:32
  ds_read_b64_tr_b16 v[34:35], v249 offset:32
  v_mfma_f32_16x16x32_bf16 v[52:55], v[44:47], v[144:147], v[52:55]
  ds_read_b64_tr_b16 v[36:37], v248 offset:64
  ds_read_b64_tr_b16 v[38:39], v249 offset:64
  s_waitcnt lgkmcnt(8)
  v_mfma_f32_16x16x32_bf16 v[56:59], v[16:19], v[144:147], v[56:59]
  ds_read_b64_tr_b16 v[40:41], v248 offset:96
  ds_read_b64_tr_b16 v[42:43], v249 offset:96
  v_mfma_f32_16x16x32_bf16 v[60:63], v[20:23], v[144:147], v[60:63]
  ds_read_b64_tr_b16 v[44:45], v248 offset:128
  ds_read_b64_tr_b16 v[46:47], v249 offset:128
  s_waitcnt lgkmcnt(8)
  v_mfma_f32_16x16x32_bf16 v[64:67], v[24:27], v[144:147], v[64:67]
  ds_read_b64_tr_b16 v[16:17], v250 offset:0
  ds_read_b64_tr_b16 v[18:19], v251 offset:0
  s_waitcnt vmcnt(5)
  v_mfma_f32_16x16x32_bf16 v[48:51], v[28:31], v[148:151], v[48:51]
  ds_read_b64_tr_b16 v[20:21], v250 offset:32
  ds_read_b64_tr_b16 v[22:23], v251 offset:32
  s_waitcnt lgkmcnt(8)
  v_mfma_f32_16x16x32_bf16 v[52:55], v[32:35], v[148:151], v[52:55]
  ds_read_b64_tr_b16 v[24:25], v250 offset:64
  ds_read_b64_tr_b16 v[26:27], v251 offset:64
  v_mfma_f32_16x16x32_bf16 v[56:59], v[36:39], v[148:151], v[56:59]
  ds_read_b64_tr_b16 v[28:29], v250 offset:96
  ds_read_b64_tr_b16 v[30:31], v251 offset:96
  s_waitcnt lgkmcnt(8)
  v_mfma_f32_16x16x32_bf16 v[60:63], v[40:43], v[148:151], v[60:63]
  ds_read_b64_tr_b16 v[32:33], v250 offset:128
  ds_read_b64_tr_b16 v[34:35], v251 offset:128
  v_mfma_f32_16x16x32_bf16 v[64:67], v[44:47], v[148:151], v[64:67]
  ds_read_b64_tr_b16 v[36:37], v248 offset:12800
  ds_read_b64_tr_b16 v[38:39], v249 offset:12800
  s_waitcnt vmcnt(4)
  s_waitcnt lgkmcnt(8)
  v_mfma_f32_16x16x32_bf16 v[48:51], v[16:19], v[152:155], v[48:51]
  ds_read_b64_tr_b16 v[40:41], v248 offset:12832
  ds_read_b64_tr_b16 v[42:43], v249 offset:12832
  v_mfma_f32_16x16x32_bf16 v[52:55], v[20:23], v[152:155], v[52:55]
  ds_read_b64_tr_b16 v[44:45], v248 offset:12864
  ds_read_b64_tr_b16 v[46:47], v249 offset:12864
  s_waitcnt lgkmcnt(8)
  v_mfma_f32_16x16x32_bf16 v[56:59], v[24:27], v[152:155], v[56:59]
  ds_read_b64_tr_b16 v[16:17], v248 offset:12896
  ds_read_b64_tr_b16 v[18:19], v249 offset:12896
  v_mfma_f32_16x16x32_bf16 v[60:63], v[28:31], v[152:155], v[60:63]
  ds_read_b64_tr_b16 v[20:21], v248 offset:12928
  ds_read_b64_tr_b16 v[22:23], v249 offset:12928
  s_waitcnt lgkmcnt(8)
  v_mfma_f32_16x16x32_bf16 v[64:67], v[32:35], v[152:155], v[64:67]
  ds_read_b64_tr_b16 v[24:25], v250 offset:12800
  ds_read_b64_tr_b16 v[26:27], v251 offset:12800
  s_waitcnt vmcnt(3)
  v_mfma_f32_16x16x32_bf16 v[48:51], v[36:39], v[156:159], v[48:51]
  ds_read_b64_tr_b16 v[28:29], v250 offset:12832
  ds_read_b64_tr_b16 v[30:31], v251 offset:12832
  s_waitcnt lgkmcnt(8)
  v_mfma_f32_16x16x32_bf16 v[52:55], v[40:43], v[156:159], v[52:55]
  ds_read_b64_tr_b16 v[32:33], v250 offset:12864
  ds_read_b64_tr_b16 v[34:35], v251 offset:12864
  v_mfma_f32_16x16x32_bf16 v[56:59], v[44:47], v[156:159], v[56:59]
  ds_read_b64_tr_b16 v[36:37], v250 offset:12896
  ds_read_b64_tr_b16 v[38:39], v251 offset:12896
  s_waitcnt lgkmcnt(8)
  v_mfma_f32_16x16x32_bf16 v[60:63], v[16:19], v[156:159], v[60:63]
  ds_read_b64_tr_b16 v[40:41], v250 offset:12928
  ds_read_b64_tr_b16 v[42:43], v251 offset:12928
  v_mfma_f32_16x16x32_bf16 v[64:67], v[20:23], v[156:159], v[64:67]
  ds_read_b64_tr_b16 v[44:45], v252 offset:2560
  ds_read_b64_tr_b16 v[46:47], v252 offset:15360
  s_waitcnt vmcnt(2)
  s_waitcnt lgkmcnt(8)
  v_mfma_f32_16x16x32_bf16 v[48:51], v[24:27], v[160:163], v[48:51]
  ds_read_b64_tr_b16 v[16:17], v252 offset:2592
  ds_read_b64_tr_b16 v[18:19], v252 offset:15392
  v_mfma_f32_16x16x32_bf16 v[52:55], v[28:31], v[160:163], v[52:55]
  ds_read_b64_tr_b16 v[20:21], v252 offset:2624
  ds_read_b64_tr_b16 v[22:23], v252 offset:15424
  s_waitcnt lgkmcnt(8)
  v_mfma_f32_16x16x32_bf16 v[56:59], v[32:35], v[160:163], v[56:59]
  ds_read_b64_tr_b16 v[24:25], v252 offset:2656
  ds_read_b64_tr_b16 v[26:27], v252 offset:15456
  v_mfma_f32_16x16x32_bf16 v[60:63], v[36:39], v[160:163], v[60:63]
  ds_read_b64_tr_b16 v[28:29], v252 offset:2688
  ds_read_b64_tr_b16 v[30:31], v252 offset:15488
  s_waitcnt lgkmcnt(8)
  v_mfma_f32_16x16x32_bf16 v[64:67], v[40:43], v[160:163], v[64:67]
  s_waitcnt vmcnt(0)
  v_mfma_f32_16x16x32_bf16 v[48:51], v[44:47], v[164:167], v[48:51]
  s_waitcnt lgkmcnt(4)
  v_mfma_f32_16x16x32_bf16 v[52:55], v[16:19], v[164:167], v[52:55]
  v_mfma_f32_16x16x32_bf16 v[56:59], v[20:23], v[164:167], v[56:59]
  s_waitcnt lgkmcnt(0)
  v_mfma_f32_16x16x32_bf16 v[60:63], v[24:27], v[164:167], v[60:63]
  v_mfma_f32_16x16x32_bf16 v[64:67], v[28:31], v[164:167], v[64:67]
  s_nop 1
  v_cvt_pk_bf16_f32 v88, v48, v49
  v_cvt_pk_bf16_f32 v89, v50, v51
  v_cvt_pk_bf16_f32 v90, v52, v53
  v_cvt_pk_bf16_f32 v91, v54, v55
  v_cvt_pk_bf16_f32 v92, v56, v57
  v_cvt_pk_bf16_f32 v93, v58, v59
  v_cvt_pk_bf16_f32 v94, v60, v61
  v_cvt_pk_bf16_f32 v95, v62, v63
  v_cvt_pk_bf16_f32 v96, v64, v65
  v_cvt_pk_bf16_f32 v97, v66, v67
  v_permlane16_swap_b32 v88, v90
  v_permlane16_swap_b32 v89, v91
  v_permlane16_swap_b32 v92, v94
  v_permlane16_swap_b32 v93, v95
  buffer_store_dwordx4 v[88:91], v5, s[60:63], s72 offen offset:0
  buffer_store_dwordx4 v[92:95], v5, s[60:63], s72 offen offset:64
  buffer_store_dwordx2 v[96:97], v6, s[60:63], s72 offen offset:128
  s_endpgm
k_A:
k_A0:
  v_bfe_u32 v8, v1, 2, 2
  v_and_b32 v9, 3, v1
  v_lshrrev_b32 v10, 1, v2
  v_lshlrev_b32 v10, 4, v10
  v_and_b32 v11, 1, v2
  v_lshl_add_u32 v10, v11, 2, v10
  v_add_u32 v10, v10, v8
  v_mul_u32_u24 v11, 160, v10
  v_mad_u32_u24 v4, v9, 40, v11
  v_lshl_add_u32 v5, v9, 3, v11
  s_lshl_b32 s9, s8, 5
  s_cmp_eq_u32 s5, 0
  s_cselect_b32 s9, 0, s9
  v_lshrrev_b32 v11, 1, v3
  v_xor_b32 v11, v11, v2
  v_lshlrev_b32 v11, 4, v11
  v_add_u32 v12, s9, v3
  v_lshl_add_u32 v6, v12, 7, v11
  v_xor_b32 v7, 64, v6
  s_lshl_b32 s9, s8, 2
  s_add_u32 s9, s9, 16
  v_add_u32 v14, s9, v0
  v_mov_b32 v16, 0
  v_mov_b32 v17, 0
  v_pk_mov_b32 v[128:129], v[16:17], v[16:17]
  v_pk_mov_b32 v[130:131], v[16:17], v[16:17]
  v_pk_mov_b32 v[132:133], v[16:17], v[16:17]
  v_pk_mov_b32 v[134:135], v[16:17], v[16:17]
  v_pk_mov_b32 v[136:137], v[16:17], v[16:17]
  v_pk_mov_b32 v[138:139], v[16:17], v[16:17]
  v_pk_mov_b32 v[140:141], v[16:17], v[16:17]
  v_pk_mov_b32 v[142:143], v[16:17], v[16:17]
  v_pk_mov_b32 v[144:145], v[16:17], v[16:17]
  v_pk_mov_b32 v[146:147], v[16:17], v[16:17]
  v_pk_mov_b32 v[148:149], v[16:17], v[16:17]
  v_pk_mov_b32 v[150:151], v[16:17], v[16:17]
  v_pk_mov_b32 v[152:153], v[16:17], v[16:17]
  v_pk_mov_b32 v[154:155], v[16:17], v[16:17]
  v_pk_mov_b32 v[156:157], v[16:17], v[16:17]
  v_pk_mov_b32 v[158:159], v[16:17], v[16:17]
  v_pk_mov_b32 v[160:161], v[16:17], v[16:17]
  v_pk_mov_b32 v[162:163], v[16:17], v[16:17]
  v_pk_mov_b32 v[164:165], v[16:17], v[16:17]
  v_pk_mov_b32 v[166:167], v[16:17], v[16:17]
  v_pk_mov_b32 v[168:169], v[16:17], v[16:17]
  v_pk_mov_b32 v[170:171], v[16:17], v[16:17]
  v_pk_mov_b32 v[172:173], v[16:17], v[16:17]
  v_pk_mov_b32 v[174:175], v[16:17], v[16:17]
  v_pk_mov_b32 v[176:177], v[16:17], v[16:17]
  v_pk_mov_b32 v[178:179], v[16:17], v[16:17]
  v_pk_mov_b32 v[180:181], v[16:17], v[16:17]
  v_pk_mov_b32 v[182:183], v[16:17], v[16:17]
  v_pk_mov_b32 v[184:185], v[16:17], v[16:17]
  v_pk_mov_b32 v[186:187], v[16:17], v[16:17]
  v_pk_mov_b32 v[188:189], v[16:17], v[16:17]
  v_pk_mov_b32 v[190:191], v[16:17], v[16:17]
  v_pk_mov_b32 v[192:193], v[16:17], v[16:17]
  v_pk_mov_b32 v[194:195], v[16:17], v[16:17]
  v_pk_mov_b32 v[196:197], v[16:17], v[16:17]
  v_pk_mov_b32 v[198:199], v[16:17], v[16:17]
  v_pk_mov_b32 v[200:201], v[16:17], v[16:17]
  v_pk_mov_b32 v[202:203], v[16:17], v[16:17]
  v_pk_mov_b32 v[204:205], v[16:17], v[16:17]
  v_pk_mov_b32 v[206:207], v[16:17], v[16:17]
  v_pk_mov_b32 v[208:209], v[16:17], v[16:17]
  v_pk_mov_b32 v[210:211], v[16:17], v[16:17]
  v_pk_mov_b32 v[212:213], v[16:17], v[16:17]
  v_pk_mov_b32 v[214:215], v[16:17], v[16:17]
  v_pk_mov_b32 v[216:217], v[16:17], v[16:17]
  v_pk_mov_b32 v[218:219], v[16:17], v[16:17]
  v_pk_mov_b32 v[220:221], v[16:17], v[16:17]
  v_pk_mov_b32 v[222:223], v[16:17], v[16:17]
  v_pk_mov_b32 v[224:225], v[16:17], v[16:17]
  v_pk_mov_b32 v[226:227], v[16:17], v[16:17]
  v_pk_mov_b32 v[228:229], v[16:17], v[16:17]
  v_pk_mov_b32 v[230:231], v[16:17], v[16:17]
  v_pk_mov_b32 v[232:233], v[16:17], v[16:17]
  v_pk_mov_b32 v[234:235], v[16:17], v[16:17]
  v_pk_mov_b32 v[236:237], v[16:17], v[16:17]
  v_pk_mov_b32 v[238:239], v[16:17], v[16:17]
  v_pk_mov_b32 v[240:241], v[16:17], v[16:17]
  v_pk_mov_b32 v[242:243], v[16:17], v[16:17]
  v_pk_mov_b32 v[244:245], v[16:17], v[16:17]
  v_pk_mov_b32 v[246:247], v[16:17], v[16:17]
  v_pk_mov_b32 v[84:85], v[16:17], v[16:17]
  v_pk_mov_b32 v[86:87], v[16:17], v[16:17]
  v_pk_mov_b32 v[88:89], v[16:17], v[16:17]
  v_pk_mov_b32 v[90:91], v[16:17], v[16:17]
  v_pk_mov_b32 v[92:93], v[16:17], v[16:17]
  v_pk_mov_b32 v[94:95], v[16:17], v[16:17]
  s_waitcnt lgkmcnt(0)
  s_cmp_eq_u32 s5, 0
  s_cselect_b32 s56, s20, s28
  s_cselect_b32 s57, s21, s29
  s_mov_b32 s58, 819200
  s_mov_b32 s59, 0x20000
  s_mov_b32 s44, s34
  s_mov_b32 s45, s35
  s_mov_b32 s46, 268435456
  s_mov_b32 s47, 0x20000
  s_mov_b32 s48, s32
  s_mov_b32 s49, s33
  s_mov_b32 s50, 256
  s_mov_b32 s51, 0x20000
  s_mov_b32 s52, s26
  s_mov_b32 s53, s27
  s_mov_b32 s54, 25600
  s_mov_b32 s55, 0x20000
  s_mov_b32 s60, s30
  s_mov_b32 s61, s31
  s_mov_b32 s62, 5242880
  s_mov_b32 s63, 0x20000
  s_lshl_b32 s77, s5, 4
  s_add_u32 s77, s77, s6
  s_lshl_b32 s76, s77, 2
  s_add_u32 s76, s76, s8
  s_lshl_b32 s76, s76, 8
  s_add_u32 s76, s76, 9437184
  s_lshl_b32 s77, s77, 2
  s_add_u32 s77, s77, 0
  s_mov_b32 s10, 0
  v_mov_b32 v74, 0
  v_add_u32 v73, 132, v0
  s_mov_b32 s100, 49152
  s_mov_b32 s101, 49152
  s_mov_b32 s11, -98304
  s_mov_b32 s14, 0
lz_56:
  ds_read_b32 v72, v0 offset:128
  s_waitcnt lgkmcnt(0)
  v_readfirstlane_b32 s9, v72
  s_nop 0
  s_cmp_eq_u32 s9, 0
  s_cbranch_scc1 lzok_57
  s_sleep 1
  s_add_u32 s14, s14, 1
  s_cmp_lt_u32 s14, 1048576
  s_cbranch_scc1 lz_56
lzok_57:
  ds_read_b128 v[56:59], v6 offset:2048
  ds_read_b128 v[60:63], v6 offset:4096
  ds_read_b128 v[76:79], v6
  ds_read_b64_tr_b16 v[16:17], v5 offset:18432
  ds_read_b64_tr_b16 v[18:19], v5 offset:19712
  ds_read_b64_tr_b16 v[20:21], v5 offset:18472
  ds_read_b64_tr_b16 v[22:23], v5 offset:19752
  ds_read_b64_tr_b16 v[24:25], v5 offset:18512
  ds_read_b64_tr_b16 v[26:27], v5 offset:19792
  ds_read_b64_tr_b16 v[28:29], v5 offset:18552
  ds_read_b64_tr_b16 v[30:31], v5 offset:19832
  ds_read_b64_tr_b16 v[32:33], v4 offset:18464
  ds_read_b64_tr_b16 v[34:35], v4 offset:19744
.p2align 3
gl_55:
  s_waitcnt lgkmcnt(6)
  v_mfma_f32_16x16x32_bf16 v[128:131], v[16:19], v[56:59], v[128:131]
  ds_read_b64_tr_b16 v[36:37], v5 offset:28672
  ds_read_b128 v[64:67], v7 offset:2048
  s_mov_b32 s13, s100
  v_mfma_f32_16x16x32_bf16 v[132:135], v[16:19], v[60:63], v[132:135]
  ds_read_b64_tr_b16 v[38:39], v5 offset:29952
  ds_read_b128 v[68:71], v7 offset:4096
  s_mov_b32 s100, s101
  v_mfma_f32_16x16x32_bf16 v[136:139], v[20:23], v[56:59], v[136:139]
  ds_read_b64_tr_b16 v[40:41], v5 offset:28712
  ds_read_b128 v[80:83], v7
  v_mfma_f32_16x16x32_bf16 v[140:143], v[20:23], v[60:63], v[140:143]
  ds_read_b64_tr_b16 v[42:43], v5 offset:29992
  s_waitcnt lgkmcnt(9)
  v_mfma_f32_16x16x32_bf16 v[144:147], v[24:27], v[56:59], v[144:147]
  ds_read_b64_tr_b16 v[44:45], v5 offset:28752
  s_mov_b32 s101, s11
  v_mfma_f32_16x16x32_bf16 v[148:151], v[24:27], v[60:63], v[148:151]
  ds_read_b64_tr_b16 v[46:47], v5 offset:30032
  s_mov_b32 s11, s13
  v_mfma_f32_16x16x32_bf16 v[152:155], v[28:31], v[56:59], v[152:155]
  ds_read_b64_tr_b16 v[48:49], v5 offset:28792
  v_add_u32 v7, s13, v7
  v_mfma_f32_16x16x32_bf16 v[156:159], v[28:31], v[60:63], v[156:159]
  ds_read_b64_tr_b16 v[50:51], v5 offset:30072
  s_waitcnt lgkmcnt(8)
  v_mfma_f32_16x16x32_bf16 v[160:163], v[32:35], v[56:59], v[160:163]
  ds_read_b64_tr_b16 v[52:53], v4 offset:28704
  ds_read_b32 v75, v73
  v_mfma_f32_16x16x32_bf16 v[164:167], v[32:35], v[60:63], v[164:167]
  ds_read_b64_tr_b16 v[54:55], v4 offset:29984
  v_mfma_f32_16x16x32_bf16 v[168:171], v[36:39], v[56:59], v[168:171]
  ds_read_b64_tr_b16 v[16:17], v5 offset:38912
  v_mfma_f32_16x16x32_bf16 v[172:175], v[36:39], v[60:63], v[172:175]
  ds_read_b64_tr_b16 v[18:19], v5 offset:40192
  v_mfma_f32_16x16x32_bf16 v[84:87], v[36:39], v[76:79], v[84:87]
  s_waitcnt lgkmcnt(7)
  v_mfma_f32_16x16x32_bf16 v[176:179], v[40:43], v[56:59], v[176:179]
  ds_read_b64_tr_b16 v[20:21], v5 offset:38952
  v_mfma_f32_16x16x32_bf16 v[180:183], v[40:43], v[60:63], v[180:183]
  ds_read_b64_tr_b16 v[22:23], v5 offset:40232
  v_mfma_f32_16x16x32_bf16 v[88:91], v[40:43], v[76:79], v[88:91]
  v_add_u32 v74, 1, v74
  v_mfma_f32_16x16x32_bf16 v[184:187], v[44:47], v[56:59], v[184:187]
  ds_read_b64_tr_b16 v[24:25], v5 offset:38992
  v_mfma_f32_16x16x32_bf16 v[188:191], v[44:47], v[60:63], v[188:191]
  ds_read_b64_tr_b16 v[26:27], v5 offset:40272
  v_mfma_f32_16x16x32_bf16 v[92:95], v[44:47], v[76:79], v[92:95]
  s_waitcnt lgkmcnt(6)
  v_mfma_f32_16x16x32_bf16 v[192:195], v[48:51], v[56:59], v[192:195]
  ds_read_b64_tr_b16 v[28:29], v5 offset:39032
  v_readfirstlane_b32 s12, v75
  v_mfma_f32_16x16x32_bf16 v[196:199], v[48:51], v[60:63], v[196:199]
  ds_read_b64_tr_b16 v[30:31], v5 offset:40312
  v_mfma_f32_16x16x32_bf16 v[200:203], v[52:55], v[56:59], v[200:203]
  ds_read_b64_tr_b16 v[32:33], v4 offset:38944
  v_mfma_f32_16x16x32_bf16 v[204:207], v[52:55], v[60:63], v[204:207]
  ds_read_b64_tr_b16 v[34:35], v4 offset:40224
  s_cmp_eq_u32 s12, 0
  s_cbranch_scc0 slowb_60
backb_61:
  s_waitcnt lgkmcnt(6)
  v_mfma_f32_16x16x32_bf16 v[208:211], v[56:59], v[16:19], v[208:211]
  ds_read_b64_tr_b16 v[36:37], v5 offset:23552
  v_mfma_f32_16x16x32_bf16 v[212:215], v[60:63], v[16:19], v[212:215]
  ds_read_b64_tr_b16 v[38:39], v5 offset:24832
  v_mfma_f32_16x16x32_bf16 v[216:219], v[56:59], v[20:23], v[216:219]
  ds_read_b64_tr_b16 v[40:41], v5 offset:23592
  v_mfma_f32_16x16x32_bf16 v[220:223], v[60:63], v[20:23], v[220:223]
  ds_read_b64_tr_b16 v[42:43], v5 offset:24872
  s_waitcnt lgkmcnt(6)
  v_mfma_f32_16x16x32_bf16 v[224:227], v[56:59], v[24:27], v[224:227]
  ds_read_b64_tr_b16 v[44:45], v5 offset:23632
  v_mfma_f32_16x16x32_bf16 v[228:231], v[60:63], v[24:27], v[228:231]
  ds_read_b64_tr_b16 v[46:47], v5 offset:24912
  v_mfma_f32_16x16x32_bf16 v[232:235], v[56:59], v[28:31], v[232:235]
  ds_read_b64_tr_b16 v[48:49], v5 offset:23672
  v_mfma_f32_16x16x32_bf16 v[236:239], v[60:63], v[28:31], v[236:239]
  ds_read_b64_tr_b16 v[50:51], v5 offset:24952
  s_waitcnt lgkmcnt(6)
  v_mfma_f32_16x16x32_bf16 v[240:243], v[56:59], v[32:35], v[240:243]
  ds_read_b64_tr_b16 v[52:53], v4 offset:23584
  ds_write_b32 v14, v74
  v_mfma_f32_16x16x32_bf16 v[244:247], v[60:63], v[32:35], v[244:247]
  ds_read_b64_tr_b16 v[54:55], v4 offset:24864
  v_mfma_f32_16x16x32_bf16 v[128:131], v[36:39], v[64:67], v[128:131]
  ds_read_b64_tr_b16 v[16:17], v5 offset:33792
  v_mfma_f32_16x16x32_bf16 v[132:135], v[36:39], v[68:71], v[132:135]
  ds_read_b64_tr_b16 v[18:19], v5 offset:35072
  s_waitcnt lgkmcnt(7)
  v_mfma_f32_16x16x32_bf16 v[136:139], v[40:43], v[64:67], v[136:139]
  ds_read_b64_tr_b16 v[20:21], v5 offset:33832
  v_mfma_f32_16x16x32_bf16 v[140:143], v[40:43], v[68:71], v[140:143]
  ds_read_b64_tr_b16 v[22:23], v5 offset:35112
  v_mfma_f32_16x16x32_bf16 v[144:147], v[44:47], v[64:67], v[144:147]
  ds_read_b64_tr_b16 v[24:25], v5 offset:33872
  v_mfma_f32_16x16x32_bf16 v[148:151], v[44:47], v[68:71], v[148:151]
  ds_read_b64_tr_b16 v[26:27], v5 offset:35152
  s_waitcnt lgkmcnt(6)
  v_mfma_f32_16x16x32_bf16 v[152:155], v[48:51], v[64:67], v[152:155]
  ds_read_b64_tr_b16 v[28:29], v5 offset:33912
  v_mfma_f32_16x16x32_bf16 v[156:159], v[48:51], v[68:71], v[156:159]
  ds_read_b64_tr_b16 v[30:31], v5 offset:35192
  v_mfma_f32_16x16x32_bf16 v[160:163], v[52:55], v[64:67], v[160:163]
  ds_read_b64_tr_b16 v[32:33], v4 offset:33824
  v_mfma_f32_16x16x32_bf16 v[164:167], v[52:55], v[68:71], v[164:167]
  ds_read_b64_tr_b16 v[34:35], v4 offset:35104
  s_waitcnt lgkmcnt(6)
  v_mfma_f32_16x16x32_bf16 v[168:171], v[16:19], v[64:67], v[168:171]
  ds_read_b64_tr_b16 v[36:37], v5 offset:44032
  ds_read_b32 v72, v73 offset:4
  v_mfma_f32_16x16x32_bf16 v[172:175], v[16:19], v[68:71], v[172:175]
  ds_read_b64_tr_b16 v[38:39], v5 offset:45312
  v_mfma_f32_16x16x32_bf16 v[84:87], v[16:19], v[80:83], v[84:87]
  v_add_u32 v74, 1, v74
  v_mfma_f32_16x16x32_bf16 v[176:179], v[20:23], v[64:67], v[176:179]
  ds_read_b64_tr_b16 v[40:41], v5 offset:44072
  v_mfma_f32_16x16x32_bf16 v[180:183], v[20:23], v[68:71], v[180:183]
  ds_read_b64_tr_b16 v[42:43], v5 offset:45352
  v_mfma_f32_16x16x32_bf16 v[88:91], v[20:23], v[80:83], v[88:91]
  s_waitcnt lgkmcnt(7)
  v_mfma_f32_16x16x32_bf16 v[184:187], v[24:27], v[64:67], v[184:187]
  ds_read_b64_tr_b16 v[44:45], v5 offset:44112
  v_mfma_f32_16x16x32_bf16 v[188:191], v[24:27], v[68:71], v[188:191]
  ds_read_b64_tr_b16 v[46:47], v5 offset:45392
  v_mfma_f32_16x16x32_bf16 v[92:95], v[24:27], v[80:83], v[92:95]
  v_add_u32 v6, s13, v6
  v_mfma_f32_16x16x32_bf16 v[192:195], v[28:31], v[64:67], v[192:195]
  ds_read_b64_tr_b16 v[48:49], v5 offset:44152
  v_mfma_f32_16x16x32_bf16 v[196:199], v[28:31], v[68:71], v[196:199]
  ds_read_b64_tr_b16 v[50:51], v5 offset:45432
  v_add_u32 v5, s13, v5
  s_waitcnt lgkmcnt(6)
  v_mfma_f32_16x16x32_bf16 v[200:203], v[32:35], v[64:67], v[200:203]
  ds_read_b64_tr_b16 v[52:53], v4 offset:44064
  v_readfirstlane_b32 s9, v72
  v_mfma_f32_16x16x32_bf16 v[204:207], v[32:35], v[68:71], v[204:207]
  ds_read_b64_tr_b16 v[54:55], v4 offset:45344
  v_add_u32 v4, s13, v4
  s_cmp_eq_u32 s9, 0
  s_cbranch_scc0 slow_58
back_59:
  v_mfma_f32_16x16x32_bf16 v[208:211], v[64:67], v[36:39], v[208:211]
  ds_read_b64_tr_b16 v[16:17], v5 offset:18432
  ds_read_b128 v[56:59], v6 offset:2048
  ds_read_b128 v[60:63], v6 offset:4096
  v_mfma_f32_16x16x32_bf16 v[212:215], v[68:71], v[36:39], v[212:215]
  ds_read_b64_tr_b16 v[18:19], v5 offset:19712
  ds_read_b128 v[76:79], v6
  s_waitcnt lgkmcnt(9)
  v_mfma_f32_16x16x32_bf16 v[216:219], v[64:67], v[40:43], v[216:219]
  ds_read_b64_tr_b16 v[20:21], v5 offset:18472
  v_add_u32 v73, 8, v73
  v_mfma_f32_16x16x32_bf16 v[220:223], v[68:71], v[40:43], v[220:223]
  ds_read_b64_tr_b16 v[22:23], v5 offset:19752
  s_add_u32 s10, s10, 1
  v_mfma_f32_16x16x32_bf16 v[224:227], v[64:67], v[44:47], v[224:227]
  ds_read_b64_tr_b16 v[24:25], v5 offset:18512
  v_mfma_f32_16x16x32_bf16 v[228:231], v[68:71], v[44:47], v[228:231]
  ds_read_b64_tr_b16 v[26:27], v5 offset:19792
  s_waitcnt lgkmcnt(9)
  v_mfma_f32_16x16x32_bf16 v[232:235], v[64:67], v[48:51], v[232:235]
  ds_read_b64_tr_b16 v[28:29], v5 offset:18552
  ds_write_b32 v14, v74
  v_mfma_f32_16x16x32_bf16 v[236:239], v[68:71], v[48:51], v[236:239]
  ds_read_b64_tr_b16 v[30:31], v5 offset:19832
  v_mfma_f32_16x16x32_bf16 v[240:243], v[64:67], v[52:55], v[240:243]
  ds_read_b64_tr_b16 v[32:33], v4 offset:18464
  v_mfma_f32_16x16x32_bf16 v[244:247], v[68:71], v[52:55], v[244:247]
  ds_read_b64_tr_b16 v[34:35], v4 offset:19744
  s_cmp_lt_u32 s10, 10
  s_cbranch_scc1 gl_55
  s_waitcnt lgkmcnt(0)
  s_branch gd_62
slow_58:
  s_mov_b32 s14, 0
lz_63:
  ds_read_b32 v72, v73 offset:4
  s_waitcnt lgkmcnt(0)
  v_readfirstlane_b32 s9, v72
  s_nop 0
  s_cmp_eq_u32 s9, 0
  s_cbranch_scc1 lzok_64
  s_add_u32 s14, s14, 1
  s_cmp_lt_u32 s14, 1048576
  s_cbranch_scc1 lz_63
lzok_64:
  s_branch back_59
slowb_60:
  s_mov_b32 s14, 0
lz_65:
  ds_read_b32 v72, v73 offset:0
  s_waitcnt lgkmcnt(0)
  v_readfirstlane_b32 s9, v72
  s_nop 0
  s_cmp_eq_u32 s9, 0
  s_cbranch_scc1 lzok_66
  s_add_u32 s14, s14, 1
  s_cmp_lt_u32 s14, 1048576
  s_cbranch_scc1 lz_65
lzok_66:
  s_branch backb_61
gd_62:
  v_lshlrev_b32 v8, 4, v1
  v_lshlrev_b32 v9, 3, v1
  v_cvt_pk_bf16_f32 v16, v84, v85
  v_cvt_pk_bf16_f32 v17, v86, v87
  v_cvt_pk_bf16_f32 v18, v88, v89
  v_cvt_pk_bf16_f32 v19, v90, v91
  v_cvt_pk_bf16_f32 v20, v92, v93
  v_cvt_pk_bf16_f32 v21, v94, v95
  s_mov_b32 s14, 0
lw_67:
  ds_read_b128 v[248:251], v0 offset:16
  s_waitcnt lgkmcnt(0)
  v_min3_u32 v248, v248, v249, v250
  v_min_u32 v248, v248, v251
  s_nop 0
  v_readfirstlane_b32 s9, v248
  s_nop 0
  s_cmp_ge_u32 s9, 16
  s_cbranch_scc1 lwok_68
  s_sleep 1
  s_add_u32 s14, s14, 1
  s_cmp_lt_u32 s14, 1048576
  s_cbranch_scc1 lw_67
lwok_68:
  ds_write_b64 v8, v[16:17] offset:51200
  ds_write_b64 v8, v[18:19] offset:52224
  ds_write_b64 v8, v[20:21] offset:53248
  v_mov_b32 v12, 1
  s_mov_b64 exec, 1
  ds_add_u32 v0, v12 offset:48
  s_mov_b64 exec, -1
  s_branch k_Aep
k_A1:
  v_bfe_u32 v8, v1, 2, 2
  v_and_b32 v9, 3, v1
  v_lshrrev_b32 v10, 1, v2
  v_lshlrev_b32 v10, 4, v10
  v_and_b32 v11, 1, v2
  v_lshl_add_u32 v10, v11, 2, v10
  v_add_u32 v10, v10, v8
  v_mul_u32_u24 v11, 160, v10
  v_mad_u32_u24 v4, v9, 40, v11
  v_lshl_add_u32 v5, v9, 3, v11
  s_lshl_b32 s9, s8, 5
  s_cmp_eq_u32 s5, 0
  s_cselect_b32 s9, 0, s9
  v_lshrrev_b32 v11, 1, v3
  v_xor_b32 v11, v11, v2
  v_lshlrev_b32 v11, 4, v11
  v_add_u32 v12, s9, v3
  v_lshl_add_u32 v6, v12, 7, v11
  v_xor_b32 v7, 64, v6
  s_lshl_b32 s9, s8, 2
  s_add_u32 s9, s9, 16
  v_add_u32 v14, s9, v0
  v_mov_b32 v16, 0
  v_mov_b32 v17, 0
  v_pk_mov_b32 v[128:129], v[16:17], v[16:17]
  v_pk_mov_b32 v[130:131], v[16:17], v[16:17]
  v_pk_mov_b32 v[132:133], v[16:17], v[16:17]
  v_pk_mov_b32 v[134:135], v[16:17], v[16:17]
  v_pk_mov_b32 v[136:137], v[16:17], v[16:17]
  v_pk_mov_b32 v[138:139], v[16:17], v[16:17]
  v_pk_mov_b32 v[140:141], v[16:17], v[16:17]
  v_pk_mov_b32 v[142:143], v[16:17], v[16:17]
  v_pk_mov_b32 v[144:145], v[16:17], v[16:17]
  v_pk_mov_b32 v[146:147], v[16:17], v[16:17]
  v_pk_mov_b32 v[148:149], v[16:17], v[16:17]
  v_pk_mov_b32 v[150:151], v[16:17], v[16:17]
  v_pk_mov_b32 v[152:153], v[16:17], v[16:17]
  v_pk_mov_b32 v[154:155], v[16:17], v[16:17]
  v_pk_mov_b32 v[156:157], v[16:17], v[16:17]
  v_pk_mov_b32 v[158:159], v[16:17], v[16:17]
  v_pk_mov_b32 v[160:161], v[16:17], v[16:17]
  v_pk_mov_b32 v[162:163], v[16:17], v[16:17]
  v_pk_mov_b32 v[164:165], v[16:17], v[16:17]
  v_pk_mov_b32 v[166:167], v[16:17], v[16:17]
  v_pk_mov_b32 v[168:169], v[16:17], v[16:17]
  v_pk_mov_b32 v[170:171], v[16:17], v[16:17]
  v_pk_mov_b32 v[172:173], v[16:17], v[16:17]
  v_pk_mov_b32 v[174:175], v[16:17], v[16:17]
  v_pk_mov_b32 v[176:177], v[16:17], v[16:17]
  v_pk_mov_b32 v[178:179], v[16:17], v[16:17]
  v_pk_mov_b32 v[180:181], v[16:17], v[16:17]
  v_pk_mov_b32 v[182:183], v[16:17], v[16:17]
  v_pk_mov_b32 v[184:185], v[16:17], v[16:17]
  v_pk_mov_b32 v[186:187], v[16:17], v[16:17]
  v_pk_mov_b32 v[188:189], v[16:17], v[16:17]
  v_pk_mov_b32 v[190:191], v[16:17], v[16:17]
  v_pk_mov_b32 v[192:193], v[16:17], v[16:17]
  v_pk_mov_b32 v[194:195], v[16:17], v[16:17]
  v_pk_mov_b32 v[196:197], v[16:17], v[16:17]
  v_pk_mov_b32 v[198:199], v[16:17], v[16:17]
  v_pk_mov_b32 v[200:201], v[16:17], v[16:17]
  v_pk_mov_b32 v[202:203], v[16:17], v[16:17]
  v_pk_mov_b32 v[204:205], v[16:17], v[16:17]
  v_pk_mov_b32 v[206:207], v[16:17], v[16:17]
  v_pk_mov_b32 v[208:209], v[16:17], v[16:17]
  v_pk_mov_b32 v[210:211], v[16:17], v[16:17]
  v_pk_mov_b32 v[212:213], v[16:17], v[16:17]
  v_pk_mov_b32 v[214:215], v[16:17], v[16:17]
  v_pk_mov_b32 v[216:217], v[16:17], v[16:17]
  v_pk_mov_b32 v[218:219], v[16:17], v[16:17]
  v_pk_mov_b32 v[220:221], v[16:17], v[16:17]
  v_pk_mov_b32 v[222:223], v[16:17], v[16:17]
  v_pk_mov_b32 v[224:225], v[16:17], v[16:17]
  v_pk_mov_b32 v[226:227], v[16:17], v[16:17]
  v_pk_mov_b32 v[228:229], v[16:17], v[16:17]
  v_pk_mov_b32 v[230:231], v[16:17], v[16:17]
  v_pk_mov_b32 v[232:233], v[16:17], v[16:17]
  v_pk_mov_b32 v[234:235], v[16:17], v[16:17]
  v_pk_mov_b32 v[236:237], v[16:17], v[16:17]
  v_pk_mov_b32 v[238:239], v[16:17], v[16:17]
  v_pk_mov_b32 v[240:241], v[16:17], v[16:17]
  v_pk_mov_b32 v[242:243], v[16:17], v[16:17]
  v_pk_mov_b32 v[244:245], v[16:17], v[16:17]
  v_pk_mov_b32 v[246:247], v[16:17], v[16:17]
  v_pk_mov_b32 v[84:85], v[16:17], v[16:17]
  v_pk_mov_b32 v[86:87], v[16:17], v[16:17]
  v_pk_mov_b32 v[88:89], v[16:17], v[16:17]
  v_pk_mov_b32 v[90:91], v[16:17], v[16:17]
  v_pk_mov_b32 v[92:93], v[16:17], v[16:17]
  v_pk_mov_b32 v[94:95], v[16:17], v[16:17]
  s_waitcnt lgkmcnt(0)
  s_cmp_eq_u32 s5, 0
  s_cselect_b32 s56, s20, s28
  s_cselect_b32 s57, s21, s29
  s_mov_b32 s58, 819200
  s_mov_b32 s59, 0x20000
  s_mov_b32 s44, s34
  s_mov_b32 s45, s35
  s_mov_b32 s46, 268435456
  s_mov_b32 s47, 0x20000
  s_mov_b32 s48, s32
  s_mov_b32 s49, s33
  s_mov_b32 s50, 256
  s_mov_b32 s51, 0x20000
  s_mov_b32 s52, s26
  s_mov_b32 s53, s27
  s_mov_b32 s54, 25600
  s_mov_b32 s55, 0x20000
  s_mov_b32 s60, s30
  s_mov_b32 s61, s31
  s_mov_b32 s62, 5242880
  s_mov_b32 s63, 0x20000
  s_lshl_b32 s77, s5, 4
  s_add_u32 s77, s77, s6
  s_lshl_b32 s76, s77, 2
  s_add_u32 s76, s76, s8
  s_lshl_b32 s76, s76, 8
  s_add_u32 s76, s76, 9437184
  s_lshl_b32 s77, s77, 2
  s_add_u32 s77, s77, 0
  s_mov_b32 s10, 0
  v_mov_b32 v74, 0
  v_add_u32 v73, 132, v0
  s_mov_b32 s100, 49152
  s_mov_b32 s101, 49152
  s_mov_b32 s11, -98304
  s_mov_b32 s14, 0
lz_70:
  ds_read_b32 v72, v0 offset:128
  s_waitcnt lgkmcnt(0)
  v_readfirstlane_b32 s9, v72
  s_nop 0
  s_cmp_eq_u32 s9, 0
  s_cbranch_scc1 lzok_71
  s_sleep 1
  s_add_u32 s14, s14, 1
  s_cmp_lt_u32 s14, 1048576
  s_cbranch_scc1 lz_70
lzok_71:
  ds_read_b128 v[56:59], v6 offset:6144
  ds_read_b128 v[60:63], v6 offset:8192
  ds_read_b128 v[76:79], v6
  ds_read_b64_tr_b16 v[16:17], v5 offset:18432
  ds_read_b64_tr_b16 v[18:19], v5 offset:19712
  ds_read_b64_tr_b16 v[20:21], v5 offset:18472
  ds_read_b64_tr_b16 v[22:23], v5 offset:19752
  ds_read_b64_tr_b16 v[24:25], v5 offset:18512
  ds_read_b64_tr_b16 v[26:27], v5 offset:19792
  ds_read_b64_tr_b16 v[28:29], v5 offset:18552
  ds_read_b64_tr_b16 v[30:31], v5 offset:19832
  ds_read_b64_tr_b16 v[32:33], v4 offset:18464
  ds_read_b64_tr_b16 v[34:35], v4 offset:19744
.p2align 3
gl_69:
  s_waitcnt lgkmcnt(6)
  v_mfma_f32_16x16x32_bf16 v[128:131], v[16:19], v[56:59], v[128:131]
  ds_read_b64_tr_b16 v[36:37], v5 offset:28672
  ds_read_b128 v[64:67], v7 offset:6144
  s_mov_b32 s13, s100
  v_mfma_f32_16x16x32_bf16 v[132:135], v[16:19], v[60:63], v[132:135]
  ds_read_b64_tr_b16 v[38:39], v5 offset:29952
  ds_read_b128 v[68:71], v7 offset:8192
  s_mov_b32 s100, s101
  v_mfma_f32_16x16x32_bf16 v[136:139], v[20:23], v[56:59], v[136:139]
  ds_read_b64_tr_b16 v[40:41], v5 offset:28712
  ds_read_b128 v[80:83], v7
  v_mfma_f32_16x16x32_bf16 v[140:143], v[20:23], v[60:63], v[140:143]
  ds_read_b64_tr_b16 v[42:43], v5 offset:29992
  s_waitcnt lgkmcnt(9)
  v_mfma_f32_16x16x32_bf16 v[144:147], v[24:27], v[56:59], v[144:147]
  ds_read_b64_tr_b16 v[44:45], v5 offset:28752
  s_mov_b32 s101, s11
  v_mfma_f32_16x16x32_bf16 v[148:151], v[24:27], v[60:63], v[148:151]
  ds_read_b64_tr_b16 v[46:47], v5 offset:30032
  s_mov_b32 s11, s13
  v_mfma_f32_16x16x32_bf16 v[152:155], v[28:31], v[56:59], v[152:155]
  ds_read_b64_tr_b16 v[48:49], v5 offset:28792
  v_add_u32 v7, s13, v7
  v_mfma_f32_16x16x32_bf16 v[156:159], v[28:31], v[60:63], v[156:159]
  ds_read_b64_tr_b16 v[50:51], v5 offset:30072
  s_waitcnt lgkmcnt(8)
  v_mfma_f32_16x16x32_bf16 v[160:163], v[32:35], v[56:59], v[160:163]
  ds_read_b64_tr_b16 v[52:53], v4 offset:28704
  ds_read_b32 v75, v73
  v_mfma_f32_16x16x32_bf16 v[164:167], v[32:35], v[60:63], v[164:167]
  ds_read_b64_tr_b16 v[54:55], v4 offset:29984
  v_mfma_f32_16x16x32_bf16 v[168:171], v[36:39], v[56:59], v[168:171]
  ds_read_b64_tr_b16 v[16:17], v5 offset:38912
  v_mfma_f32_16x16x32_bf16 v[172:175], v[36:39], v[60:63], v[172:175]
  ds_read_b64_tr_b16 v[18:19], v5 offset:40192
  s_waitcnt lgkmcnt(7)
  v_mfma_f32_16x16x32_bf16 v[176:179], v[40:43], v[56:59], v[176:179]
  ds_read_b64_tr_b16 v[20:21], v5 offset:38952
  v_mfma_f32_16x16x32_bf16 v[180:183], v[40:43], v[60:63], v[180:183]
  ds_read_b64_tr_b16 v[22:23], v5 offset:40232
  v_mfma_f32_16x16x32_bf16 v[184:187], v[44:47], v[56:59], v[184:187]
  ds_read_b64_tr_b16 v[24:25], v5 offset:38992
  v_mfma_f32_16x16x32_bf16 v[188:191], v[44:47], v[60:63], v[188:191]
  ds_read_b64_tr_b16 v[26:27], v5 offset:40272
  s_waitcnt lgkmcnt(6)
  v_mfma_f32_16x16x32_bf16 v[192:195], v[48:51], v[56:59], v[192:195]
  ds_read_b64_tr_b16 v[28:29], v5 offset:39032
  v_readfirstlane_b32 s12, v75
  v_mfma_f32_16x16x32_bf16 v[196:199], v[48:51], v[60:63], v[196:199]
  ds_read_b64_tr_b16 v[30:31], v5 offset:40312
  v_mfma_f32_16x16x32_bf16 v[84:87], v[48:51], v[76:79], v[84:87]
  v_add_u32 v74, 1, v74
  v_mfma_f32_16x16x32_bf16 v[200:203], v[52:55], v[56:59], v[200:203]
  ds_read_b64_tr_b16 v[32:33], v4 offset:38944
  v_mfma_f32_16x16x32_bf16 v[204:207], v[52:55], v[60:63], v[204:207]
  ds_read_b64_tr_b16 v[34:35], v4 offset:40224
  v_mfma_f32_16x16x32_bf16 v[88:91], v[52:55], v[76:79], v[88:91]
  s_cmp_eq_u32 s12, 0
  s_cbranch_scc0 slowb_74
backb_75:
  s_waitcnt lgkmcnt(6)
  v_mfma_f32_16x16x32_bf16 v[208:211], v[56:59], v[16:19], v[208:211]
  ds_read_b64_tr_b16 v[36:37], v5 offset:23552
  v_mfma_f32_16x16x32_bf16 v[212:215], v[60:63], v[16:19], v[212:215]
  ds_read_b64_tr_b16 v[38:39], v5 offset:24832
  v_mfma_f32_16x16x32_bf16 v[92:95], v[76:79], v[16:19], v[92:95]
  v_add_u32 v6, s13, v6
  v_mfma_f32_16x16x32_bf16 v[216:219], v[56:59], v[20:23], v[216:219]
  ds_read_b64_tr_b16 v[40:41], v5 offset:23592
  v_mfma_f32_16x16x32_bf16 v[220:223], v[60:63], v[20:23], v[220:223]
  ds_read_b64_tr_b16 v[42:43], v5 offset:24872
  s_waitcnt lgkmcnt(6)
  v_mfma_f32_16x16x32_bf16 v[224:227], v[56:59], v[24:27], v[224:227]
  ds_read_b64_tr_b16 v[44:45], v5 offset:23632
  v_mfma_f32_16x16x32_bf16 v[228:231], v[60:63], v[24:27], v[228:231]
  ds_read_b64_tr_b16 v[46:47], v5 offset:24912
  v_mfma_f32_16x16x32_bf16 v[232:235], v[56:59], v[28:31], v[232:235]
  ds_read_b64_tr_b16 v[48:49], v5 offset:23672
  v_mfma_f32_16x16x32_bf16 v[236:239], v[60:63], v[28:31], v[236:239]
  ds_read_b64_tr_b16 v[50:51], v5 offset:24952
  s_waitcnt lgkmcnt(6)
  v_mfma_f32_16x16x32_bf16 v[240:243], v[56:59], v[32:35], v[240:243]
  ds_read_b64_tr_b16 v[52:53], v4 offset:23584
  ds_write_b32 v14, v74
  v_mfma_f32_16x16x32_bf16 v[244:247], v[60:63], v[32:35], v[244:247]
  ds_read_b64_tr_b16 v[54:55], v4 offset:24864
  v_mfma_f32_16x16x32_bf16 v[128:131], v[36:39], v[64:67], v[128:131]
  ds_read_b64_tr_b16 v[16:17], v5 offset:33792
  v_mfma_f32_16x16x32_bf16 v[132:135], v[36:39], v[68:71], v[132:135]
  ds_read_b64_tr_b16 v[18:19], v5 offset:35072
  s_waitcnt lgkmcnt(7)
  v_mfma_f32_16x16x32_bf16 v[136:139], v[40:43], v[64:67], v[136:139]
  ds_read_b64_tr_b16 v[20:21], v5 offset:33832
  v_mfma_f32_16x16x32_bf16 v[140:143], v[40:43], v[68:71], v[140:143]
  ds_read_b64_tr_b16 v[22:23], v5 offset:35112
  v_mfma_f32_16x16x32_bf16 v[144:147], v[44:47], v[64:67], v[144:147]
  ds_read_b64_tr_b16 v[24:25], v5 offset:33872
  v_mfma_f32_16x16x32_bf16 v[148:151], v[44:47], v[68:71], v[148:151]
  ds_read_b64_tr_b16 v[26:27], v5 offset:35152
  s_waitcnt lgkmcnt(6)
  v_mfma_f32_16x16x32_bf16 v[152:155], v[48:51], v[64:67], v[152:155]
  ds_read_b64_tr_b16 v[28:29], v5 offset:33912
  v_mfma_f32_16x16x32_bf16 v[156:159], v[48:51], v[68:71], v[156:159]
  ds_read_b64_tr_b16 v[30:31], v5 offset:35192
  v_mfma_f32_16x16x32_bf16 v[160:163], v[52:55], v[64:67], v[160:163]
  ds_read_b64_tr_b16 v[32:33], v4 offset:33824
  v_mfma_f32_16x16x32_bf16 v[164:167], v[52:55], v[68:71], v[164:167]
  ds_read_b64_tr_b16 v[34:35], v4 offset:35104
  s_waitcnt lgkmcnt(6)
  v_mfma_f32_16x16x32_bf16 v[168:171], v[16:19], v[64:67], v[168:171]
  ds_read_b64_tr_b16 v[36:37], v5 offset:44032
  ds_read_b32 v72, v73 offset:4
  v_mfma_f32_16x16x32_bf16 v[172:175], v[16:19], v[68:71], v[172:175]
  ds_read_b64_tr_b16 v[38:39], v5 offset:45312
  v_mfma_f32_16x16x32_bf16 v[176:179], v[20:23], v[64:67], v[176:179]
  ds_read_b64_tr_b16 v[40:41], v5 offset:44072
  v_mfma_f32_16x16x32_bf16 v[180:183], v[20:23], v[68:71], v[180:183]
  ds_read_b64_tr_b16 v[42:43], v5 offset:45352
  s_waitcnt lgkmcnt(7)
  v_mfma_f32_16x16x32_bf16 v[184:187], v[24:27], v[64:67], v[184:187]
  ds_read_b64_tr_b16 v[44:45], v5 offset:44112
  v_mfma_f32_16x16x32_bf16 v[188:191], v[24:27], v[68:71], v[188:191]
  ds_read_b64_tr_b16 v[46:47], v5 offset:45392
  v_mfma_f32_16x16x32_bf16 v[192:195], v[28:31], v[64:67], v[192:195]
  ds_read_b64_tr_b16 v[48:49], v5 offset:44152
  v_mfma_f32_16x16x32_bf16 v[196:199], v[28:31], v[68:71], v[196:199]
  ds_read_b64_tr_b16 v[50:51], v5 offset:45432
  v_add_u32 v5, s13, v5
  v_mfma_f32_16x16x32_bf16 v[84:87], v[28:31], v[80:83], v[84:87]
  s_waitcnt lgkmcnt(6)
  v_mfma_f32_16x16x32_bf16 v[200:203], v[32:35], v[64:67], v[200:203]
  ds_read_b64_tr_b16 v[52:53], v4 offset:44064
  v_readfirstlane_b32 s9, v72
  v_mfma_f32_16x16x32_bf16 v[204:207], v[32:35], v[68:71], v[204:207]
  ds_read_b64_tr_b16 v[54:55], v4 offset:45344
  v_add_u32 v4, s13, v4
  v_mfma_f32_16x16x32_bf16 v[88:91], v[32:35], v[80:83], v[88:91]
  v_add_u32 v74, 1, v74
  s_cmp_eq_u32 s9, 0
  s_cbranch_scc0 slow_72
back_73:
  v_mfma_f32_16x16x32_bf16 v[208:211], v[64:67], v[36:39], v[208:211]
  ds_read_b64_tr_b16 v[16:17], v5 offset:18432
  ds_read_b128 v[56:59], v6 offset:6144
  v_mfma_f32_16x16x32_bf16 v[212:215], v[68:71], v[36:39], v[212:215]
  ds_read_b64_tr_b16 v[18:19], v5 offset:19712
  ds_read_b128 v[60:63], v6 offset:8192
  v_mfma_f32_16x16x32_bf16 v[92:95], v[80:83], v[36:39], v[92:95]
  ds_read_b128 v[76:79], v6
  s_waitcnt lgkmcnt(9)
  v_mfma_f32_16x16x32_bf16 v[216:219], v[64:67], v[40:43], v[216:219]
  ds_read_b64_tr_b16 v[20:21], v5 offset:18472
  v_add_u32 v73, 8, v73
  v_mfma_f32_16x16x32_bf16 v[220:223], v[68:71], v[40:43], v[220:223]
  ds_read_b64_tr_b16 v[22:23], v5 offset:19752
  s_add_u32 s10, s10, 1
  v_mfma_f32_16x16x32_bf16 v[224:227], v[64:67], v[44:47], v[224:227]
  ds_read_b64_tr_b16 v[24:25], v5 offset:18512
  v_mfma_f32_16x16x32_bf16 v[228:231], v[68:71], v[44:47], v[228:231]
  ds_read_b64_tr_b16 v[26:27], v5 offset:19792
  s_waitcnt lgkmcnt(9)
  v_mfma_f32_16x16x32_bf16 v[232:235], v[64:67], v[48:51], v[232:235]
  ds_read_b64_tr_b16 v[28:29], v5 offset:18552
  ds_write_b32 v14, v74
  v_mfma_f32_16x16x32_bf16 v[236:239], v[68:71], v[48:51], v[236:239]
  ds_read_b64_tr_b16 v[30:31], v5 offset:19832
  v_mfma_f32_16x16x32_bf16 v[240:243], v[64:67], v[52:55], v[240:243]
  ds_read_b64_tr_b16 v[32:33], v4 offset:18464
  v_mfma_f32_16x16x32_bf16 v[244:247], v[68:71], v[52:55], v[244:247]
  ds_read_b64_tr_b16 v[34:35], v4 offset:19744
  s_cmp_lt_u32 s10, 10
  s_cbranch_scc1 gl_69
  s_waitcnt lgkmcnt(0)
  s_branch gd_76
slow_72:
  s_mov_b32 s14, 0
lz_77:
  ds_read_b32 v72, v73 offset:4
  s_waitcnt lgkmcnt(0)
  v_readfirstlane_b32 s9, v72
  s_nop 0
  s_cmp_eq_u32 s9, 0
  s_cbranch_scc1 lzok_78
  s_add_u32 s14, s14, 1
  s_cmp_lt_u32 s14, 1048576
  s_cbranch_scc1 lz_77
lzok_78:
  s_branch back_73
slowb_74:
  s_mov_b32 s14, 0
lz_79:
  ds_read_b32 v72, v73 offset:0
  s_waitcnt lgkmcnt(0)
  v_readfirstlane_b32 s9, v72
  s_nop 0
  s_cmp_eq_u32 s9, 0
  s_cbranch_scc1 lzok_80
  s_add_u32 s14, s14, 1
  s_cmp_lt_u32 s14, 1048576
  s_cbranch_scc1 lz_79
lzok_80:
  s_branch backb_75
gd_76:
  v_lshlrev_b32 v8, 4, v1
  v_lshlrev_b32 v9, 3, v1
  v_cvt_pk_bf16_f32 v16, v84, v85
  v_cvt_pk_bf16_f32 v17, v86, v87
  v_cvt_pk_bf16_f32 v18, v88, v89
  v_cvt_pk_bf16_f32 v19, v90, v91
  v_cvt_pk_bf16_f32 v20, v92, v93
  v_cvt_pk_bf16_f32 v21, v94, v95
  s_mov_b32 s14, 0
lw_81:
  ds_read_b128 v[248:251], v0 offset:16
  s_waitcnt lgkmcnt(0)
  v_min3_u32 v248, v248, v249, v250
  v_min_u32 v248, v248, v251
  s_nop 0
  v_readfirstlane_b32 s9, v248
  s_nop 0
  s_cmp_ge_u32 s9, 16
  s_cbranch_scc1 lwok_82
  s_sleep 1
  s_add_u32 s14, s14, 1
  s_cmp_lt_u32 s14, 1048576
  s_cbranch_scc1 lw_81
lwok_82:
  ds_write_b64 v8, v[16:17] offset:54272
  ds_write_b64 v8, v[18:19] offset:51208
  ds_write_b64 v8, v[18:19] offset:52232
  ds_write_b64 v8, v[18:19] offset:53256
  ds_write_b64 v8, v[18:19] offset:54280
  ds_write_b64 v9, v[20:21] offset:55296
  v_mov_b32 v12, 1
  s_mov_b64 exec, 1
  ds_add_u32 v0, v12 offset:48
  s_mov_b64 exec, -1
  s_branch k_Aep
k_A2:
  v_bfe_u32 v8, v1, 2, 2
  v_and_b32 v9, 3, v1
  v_lshrrev_b32 v10, 1, v2
  v_lshlrev_b32 v10, 4, v10
  v_and_b32 v11, 1, v2
  v_lshl_add_u32 v10, v11, 2, v10
  v_add_u32 v10, v10, v8
  v_mul_u32_u24 v11, 160, v10
  v_mad_u32_u24 v4, v9, 40, v11
  v_lshl_add_u32 v5, v9, 3, v11
  s_lshl_b32 s9, s8, 5
  s_cmp_eq_u32 s5, 0
  s_cselect_b32 s9, 0, s9
  v_lshrrev_b32 v11, 1, v3
  v_xor_b32 v11, v11, v2
  v_lshlrev_b32 v11, 4, v11
  v_add_u32 v12, s9, v3
  v_lshl_add_u32 v6, v12, 7, v11
  v_xor_b32 v7, 64, v6
  s_lshl_b32 s9, s8, 2
  s_add_u32 s9, s9, 16
  v_add_u32 v14, s9, v0
  v_mov_b32 v16, 0
  v_mov_b32 v17, 0
  v_pk_mov_b32 v[128:129], v[16:17], v[16:17]
  v_pk_mov_b32 v[130:131], v[16:17], v[16:17]
  v_pk_mov_b32 v[132:133], v[16:17], v[16:17]
  v_pk_mov_b32 v[134:135], v[16:17], v[16:17]
  v_pk_mov_b32 v[136:137], v[16:17], v[16:17]
  v_pk_mov_b32 v[138:139], v[16:17], v[16:17]
  v_pk_mov_b32 v[140:141], v[16:17], v[16:17]
  v_pk_mov_b32 v[142:143], v[16:17], v[16:17]
  v_pk_mov_b32 v[144:145], v[16:17], v[16:17]
  v_pk_mov_b32 v[146:147], v[16:17], v[16:17]
  v_pk_mov_b32 v[148:149], v[16:17], v[16:17]
  v_pk_mov_b32 v[150:151], v[16:17], v[16:17]
  v_pk_mov_b32 v[152:153], v[16:17], v[16:17]
  v_pk_mov_b32 v[154:155], v[16:17], v[16:17]
  v_pk_mov_b32 v[156:157], v[16:17], v[16:17]
  v_pk_mov_b32 v[158:159], v[16:17], v[16:17]
  v_pk_mov_b32 v[160:161], v[16:17], v[16:17]
  v_pk_mov_b32 v[162:163], v[16:17], v[16:17]
  v_pk_mov_b32 v[164:165], v[16:17], v[16:17]
  v_pk_mov_b32 v[166:167], v[16:17], v[16:17]
  v_pk_mov_b32 v[168:169], v[16:17], v[16:17]
  v_pk_mov_b32 v[170:171], v[16:17], v[16:17]
  v_pk_mov_b32 v[172:173], v[16:17], v[16:17]
  v_pk_mov_b32 v[174:175], v[16:17], v[16:17]
  v_pk_mov_b32 v[176:177], v[16:17], v[16:17]
  v_pk_mov_b32 v[178:179], v[16:17], v[16:17]
  v_pk_mov_b32 v[180:181], v[16:17], v[16:17]
  v_pk_mov_b32 v[182:183], v[16:17], v[16:17]
  v_pk_mov_b32 v[184:185], v[16:17], v[16:17]
  v_pk_mov_b32 v[186:187], v[16:17], v[16:17]
  v_pk_mov_b32 v[188:189], v[16:17], v[16:17]
  v_pk_mov_b32 v[190:191], v[16:17], v[16:17]
  v_pk_mov_b32 v[192:193], v[16:17], v[16:17]
  v_pk_mov_b32 v[194:195], v[16:17], v[16:17]
  v_pk_mov_b32 v[196:197], v[16:17], v[16:17]
  v_pk_mov_b32 v[198:199], v[16:17], v[16:17]
  v_pk_mov_b32 v[200:201], v[16:17], v[16:17]
  v_pk_mov_b32 v[202:203], v[16:17], v[16:17]
  v_pk_mov_b32 v[204:205], v[16:17], v[16:17]
  v_pk_mov_b32 v[206:207], v[16:17], v[16:17]
  v_pk_mov_b32 v[208:209], v[16:17], v[16:17]
  v_pk_mov_b32 v[210:211], v[16:17], v[16:17]
  v_pk_mov_b32 v[212:213], v[16:17], v[16:17]
  v_pk_mov_b32 v[214:215], v[16:17], v[16:17]
  v_pk_mov_b32 v[216:217], v[16:17], v[16:17]
  v_pk_mov_b32 v[218:219], v[16:17], v[16:17]
  v_pk_mov_b32 v[220:221], v[16:17], v[16:17]
  v_pk_mov_b32 v[222:223], v[16:17], v[16:17]
  v_pk_mov_b32 v[224:225], v[16:17], v[16:17]
  v_pk_mov_b32 v[226:227], v[16:17], v[16:17]
  v_pk_mov_b32 v[228:229], v[16:17], v[16:17]
  v_pk_mov_b32 v[230:231], v[16:17], v[16:17]
  v_pk_mov_b32 v[232:233], v[16:17], v[16:17]
  v_pk_mov_b32 v[234:235], v[16:17], v[16:17]
  v_pk_mov_b32 v[236:237], v[16:17], v[16:17]
  v_pk_mov_b32 v[238:239], v[16:17], v[16:17]
  v_pk_mov_b32 v[240:241], v[16:17], v[16:17]
  v_pk_mov_b32 v[242:243], v[16:17], v[16:17]
  v_pk_mov_b32 v[244:245], v[16:17], v[16:17]
  v_pk_mov_b32 v[246:247], v[16:17], v[16:17]
  v_pk_mov_b32 v[84:85], v[16:17], v[16:17]
  v_pk_mov_b32 v[86:87], v[16:17], v[16:17]
  v_pk_mov_b32 v[88:89], v[16:17], v[16:17]
  v_pk_mov_b32 v[90:91], v[16:17], v[16:17]
  v_pk_mov_b32 v[92:93], v[16:17], v[16:17]
  v_pk_mov_b32 v[94:95], v[16:17], v[16:17]
  s_waitcnt lgkmcnt(0)
  s_cmp_eq_u32 s5, 0
  s_cselect_b32 s56, s20, s28
  s_cselect_b32 s57, s21, s29
  s_mov_b32 s58, 819200
  s_mov_b32 s59, 0x20000
  s_mov_b32 s44, s34
  s_mov_b32 s45, s35
  s_mov_b32 s46, 268435456
  s_mov_b32 s47, 0x20000
  s_mov_b32 s48, s32
  s_mov_b32 s49, s33
  s_mov_b32 s50, 256
  s_mov_b32 s51, 0x20000
  s_mov_b32 s52, s26
  s_mov_b32 s53, s27
  s_mov_b32 s54, 25600
  s_mov_b32 s55, 0x20000
  s_mov_b32 s60, s30
  s_mov_b32 s61, s31
  s_mov_b32 s62, 5242880
  s_mov_b32 s63, 0x20000
  s_lshl_b32 s77, s5, 4
  s_add_u32 s77, s77, s6
  s_lshl_b32 s76, s77, 2
  s_add_u32 s76, s76, s8
  s_lshl_b32 s76, s76, 8
  s_add_u32 s76, s76, 9437184
  s_lshl_b32 s77, s77, 2
  s_add_u32 s77, s77, 0
  s_mov_b32 s10, 0
  v_mov_b32 v74, 0
  v_add_u32 v73, 132, v0
  s_mov_b32 s100, 49152
  s_mov_b32 s101, 49152
  s_mov_b32 s11, -98304
  s_mov_b32 s14, 0
lz_84:
  ds_read_b32 v72, v0 offset:128
  s_waitcnt lgkmcnt(0)
  v_readfirstlane_b32 s9, v72
  s_nop 0
  s_cmp_eq_u32 s9, 0
  s_cbranch_scc1 lzok_85
  s_sleep 1
  s_add_u32 s14, s14, 1
  s_cmp_lt_u32 s14, 1048576
  s_cbranch_scc1 lz_84
lzok_85:
  ds_read_b128 v[56:59], v6 offset:10240
  ds_read_b128 v[60:63], v6 offset:12288
  ds_read_b128 v[76:79], v6
  ds_read_b64_tr_b16 v[16:17], v5 offset:18432
  ds_read_b64_tr_b16 v[18:19], v5 offset:19712
  ds_read_b64_tr_b16 v[20:21], v5 offset:18472
  ds_read_b64_tr_b16 v[22:23], v5 offset:19752
  ds_read_b64_tr_b16 v[24:25], v5 offset:18512
  ds_read_b64_tr_b16 v[26:27], v5 offset:19792
  ds_read_b64_tr_b16 v[28:29], v5 offset:18552
  ds_read_b64_tr_b16 v[30:31], v5 offset:19832
  ds_read_b64_tr_b16 v[32:33], v4 offset:18464
  ds_read_b64_tr_b16 v[34:35], v4 offset:19744
.p2align 3
gl_83:
  s_waitcnt lgkmcnt(6)
  v_mfma_f32_16x16x32_bf16 v[128:131], v[16:19], v[56:59], v[128:131]
  ds_read_b64_tr_b16 v[36:37], v5 offset:28672
  ds_read_b128 v[64:67], v7 offset:10240
  s_mov_b32 s13, s100
  v_mfma_f32_16x16x32_bf16 v[132:135], v[16:19], v[60:63], v[132:135]
  ds_read_b64_tr_b16 v[38:39], v5 offset:29952
  ds_read_b128 v[68:71], v7 offset:12288
  s_mov_b32 s100, s101
  v_mfma_f32_16x16x32_bf16 v[136:139], v[20:23], v[56:59], v[136:139]
  ds_read_b64_tr_b16 v[40:41], v5 offset:28712
  ds_read_b128 v[80:83], v7
  v_mfma_f32_16x16x32_bf16 v[140:143], v[20:23], v[60:63], v[140:143]
  ds_read_b64_tr_b16 v[42:43], v5 offset:29992
  s_waitcnt lgkmcnt(9)
  v_mfma_f32_16x16x32_bf16 v[144:147], v[24:27], v[56:59], v[144:147]
  ds_read_b64_tr_b16 v[44:45], v5 offset:28752
  s_mov_b32 s101, s11
  v_mfma_f32_16x16x32_bf16 v[148:151], v[24:27], v[60:63], v[148:151]
  ds_read_b64_tr_b16 v[46:47], v5 offset:30032
  s_mov_b32 s11, s13
  v_mfma_f32_16x16x32_bf16 v[152:155], v[28:31], v[56:59], v[152:155]
  ds_read_b64_tr_b16 v[48:49], v5 offset:28792
  v_add_u32 v6, s13, v6
  v_mfma_f32_16x16x32_bf16 v[156:159], v[28:31], v[60:63], v[156:159]
  ds_read_b64_tr_b16 v[50:51], v5 offset:30072
  s_waitcnt lgkmcnt(8)
  v_mfma_f32_16x16x32_bf16 v[160:163], v[32:35], v[56:59], v[160:163]
  ds_read_b64_tr_b16 v[52:53], v4 offset:28704
  ds_read_b32 v75, v73
  v_mfma_f32_16x16x32_bf16 v[164:167], v[32:35], v[60:63], v[164:167]
  ds_read_b64_tr_b16 v[54:55], v4 offset:29984
  v_add_u32 v7, s13, v7
  v_mfma_f32_16x16x32_bf16 v[168:171], v[36:39], v[56:59], v[168:171]
  ds_read_b64_tr_b16 v[16:17], v5 offset:38912
  v_mfma_f32_16x16x32_bf16 v[172:175], v[36:39], v[60:63], v[172:175]
  ds_read_b64_tr_b16 v[18:19], v5 offset:40192
  s_waitcnt lgkmcnt(7)
  v_mfma_f32_16x16x32_bf16 v[176:179], v[40:43], v[56:59], v[176:179]
  ds_read_b64_tr_b16 v[20:21], v5 offset:38952
  v_mfma_f32_16x16x32_bf16 v[180:183], v[40:43], v[60:63], v[180:183]
  ds_read_b64_tr_b16 v[22:23], v5 offset:40232
  v_mfma_f32_16x16x32_bf16 v[184:187], v[44:47], v[56:59], v[184:187]
  ds_read_b64_tr_b16 v[24:25], v5 offset:38992
  v_mfma_f32_16x16x32_bf16 v[188:191], v[44:47], v[60:63], v[188:191]
  ds_read_b64_tr_b16 v[26:27], v5 offset:40272
  s_waitcnt lgkmcnt(6)
  v_mfma_f32_16x16x32_bf16 v[192:195], v[48:51], v[56:59], v[192:195]
  ds_read_b64_tr_b16 v[28:29], v5 offset:39032
  v_readfirstlane_b32 s12, v75
  v_mfma_f32_16x16x32_bf16 v[196:199], v[48:51], v[60:63], v[196:199]
  ds_read_b64_tr_b16 v[30:31], v5 offset:40312
  v_mfma_f32_16x16x32_bf16 v[200:203], v[52:55], v[56:59], v[200:203]
  ds_read_b64_tr_b16 v[32:33], v4 offset:38944
  v_mfma_f32_16x16x32_bf16 v[204:207], v[52:55], v[60:63], v[204:207]
  ds_read_b64_tr_b16 v[34:35], v4 offset:40224
  s_cmp_eq_u32 s12, 0
  s_cbranch_scc0 slowb_88
backb_89:
  s_waitcnt lgkmcnt(6)
  v_mfma_f32_16x16x32_bf16 v[208:211], v[56:59], v[16:19], v[208:211]
  ds_read_b64_tr_b16 v[36:37], v5 offset:23552
  v_mfma_f32_16x16x32_bf16 v[212:215], v[60:63], v[16:19], v[212:215]
  ds_read_b64_tr_b16 v[38:39], v5 offset:24832
  v_mfma_f32_16x16x32_bf16 v[216:219], v[56:59], v[20:23], v[216:219]
  ds_read_b64_tr_b16 v[40:41], v5 offset:23592
  v_mfma_f32_16x16x32_bf16 v[220:223], v[60:63], v[20:23], v[220:223]
  ds_read_b64_tr_b16 v[42:43], v5 offset:24872
  v_mfma_f32_16x16x32_bf16 v[84:87], v[76:79], v[20:23], v[84:87]
  s_waitcnt lgkmcnt(6)
  v_mfma_f32_16x16x32_bf16 v[224:227], v[56:59], v[24:27], v[224:227]
  ds_read_b64_tr_b16 v[44:45], v5 offset:23632
  v_mfma_f32_16x16x32_bf16 v[228:231], v[60:63], v[24:27], v[228:231]
  ds_read_b64_tr_b16 v[46:47], v5 offset:24912
  v_mfma_f32_16x16x32_bf16 v[88:91], v[76:79], v[24:27], v[88:91]
  v_add_u32 v74, 1, v74
  v_mfma_f32_16x16x32_bf16 v[232:235], v[56:59], v[28:31], v[232:235]
  ds_read_b64_tr_b16 v[48:49], v5 offset:23672
  v_mfma_f32_16x16x32_bf16 v[236:239], v[60:63], v[28:31], v[236:239]
  ds_read_b64_tr_b16 v[50:51], v5 offset:24952
  s_waitcnt lgkmcnt(6)
  v_mfma_f32_16x16x32_bf16 v[240:243], v[56:59], v[32:35], v[240:243]
  ds_read_b64_tr_b16 v[52:53], v4 offset:23584
  ds_write_b32 v14, v74
  v_mfma_f32_16x16x32_bf16 v[244:247], v[60:63], v[32:35], v[244:247]
  ds_read_b64_tr_b16 v[54:55], v4 offset:24864
  v_mfma_f32_16x16x32_bf16 v[128:131], v[36:39], v[64:67], v[128:131]
  ds_read_b64_tr_b16 v[16:17], v5 offset:33792
  v_mfma_f32_16x16x32_bf16 v[132:135], v[36:39], v[68:71], v[132:135]
  ds_read_b64_tr_b16 v[18:19], v5 offset:35072
  s_waitcnt lgkmcnt(7)
  v_mfma_f32_16x16x32_bf16 v[136:139], v[40:43], v[64:67], v[136:139]
  ds_read_b64_tr_b16 v[20:21], v5 offset:33832
  v_mfma_f32_16x16x32_bf16 v[140:143], v[40:43], v[68:71], v[140:143]
  ds_read_b64_tr_b16 v[22:23], v5 offset:35112
  v_mfma_f32_16x16x32_bf16 v[144:147], v[44:47], v[64:67], v[144:147]
  ds_read_b64_tr_b16 v[24:25], v5 offset:33872
  v_mfma_f32_16x16x32_bf16 v[148:151], v[44:47], v[68:71], v[148:151]
  ds_read_b64_tr_b16 v[26:27], v5 offset:35152
  s_waitcnt lgkmcnt(6)
  v_mfma_f32_16x16x32_bf16 v[152:155], v[48:51], v[64:67], v[152:155]
  ds_read_b64_tr_b16 v[28:29], v5 offset:33912
  v_mfma_f32_16x16x32_bf16 v[156:159], v[48:51], v[68:71], v[156:159]
  ds_read_b64_tr_b16 v[30:31], v5 offset:35192
  v_mfma_f32_16x16x32_bf16 v[160:163], v[52:55], v[64:67], v[160:163]
  ds_read_b64_tr_b16 v[32:33], v4 offset:33824
  v_mfma_f32_16x16x32_bf16 v[164:167], v[52:55], v[68:71], v[164:167]
  ds_read_b64_tr_b16 v[34:35], v4 offset:35104
  s_waitcnt lgkmcnt(6)
  v_mfma_f32_16x16x32_bf16 v[168:171], v[16:19], v[64:67], v[168:171]
  ds_read_b64_tr_b16 v[36:37], v5 offset:44032
  ds_read_b32 v72, v73 offset:4
  v_mfma_f32_16x16x32_bf16 v[172:175], v[16:19], v[68:71], v[172:175]
  ds_read_b64_tr_b16 v[38:39], v5 offset:45312
  v_mfma_f32_16x16x32_bf16 v[176:179], v[20:23], v[64:67], v[176:179]
  ds_read_b64_tr_b16 v[40:41], v5 offset:44072
  v_mfma_f32_16x16x32_bf16 v[180:183], v[20:23], v[68:71], v[180:183]
  ds_read_b64_tr_b16 v[42:43], v5 offset:45352
  s_waitcnt lgkmcnt(7)
  v_mfma_f32_16x16x32_bf16 v[184:187], v[24:27], v[64:67], v[184:187]
  ds_read_b64_tr_b16 v[44:45], v5 offset:44112
  v_mfma_f32_16x16x32_bf16 v[188:191], v[24:27], v[68:71], v[188:191]
  ds_read_b64_tr_b16 v[46:47], v5 offset:45392
  v_mfma_f32_16x16x32_bf16 v[192:195], v[28:31], v[64:67], v[192:195]
  ds_read_b64_tr_b16 v[48:49], v5 offset:44152
  v_mfma_f32_16x16x32_bf16 v[196:199], v[28:31], v[68:71], v[196:199]
  ds_read_b64_tr_b16 v[50:51], v5 offset:45432
  v_add_u32 v5, s13, v5
  s_waitcnt lgkmcnt(6)
  v_mfma_f32_16x16x32_bf16 v[200:203], v[32:35], v[64:67], v[200:203]
  ds_read_b64_tr_b16 v[52:53], v4 offset:44064
  v_readfirstlane_b32 s9, v72
  v_mfma_f32_16x16x32_bf16 v[204:207], v[32:35], v[68:71], v[204:207]
  ds_read_b64_tr_b16 v[54:55], v4 offset:45344
  v_add_u32 v4, s13, v4
  s_cmp_eq_u32 s9, 0
  s_cbranch_scc0 slow_86
back_87:
  v_mfma_f32_16x16x32_bf16 v[208:211], v[64:67], v[36:39], v[208:211]
  ds_read_b64_tr_b16 v[16:17], v5 offset:18432
  ds_read_b128 v[56:59], v6 offset:10240
  ds_read_b128 v[60:63], v6 offset:12288
  v_mfma_f32_16x16x32_bf16 v[212:215], v[68:71], v[36:39], v[212:215]
  ds_read_b64_tr_b16 v[18:19], v5 offset:19712
  ds_read_b128 v[76:79], v6
  s_waitcnt lgkmcnt(9)
  v_mfma_f32_16x16x32_bf16 v[216:219], v[64:67], v[40:43], v[216:219]
  ds_read_b64_tr_b16 v[20:21], v5 offset:18472
  v_add_u32 v73, 8, v73
  v_mfma_f32_16x16x32_bf16 v[220:223], v[68:71], v[40:43], v[220:223]
  ds_read_b64_tr_b16 v[22:23], v5 offset:19752
  s_add_u32 s10, s10, 1
  v_mfma_f32_16x16x32_bf16 v[84:87], v[80:83], v[40:43], v[84:87]
  v_add_u32 v74, 1, v74
  v_mfma_f32_16x16x32_bf16 v[224:227], v[64:67], v[44:47], v[224:227]
  ds_read_b64_tr_b16 v[24:25], v5 offset:18512
  v_mfma_f32_16x16x32_bf16 v[228:231], v[68:71], v[44:47], v[228:231]
  ds_read_b64_tr_b16 v[26:27], v5 offset:19792
  v_mfma_f32_16x16x32_bf16 v[88:91], v[80:83], v[44:47], v[88:91]
  s_waitcnt lgkmcnt(9)
  v_mfma_f32_16x16x32_bf16 v[232:235], v[64:67], v[48:51], v[232:235]
  ds_read_b64_tr_b16 v[28:29], v5 offset:18552
  ds_write_b32 v14, v74
  v_mfma_f32_16x16x32_bf16 v[236:239], v[68:71], v[48:51], v[236:239]
  ds_read_b64_tr_b16 v[30:31], v5 offset:19832
  v_mfma_f32_16x16x32_bf16 v[240:243], v[64:67], v[52:55], v[240:243]
  ds_read_b64_tr_b16 v[32:33], v4 offset:18464
  v_mfma_f32_16x16x32_bf16 v[244:247], v[68:71], v[52:55], v[244:247]
  ds_read_b64_tr_b16 v[34:35], v4 offset:19744
  s_cmp_lt_u32 s10, 10
  s_cbranch_scc1 gl_83
  s_waitcnt lgkmcnt(0)
  s_branch gd_90
slow_86:
  s_mov_b32 s14, 0
lz_91:
  ds_read_b32 v72, v73 offset:4
  s_waitcnt lgkmcnt(0)
  v_readfirstlane_b32 s9, v72
  s_nop 0
  s_cmp_eq_u32 s9, 0
  s_cbranch_scc1 lzok_92
  s_add_u32 s14, s14, 1
  s_cmp_lt_u32 s14, 1048576
  s_cbranch_scc1 lz_91
lzok_92:
  s_branch back_87
slowb_88:
  s_mov_b32 s14, 0
lz_93:
  ds_read_b32 v72, v73 offset:0
  s_waitcnt lgkmcnt(0)
  v_readfirstlane_b32 s9, v72
  s_nop 0
  s_cmp_eq_u32 s9, 0
  s_cbranch_scc1 lzok_94
  s_add_u32 s14, s14, 1
  s_cmp_lt_u32 s14, 1048576
  s_cbranch_scc1 lz_93
lzok_94:
  s_branch backb_89
gd_90:
  v_lshlrev_b32 v8, 4, v1
  v_lshlrev_b32 v9, 3, v1
  v_cvt_pk_bf16_f32 v16, v84, v85
  v_cvt_pk_bf16_f32 v17, v86, v87
  v_cvt_pk_bf16_f32 v18, v88, v89
  v_cvt_pk_bf16_f32 v19, v90, v91
  s_mov_b32 s14, 0
lw_95:
  ds_read_b128 v[248:251], v0 offset:16
  s_waitcnt lgkmcnt(0)
  v_min3_u32 v248, v248, v249, v250
  v_min_u32 v248, v248, v251
  s_nop 0
  v_readfirstlane_b32 s9, v248
  s_nop 0
  s_cmp_ge_u32 s9, 16
  s_cbranch_scc1 lwok_96
  s_sleep 1
  s_add_u32 s14, s14, 1
  s_cmp_lt_u32 s14, 1048576
  s_cbranch_scc1 lw_95
lwok_96:
  ds_write_b64 v9, v[16:17] offset:55808
  ds_write_b64 v9, v[18:19] offset:56320
  v_mov_b32 v12, 1
  s_mov_b64 exec, 1
  ds_add_u32 v0, v12 offset:48
  s_mov_b64 exec, -1
  s_branch k_Aep
k_A3:
  v_bfe_u32 v8, v1, 2, 2
  v_and_b32 v9, 3, v1
  v_lshrrev_b32 v10, 1, v2
  v_lshlrev_b32 v10, 4, v10
  v_and_b32 v11, 1, v2
  v_lshl_add_u32 v10, v11, 2, v10
  v_add_u32 v10, v10, v8
  v_mul_u32_u24 v11, 160, v10
  v_mad_u32_u24 v4, v9, 40, v11
  v_lshl_add_u32 v5, v9, 3, v11
  s_lshl_b32 s9, s8, 5
  s_cmp_eq_u32 s5, 0
  s_cselect_b32 s9, 0, s9
  v_lshrrev_b32 v11, 1, v3
  v_xor_b32 v11, v11, v2
  v_lshlrev_b32 v11, 4, v11
  v_add_u32 v12, s9, v3
  v_lshl_add_u32 v6, v12, 7, v11
  v_xor_b32 v7, 64, v6
  s_lshl_b32 s9, s8, 2
  s_add_u32 s9, s9, 16
  v_add_u32 v14, s9, v0
  v_mov_b32 v16, 0
  v_mov_b32 v17, 0
  v_pk_mov_b32 v[128:129], v[16:17], v[16:17]
  v_pk_mov_b32 v[130:131], v[16:17], v[16:17]
  v_pk_mov_b32 v[132:133], v[16:17], v[16:17]
  v_pk_mov_b32 v[134:135], v[16:17], v[16:17]
  v_pk_mov_b32 v[136:137], v[16:17], v[16:17]
  v_pk_mov_b32 v[138:139], v[16:17], v[16:17]
  v_pk_mov_b32 v[140:141], v[16:17], v[16:17]
  v_pk_mov_b32 v[142:143], v[16:17], v[16:17]
  v_pk_mov_b32 v[144:145], v[16:17], v[16:17]
  v_pk_mov_b32 v[146:147], v[16:17], v[16:17]
  v_pk_mov_b32 v[148:149], v[16:17], v[16:17]
  v_pk_mov_b32 v[150:151], v[16:17], v[16:17]
  v_pk_mov_b32 v[152:153], v[16:17], v[16:17]
  v_pk_mov_b32 v[154:155], v[16:17], v[16:17]
  v_pk_mov_b32 v[156:157], v[16:17], v[16:17]
  v_pk_mov_b32 v[158:159], v[16:17], v[16:17]
  v_pk_mov_b32 v[160:161], v[16:17], v[16:17]
  v_pk_mov_b32 v[162:163], v[16:17], v[16:17]
  v_pk_mov_b32 v[164:165], v[16:17], v[16:17]
  v_pk_mov_b32 v[166:167], v[16:17], v[16:17]
  v_pk_mov_b32 v[168:169], v[16:17], v[16:17]
  v_pk_mov_b32 v[170:171], v[16:17], v[16:17]
  v_pk_mov_b32 v[172:173], v[16:17], v[16:17]
  v_pk_mov_b32 v[174:175], v[16:17], v[16:17]
  v_pk_mov_b32 v[176:177], v[16:17], v[16:17]
  v_pk_mov_b32 v[178:179], v[16:17], v[16:17]
  v_pk_mov_b32 v[180:181], v[16:17], v[16:17]
  v_pk_mov_b32 v[182:183], v[16:17], v[16:17]
  v_pk_mov_b32 v[184:185], v[16:17], v[16:17]
  v_pk_mov_b32 v[186:187], v[16:17], v[16:17]
  v_pk_mov_b32 v[188:189], v[16:17], v[16:17]
  v_pk_mov_b32 v[190:191], v[16:17], v[16:17]
  v_pk_mov_b32 v[192:193], v[16:17], v[16:17]
  v_pk_mov_b32 v[194:195], v[16:17], v[16:17]
  v_pk_mov_b32 v[196:197], v[16:17], v[16:17]
  v_pk_mov_b32 v[198:199], v[16:17], v[16:17]
  v_pk_mov_b32 v[200:201], v[16:17], v[16:17]
  v_pk_mov_b32 v[202:203], v[16:17], v[16:17]
  v_pk_mov_b32 v[204:205], v[16:17], v[16:17]
  v_pk_mov_b32 v[206:207], v[16:17], v[16:17]
  v_pk_mov_b32 v[208:209], v[16:17], v[16:17]
  v_pk_mov_b32 v[210:211], v[16:17], v[16:17]
  v_pk_mov_b32 v[212:213], v[16:17], v[16:17]
  v_pk_mov_b32 v[214:215], v[16:17], v[16:17]
  v_pk_mov_b32 v[216:217], v[16:17], v[16:17]
  v_pk_mov_b32 v[218:219], v[16:17], v[16:17]
  v_pk_mov_b32 v[220:221], v[16:17], v[16:17]
  v_pk_mov_b32 v[222:223], v[16:17], v[16:17]
  v_pk_mov_b32 v[224:225], v[16:17], v[16:17]
  v_pk_mov_b32 v[226:227], v[16:17], v[16:17]
  v_pk_mov_b32 v[228:229], v[16:17], v[16:17]
  v_pk_mov_b32 v[230:231], v[16:17], v[16:17]
  v_pk_mov_b32 v[232:233], v[16:17], v[16:17]
  v_pk_mov_b32 v[234:235], v[16:17], v[16:17]
  v_pk_mov_b32 v[236:237], v[16:17], v[16:17]
  v_pk_mov_b32 v[238:239], v[16:17], v[16:17]
  v_pk_mov_b32 v[240:241], v[16:17], v[16:17]
  v_pk_mov_b32 v[242:243], v[16:17], v[16:17]
  v_pk_mov_b32 v[244:245], v[16:17], v[16:17]
  v_pk_mov_b32 v[246:247], v[16:17], v[16:17]
  v_pk_mov_b32 v[84:85], v[16:17], v[16:17]
  v_pk_mov_b32 v[86:87], v[16:17], v[16:17]
  v_pk_mov_b32 v[88:89], v[16:17], v[16:17]
  v_pk_mov_b32 v[90:91], v[16:17], v[16:17]
  v_pk_mov_b32 v[92:93], v[16:17], v[16:17]
  v_pk_mov_b32 v[94:95], v[16:17], v[16:17]
  s_waitcnt lgkmcnt(0)
  s_cmp_eq_u32 s5, 0
  s_cselect_b32 s56, s20, s28
  s_cselect_b32 s57, s21, s29
  s_mov_b32 s58, 819200
  s_mov_b32 s59, 0x20000
  s_mov_b32 s44, s34
  s_mov_b32 s45, s35
  s_mov_b32 s46, 268435456
  s_mov_b32 s47, 0x20000
  s_mov_b32 s48, s32
  s_mov_b32 s49, s33
  s_mov_b32 s50, 256
  s_mov_b32 s51, 0x20000
  s_mov_b32 s52, s26
  s_mov_b32 s53, s27
  s_mov_b32 s54, 25600
  s_mov_b32 s55, 0x20000
  s_mov_b32 s60, s30
  s_mov_b32 s61, s31
  s_mov_b32 s62, 5242880
  s_mov_b32 s63, 0x20000
  s_lshl_b32 s77, s5, 4
  s_add_u32 s77, s77, s6
  s_lshl_b32 s76, s77, 2
  s_add_u32 s76, s76, s8
  s_lshl_b32 s76, s76, 8
  s_add_u32 s76, s76, 9437184
  s_lshl_b32 s77, s77, 2
  s_add_u32 s77, s77, 0
  s_mov_b32 s10, 0
  v_mov_b32 v74, 0
  v_add_u32 v73, 132, v0
  s_mov_b32 s100, 49152
  s_mov_b32 s101, 49152
  s_mov_b32 s11, -98304
  s_mov_b32 s14, 0
lz_98:
  ds_read_b32 v72, v0 offset:128
  s_waitcnt lgkmcnt(0)
  v_readfirstlane_b32 s9, v72
  s_nop 0
  s_cmp_eq_u32 s9, 0
  s_cbranch_scc1 lzok_99
  s_sleep 1
  s_add_u32 s14, s14, 1
  s_cmp_lt_u32 s14, 1048576
  s_cbranch_scc1 lz_98
lzok_99:
  ds_read_b128 v[56:59], v6 offset:14336
  ds_read_b128 v[60:63], v6 offset:16384
  ds_read_b128 v[76:79], v6
  ds_read_b64_tr_b16 v[16:17], v5 offset:18432
  ds_read_b64_tr_b16 v[18:19], v5 offset:19712
  ds_read_b64_tr_b16 v[20:21], v5 offset:18472
  ds_read_b64_tr_b16 v[22:23], v5 offset:19752
  ds_read_b64_tr_b16 v[24:25], v5 offset:18512
  ds_read_b64_tr_b16 v[26:27], v5 offset:19792
  ds_read_b64_tr_b16 v[28:29], v5 offset:18552
  ds_read_b64_tr_b16 v[30:31], v5 offset:19832
  ds_read_b64_tr_b16 v[32:33], v4 offset:18464
  ds_read_b64_tr_b16 v[34:35], v4 offset:19744
.p2align 3
gl_97:
  s_waitcnt lgkmcnt(6)
  v_mfma_f32_16x16x32_bf16 v[128:131], v[16:19], v[56:59], v[128:131]
  ds_read_b64_tr_b16 v[36:37], v5 offset:28672
  ds_read_b128 v[64:67], v7 offset:14336
  s_mov_b32 s13, s100
  v_mfma_f32_16x16x32_bf16 v[132:135], v[16:19], v[60:63], v[132:135]
  ds_read_b64_tr_b16 v[38:39], v5 offset:29952
  ds_read_b128 v[68:71], v7 offset:16384
  s_mov_b32 s100, s101
  v_mfma_f32_16x16x32_bf16 v[136:139], v[20:23], v[56:59], v[136:139]
  ds_read_b64_tr_b16 v[40:41], v5 offset:28712
  ds_read_b128 v[80:83], v7
  s_mov_b32 s101, s11
  v_mfma_f32_16x16x32_bf16 v[140:143], v[20:23], v[60:63], v[140:143]
  ds_read_b64_tr_b16 v[42:43], v5 offset:29992
  s_waitcnt lgkmcnt(9)
  v_mfma_f32_16x16x32_bf16 v[144:147], v[24:27], v[56:59], v[144:147]
  ds_read_b64_tr_b16 v[44:45], v5 offset:28752
  v_add_u32 v74, 1, v74
  v_mfma_f32_16x16x32_bf16 v[148:151], v[24:27], v[60:63], v[148:151]
  ds_read_b64_tr_b16 v[46:47], v5 offset:30032
  s_mov_b32 s11, s13
  v_mfma_f32_16x16x32_bf16 v[152:155], v[28:31], v[56:59], v[152:155]
  ds_read_b64_tr_b16 v[48:49], v5 offset:28792
  v_add_u32 v7, s13, v7
  v_mfma_f32_16x16x32_bf16 v[156:159], v[28:31], v[60:63], v[156:159]
  ds_read_b64_tr_b16 v[50:51], v5 offset:30072
  s_waitcnt lgkmcnt(8)
  v_mfma_f32_16x16x32_bf16 v[160:163], v[32:35], v[56:59], v[160:163]
  ds_read_b64_tr_b16 v[52:53], v4 offset:28704
  ds_read_b32 v75, v73
  v_mfma_f32_16x16x32_bf16 v[164:167], v[32:35], v[60:63], v[164:167]
  ds_read_b64_tr_b16 v[54:55], v4 offset:29984
  v_mfma_f32_16x16x32_bf16 v[168:171], v[36:39], v[56:59], v[168:171]
  ds_read_b64_tr_b16 v[16:17], v5 offset:38912
  v_mfma_f32_16x16x32_bf16 v[172:175], v[36:39], v[60:63], v[172:175]
  ds_read_b64_tr_b16 v[18:19], v5 offset:40192
  s_waitcnt lgkmcnt(7)
  v_mfma_f32_16x16x32_bf16 v[176:179], v[40:43], v[56:59], v[176:179]
  ds_read_b64_tr_b16 v[20:21], v5 offset:38952
  v_mfma_f32_16x16x32_bf16 v[180:183], v[40:43], v[60:63], v[180:183]
  ds_read_b64_tr_b16 v[22:23], v5 offset:40232
  v_mfma_f32_16x16x32_bf16 v[184:187], v[44:47], v[56:59], v[184:187]
  ds_read_b64_tr_b16 v[24:25], v5 offset:38992
  v_mfma_f32_16x16x32_bf16 v[188:191], v[44:47], v[60:63], v[188:191]
  ds_read_b64_tr_b16 v[26:27], v5 offset:40272
  s_waitcnt lgkmcnt(6)
  v_mfma_f32_16x16x32_bf16 v[192:195], v[48:51], v[56:59], v[192:195]
  ds_read_b64_tr_b16 v[28:29], v5 offset:39032
  v_readfirstlane_b32 s12, v75
  v_mfma_f32_16x16x32_bf16 v[196:199], v[48:51], v[60:63], v[196:199]
  ds_read_b64_tr_b16 v[30:31], v5 offset:40312
  v_mfma_f32_16x16x32_bf16 v[200:203], v[52:55], v[56:59], v[200:203]
  ds_read_b64_tr_b16 v[32:33], v4 offset:38944
  v_mfma_f32_16x16x32_bf16 v[204:207], v[52:55], v[60:63], v[204:207]
  ds_read_b64_tr_b16 v[34:35], v4 offset:40224
  s_cmp_eq_u32 s12, 0
  s_cbranch_scc0 slowb_102
backb_103:
  s_waitcnt lgkmcnt(6)
  v_mfma_f32_16x16x32_bf16 v[208:211], v[56:59], v[16:19], v[208:211]
  ds_read_b64_tr_b16 v[36:37], v5 offset:23552
  v_mfma_f32_16x16x32_bf16 v[212:215], v[60:63], v[16:19], v[212:215]
  ds_read_b64_tr_b16 v[38:39], v5 offset:24832
  v_mfma_f32_16x16x32_bf16 v[216:219], v[56:59], v[20:23], v[216:219]
  ds_read_b64_tr_b16 v[40:41], v5 offset:23592
  v_mfma_f32_16x16x32_bf16 v[220:223], v[60:63], v[20:23], v[220:223]
  ds_read_b64_tr_b16 v[42:43], v5 offset:24872
  s_waitcnt lgkmcnt(6)
  v_mfma_f32_16x16x32_bf16 v[224:227], v[56:59], v[24:27], v[224:227]
  ds_read_b64_tr_b16 v[44:45], v5 offset:23632
  v_mfma_f32_16x16x32_bf16 v[228:231], v[60:63], v[24:27], v[228:231]
  ds_read_b64_tr_b16 v[46:47], v5 offset:24912
  v_mfma_f32_16x16x32_bf16 v[232:235], v[56:59], v[28:31], v[232:235]
  ds_read_b64_tr_b16 v[48:49], v5 offset:23672
  v_mfma_f32_16x16x32_bf16 v[236:239], v[60:63], v[28:31], v[236:239]
  ds_read_b64_tr_b16 v[50:51], v5 offset:24952
  v_mfma_f32_16x16x32_bf16 v[84:87], v[76:79], v[28:31], v[84:87]
  s_waitcnt lgkmcnt(6)
  v_mfma_f32_16x16x32_bf16 v[240:243], v[56:59], v[32:35], v[240:243]
  ds_read_b64_tr_b16 v[52:53], v4 offset:23584
  ds_write_b32 v14, v74
  v_mfma_f32_16x16x32_bf16 v[244:247], v[60:63], v[32:35], v[244:247]
  ds_read_b64_tr_b16 v[54:55], v4 offset:24864
  v_mfma_f32_16x16x32_bf16 v[88:91], v[76:79], v[32:35], v[88:91]
  v_add_u32 v6, s13, v6
  v_mfma_f32_16x16x32_bf16 v[128:131], v[36:39], v[64:67], v[128:131]
  ds_read_b64_tr_b16 v[16:17], v5 offset:33792
  v_add_u32 v74, 1, v74
  v_mfma_f32_16x16x32_bf16 v[132:135], v[36:39], v[68:71], v[132:135]
  ds_read_b64_tr_b16 v[18:19], v5 offset:35072
  s_waitcnt lgkmcnt(7)
  v_mfma_f32_16x16x32_bf16 v[136:139], v[40:43], v[64:67], v[136:139]
  ds_read_b64_tr_b16 v[20:21], v5 offset:33832
  v_mfma_f32_16x16x32_bf16 v[140:143], v[40:43], v[68:71], v[140:143]
  ds_read_b64_tr_b16 v[22:23], v5 offset:35112
  v_mfma_f32_16x16x32_bf16 v[144:147], v[44:47], v[64:67], v[144:147]
  ds_read_b64_tr_b16 v[24:25], v5 offset:33872
  v_mfma_f32_16x16x32_bf16 v[148:151], v[44:47], v[68:71], v[148:151]
  ds_read_b64_tr_b16 v[26:27], v5 offset:35152
  s_waitcnt lgkmcnt(6)
  v_mfma_f32_16x16x32_bf16 v[152:155], v[48:51], v[64:67], v[152:155]
  ds_read_b64_tr_b16 v[28:29], v5 offset:33912
  v_mfma_f32_16x16x32_bf16 v[156:159], v[48:51], v[68:71], v[156:159]
  ds_read_b64_tr_b16 v[30:31], v5 offset:35192
  v_mfma_f32_16x16x32_bf16 v[160:163], v[52:55], v[64:67], v[160:163]
  ds_read_b64_tr_b16 v[32:33], v4 offset:33824
  v_mfma_f32_16x16x32_bf16 v[164:167], v[52:55], v[68:71], v[164:167]
  ds_read_b64_tr_b16 v[34:35], v4 offset:35104
  s_waitcnt lgkmcnt(6)
  v_mfma_f32_16x16x32_bf16 v[168:171], v[16:19], v[64:67], v[168:171]
  ds_read_b64_tr_b16 v[36:37], v5 offset:44032
  ds_read_b32 v72, v73 offset:4
  v_mfma_f32_16x16x32_bf16 v[172:175], v[16:19], v[68:71], v[172:175]
  ds_read_b64_tr_b16 v[38:39], v5 offset:45312
  v_mfma_f32_16x16x32_bf16 v[176:179], v[20:23], v[64:67], v[176:179]
  ds_read_b64_tr_b16 v[40:41], v5 offset:44072
  v_mfma_f32_16x16x32_bf16 v[180:183], v[20:23], v[68:71], v[180:183]
  ds_read_b64_tr_b16 v[42:43], v5 offset:45352
  s_waitcnt lgkmcnt(7)
  v_mfma_f32_16x16x32_bf16 v[184:187], v[24:27], v[64:67], v[184:187]
  ds_read_b64_tr_b16 v[44:45], v5 offset:44112
  v_mfma_f32_16x16x32_bf16 v[188:191], v[24:27], v[68:71], v[188:191]
  ds_read_b64_tr_b16 v[46:47], v5 offset:45392
  v_mfma_f32_16x16x32_bf16 v[192:195], v[28:31], v[64:67], v[192:195]
  ds_read_b64_tr_b16 v[48:49], v5 offset:44152
  v_mfma_f32_16x16x32_bf16 v[196:199], v[28:31], v[68:71], v[196:199]
  ds_read_b64_tr_b16 v[50:51], v5 offset:45432
  s_waitcnt lgkmcnt(6)
  v_mfma_f32_16x16x32_bf16 v[200:203], v[32:35], v[64:67], v[200:203]
  ds_read_b64_tr_b16 v[52:53], v4 offset:44064
  v_readfirstlane_b32 s9, v72
  v_mfma_f32_16x16x32_bf16 v[204:207], v[32:35], v[68:71], v[204:207]
  ds_read_b64_tr_b16 v[54:55], v4 offset:45344
  v_add_u32 v5, s13, v5
  s_cmp_eq_u32 s9, 0
  s_cbranch_scc0 slow_100
back_101:
  v_mfma_f32_16x16x32_bf16 v[208:211], v[64:67], v[36:39], v[208:211]
  ds_read_b64_tr_b16 v[16:17], v5 offset:18432
  ds_read_b128 v[56:59], v6 offset:14336
  ds_read_b128 v[60:63], v6 offset:16384
  v_mfma_f32_16x16x32_bf16 v[212:215], v[68:71], v[36:39], v[212:215]
  ds_read_b64_tr_b16 v[18:19], v5 offset:19712
  ds_read_b128 v[76:79], v6
  s_waitcnt lgkmcnt(9)
  v_mfma_f32_16x16x32_bf16 v[216:219], v[64:67], v[40:43], v[216:219]
  ds_read_b64_tr_b16 v[20:21], v5 offset:18472
  v_add_u32 v73, 8, v73
  v_mfma_f32_16x16x32_bf16 v[220:223], v[68:71], v[40:43], v[220:223]
  ds_read_b64_tr_b16 v[22:23], v5 offset:19752
  s_add_u32 s10, s10, 1
  v_mfma_f32_16x16x32_bf16 v[224:227], v[64:67], v[44:47], v[224:227]
  ds_read_b64_tr_b16 v[24:25], v5 offset:18512
  v_mfma_f32_16x16x32_bf16 v[228:231], v[68:71], v[44:47], v[228:231]
  ds_read_b64_tr_b16 v[26:27], v5 offset:19792
  s_waitcnt lgkmcnt(9)
  v_mfma_f32_16x16x32_bf16 v[232:235], v[64:67], v[48:51], v[232:235]
  ds_read_b64_tr_b16 v[28:29], v5 offset:18552
  ds_write_b32 v14, v74
  v_mfma_f32_16x16x32_bf16 v[236:239], v[68:71], v[48:51], v[236:239]
  ds_read_b64_tr_b16 v[30:31], v5 offset:19832
  v_mfma_f32_16x16x32_bf16 v[84:87], v[80:83], v[48:51], v[84:87]
  v_add_u32 v4, s13, v4
  v_mfma_f32_16x16x32_bf16 v[240:243], v[64:67], v[52:55], v[240:243]
  ds_read_b64_tr_b16 v[32:33], v4 offset:18464
  v_mfma_f32_16x16x32_bf16 v[244:247], v[68:71], v[52:55], v[244:247]
  ds_read_b64_tr_b16 v[34:35], v4 offset:19744
  v_mfma_f32_16x16x32_bf16 v[88:91], v[80:83], v[52:55], v[88:91]
  s_cmp_lt_u32 s10, 10
  s_cbranch_scc1 gl_97
  s_waitcnt lgkmcnt(0)
  s_branch gd_104
slow_100:
  s_mov_b32 s14, 0
lz_105:
  ds_read_b32 v72, v73 offset:4
  s_waitcnt lgkmcnt(0)
  v_readfirstlane_b32 s9, v72
  s_nop 0
  s_cmp_eq_u32 s9, 0
  s_cbranch_scc1 lzok_106
  s_add_u32 s14, s14, 1
  s_cmp_lt_u32 s14, 1048576
  s_cbranch_scc1 lz_105
lzok_106:
  s_branch back_101
slowb_102:
  s_mov_b32 s14, 0
lz_107:
  ds_read_b32 v72, v73 offset:0
  s_waitcnt lgkmcnt(0)
  v_readfirstlane_b32 s9, v72
  s_nop 0
  s_cmp_eq_u32 s9, 0
  s_cbranch_scc1 lzok_108
  s_add_u32 s14, s14, 1
  s_cmp_lt_u32 s14, 1048576
  s_cbranch_scc1 lz_107
lzok_108:
  s_branch backb_103
gd_104:
  v_lshlrev_b32 v8, 4, v1
  v_lshlrev_b32 v9, 3, v1
  v_cvt_pk_bf16_f32 v16, v84, v85
  v_cvt_pk_bf16_f32 v17, v86, v87
  v_cvt_pk_bf16_f32 v18, v88, v89
  v_cvt_pk_bf16_f32 v19, v90, v91
  s_mov_b32 s14, 0
lw_109:
  ds_read_b128 v[248:251], v0 offset:16
  s_waitcnt lgkmcnt(0)
  v_min3_u32 v248, v248, v249, v250
  v_min_u32 v248, v248, v251
  s_nop 0
  v_readfirstlane_b32 s9, v248
  s_nop 0
  s_cmp_ge_u32 s9, 16
  s_cbranch_scc1 lwok_110
  s_sleep 1
  s_add_u32 s14, s14, 1
  s_cmp_lt_u32 s14, 1048576
  s_cbranch_scc1 lw_109
lwok_110:
  ds_write_b64 v9, v[16:17] offset:56832
  ds_write_b64 v9, v[18:19] offset:57344
  v_mov_b32 v12, 1
  s_mov_b64 exec, 1
  ds_add_u32 v0, v12 offset:48
  s_mov_b64 exec, -1
k_Aep:
  s_load_dword s78, s[32:33], s77
  s_add_u32 s9, s77, 192
  s_load_dword s79, s[32:33], s9
  s_mul_i32 s9, s8, 6656
  s_add_u32 s9, s9, 51200
  v_add_u32 v10, s9, v8
  v_add_u32 v11, s9, v9
  v_cvt_pk_bf16_f32 v80, v172, v173
  v_cvt_pk_bf16_f32 v81, v174, v175
  v_cvt_pk_bf16_f32 v82, v204, v205
  v_cvt_pk_bf16_f32 v83, v206, v207
  v_cvt_pk_bf16_f32 v84, v180, v181
  v_cvt_pk_bf16_f32 v85, v182, v183
  v_cvt_pk_bf16_f32 v86, v204, v205
  v_cvt_pk_bf16_f32 v87, v206, v207
  v_cvt_pk_bf16_f32 v88, v188, v189
  v_cvt_pk_bf16_f32 v89, v190, v191
  v_cvt_pk_bf16_f32 v90, v204, v205
  v_cvt_pk_bf16_f32 v91, v206, v207
  v_cvt_pk_bf16_f32 v92, v196, v197
  v_cvt_pk_bf16_f32 v93, v198, v199
  v_cvt_pk_bf16_f32 v94, v204, v205
  v_cvt_pk_bf16_f32 v95, v206, v207
  v_cvt_pk_bf16_f32 v100, v212, v213
  v_cvt_pk_bf16_f32 v101, v214, v215
  v_cvt_pk_bf16_f32 v106, v220, v221
  v_cvt_pk_bf16_f32 v107, v222, v223
  v_cvt_pk_bf16_f32 v112, v228, v229
  v_cvt_pk_bf16_f32 v113, v230, v231
  v_cvt_pk_bf16_f32 v118, v236, v237
  v_cvt_pk_bf16_f32 v119, v238, v239
  v_cvt_pk_bf16_f32 v124, v244, v245
  v_cvt_pk_bf16_f32 v125, v246, v247
  s_cmp_eq_u32 s8, 3
  s_cbranch_scc1 k_A_nw
  ds_write_b128 v10, v[80:83] offset:6656
  ds_write_b128 v10, v[84:87] offset:7680
  ds_write_b128 v10, v[88:91] offset:8704
  ds_write_b128 v10, v[92:95] offset:9728
  ds_write_b64 v11, v[100:101] offset:10752
  ds_write_b64 v11, v[106:107] offset:11264
  ds_write_b64 v11, v[112:113] offset:11776
  ds_write_b64 v11, v[118:119] offset:12288
  ds_write_b64 v11, v[124:125] offset:12800
  v_mov_b32 v12, 4
  ds_write_b32 v14, v12 offset:36
k_A_nw:
  v_cvt_pk_bf16_f32 v64, v168, v169
  v_cvt_pk_bf16_f32 v65, v170, v171
  v_cvt_pk_bf16_f32 v66, v200, v201
  v_cvt_pk_bf16_f32 v67, v202, v203
  v_cvt_pk_bf16_f32 v68, v176, v177
  v_cvt_pk_bf16_f32 v69, v178, v179
  v_cvt_pk_bf16_f32 v70, v200, v201
  v_cvt_pk_bf16_f32 v71, v202, v203
  v_cvt_pk_bf16_f32 v72, v184, v185
  v_cvt_pk_bf16_f32 v73, v186, v187
  v_cvt_pk_bf16_f32 v74, v200, v201
  v_cvt_pk_bf16_f32 v75, v202, v203
  v_cvt_pk_bf16_f32 v76, v192, v193
  v_cvt_pk_bf16_f32 v77, v194, v195
  v_cvt_pk_bf16_f32 v78, v200, v201
  v_cvt_pk_bf16_f32 v79, v202, v203
  v_cvt_pk_bf16_f32 v98, v208, v209
  v_cvt_pk_bf16_f32 v99, v210, v211
  v_cvt_pk_bf16_f32 v104, v216, v217
  v_cvt_pk_bf16_f32 v105, v218, v219
  v_cvt_pk_bf16_f32 v110, v224, v225
  v_cvt_pk_bf16_f32 v111, v226, v227
  v_cvt_pk_bf16_f32 v116, v232, v233
  v_cvt_pk_bf16_f32 v117, v234, v235
  v_cvt_pk_bf16_f32 v122, v240, v241
  v_cvt_pk_bf16_f32 v123, v242, v243
  s_mov_b32 s66, 0xffff
  s_mov_b32 s67, 0
  s_mov_b32 s68, 0xffff0000
  s_mov_b32 s69, 0
  s_mov_b32 s70, 0
  s_mov_b32 s71, 0xffff
  s_mov_b32 s72, 0
  s_mov_b32 s73, 0xffff0000
  v_and_b32 v12, 1, v3
  v_cmp_eq_u32 s[74:75], 1, v12
  v_lshl_add_u32 v13, v2, 2, v12
  v_cmp_ge_u32 s[100:101], v3, v13
  v_add_u32 v13, 2, v13
  v_cmp_ge_u32 vcc, v3, v13
  v_cvt_pk_bf16_f32 v6, v164, v165
  v_cvt_pk_bf16_f32 v7, v166, v167
  v_cvt_pk_bf16_f32 v32, v132, v133
  v_cvt_pk_bf16_f32 v33, v134, v135
  v_cndmask_b32 v34, 0, v6, s[66:67]
  v_cndmask_b32 v35, 0, v7, s[66:67]
  v_cvt_pk_bf16_f32 v36, v140, v141
  v_cvt_pk_bf16_f32 v37, v142, v143
  v_cndmask_b32 v38, 0, v6, s[68:69]
  v_cndmask_b32 v39, 0, v7, s[68:69]
  v_cvt_pk_bf16_f32 v40, v148, v149
  v_cvt_pk_bf16_f32 v41, v150, v151
  v_cndmask_b32 v42, 0, v6, s[70:71]
  v_cndmask_b32 v43, 0, v7, s[70:71]
  v_cvt_pk_bf16_f32 v44, v156, v157
  v_cvt_pk_bf16_f32 v45, v158, v159
  v_cndmask_b32 v46, 0, v6, s[72:73]
  v_cndmask_b32 v47, 0, v7, s[72:73]
  v_cvt_pk_bf16_f32 v6, v160, v161
  v_cvt_pk_bf16_f32 v7, v162, v163
  v_cvt_pk_bf16_f32 v16, v128, v129
  v_cvt_pk_bf16_f32 v17, v130, v131
  v_cndmask_b32 v18, 0, v6, s[66:67]
  v_cndmask_b32 v19, 0, v7, s[66:67]
  v_cvt_pk_bf16_f32 v20, v136, v137
  v_cvt_pk_bf16_f32 v21, v138, v139
  v_cndmask_b32 v22, 0, v6, s[68:69]
  v_cndmask_b32 v23, 0, v7, s[68:69]
  v_cvt_pk_bf16_f32 v24, v144, v145
  v_cvt_pk_bf16_f32 v25, v146, v147
  v_cndmask_b32 v26, 0, v6, s[70:71]
  v_cndmask_b32 v27, 0, v7, s[70:71]
  v_cvt_pk_bf16_f32 v28, v152, v153
  v_cvt_pk_bf16_f32 v29, v154, v155
  v_cndmask_b32 v30, 0, v6, s[72:73]
  v_cndmask_b32 v31, 0, v7, s[72:73]
  v_mfma_f32_16x16x32_bf16 v[164:167], v[80:83], v[32:35], 0
  v_mfma_f32_16x16x32_bf16 v[160:163], v[64:67], v[32:35], 0
  v_mfma_f32_16x16x32_bf16 v[172:175], v[84:87], v[36:39], 0
  v_mfma_f32_16x16x32_bf16 v[168:171], v[68:71], v[36:39], 0
  v_mfma_f32_16x16x32_bf16 v[180:183], v[88:91], v[40:43], 0
  v_mfma_f32_16x16x32_bf16 v[176:179], v[72:75], v[40:43], 0
  v_mfma_f32_16x16x32_bf16 v[188:191], v[92:95], v[44:47], 0
  v_mfma_f32_16x16x32_bf16 v[184:187], v[76:79], v[44:47], 0
  v_mfma_f32_16x16x32_bf16 v[132:135], v[64:67], v[16:19], 0
  v_mfma_f32_16x16x32_bf16 v[140:143], v[68:71], v[20:23], 0
  v_mfma_f32_16x16x32_bf16 v[148:151], v[72:75], v[24:27], 0
  v_mfma_f32_16x16x32_bf16 v[156:159], v[76:79], v[28:31], 0
  v_mov_b32 v12, 0x0c0c0100
  v_mov_b32 v13, 0x01000c0c
  v_cndmask_b32 v12, v12, v13, s[74:75]
  v_mov_b32 v13, 0x0c0c0302
  v_mov_b32 v6, 0x03020c0c
  v_cndmask_b32 v13, v13, v6, s[74:75]
  v_mov_b32 v6, 0x0c0c0c0c
  v_cndmask_b32 v240, v12, v6, s[100:101]
  v_cndmask_b32 v241, v13, v6, vcc
  v_cndmask_b32 v242, v6, v12, s[100:101]
  v_cndmask_b32 v243, v6, v13, vcc
  s_or_b32 s9, s6, s8
  s_cmp_eq_u32 s9, 0
  s_cselect_b32 s9, 0xf149f2ca, 0
  v_mov_b32 v244, s9
  v_mov_b32 v245, s9
  v_mov_b32 v246, s9
  v_mov_b32 v247, s9
  s_mov_b32 s64, 0x3ea52b5c
  v_lshlrev_b32 v8, 4, v1
  v_lshlrev_b32 v9, 3, v1
  s_lshl_b32 s9, s6, 2
  s_add_u32 s9, s9, s8
  s_mul_i32 s9, s9, 40960
  s_mul_i32 s10, s5, 2621440
  s_add_u32 s15, s9, s10
  s_mul_i32 s10, s7, 5120
  s_add_u32 s12, s15, s10
  s_add_u32 s13, s12, 2560
  s_mov_b32 s14, 0
lw_111:
  ds_read_b32 v248, v14 offset:32
  s_waitcnt lgkmcnt(0)
  v_readfirstlane_b32 s9, v248
  s_nop 0
  s_cmp_ge_u32 s9, 4
  s_cbranch_scc1 lwok_112
  s_sleep 1
  s_add_u32 s14, s14, 1
  s_cmp_lt_u32 s14, 1048576
  s_cbranch_scc1 lw_111
lwok_112:
  ds_read_b128 v[48:51], v10 offset:0
  ds_read_b128 v[52:55], v10 offset:1024
  ds_read_b128 v[56:59], v10 offset:2048
  ds_read_b128 v[60:63], v10 offset:3072
  ds_read_b64 v[96:97], v11 offset:4096
  ds_read_b64 v[102:103], v11 offset:4608
  ds_read_b64 v[108:109], v11 offset:5120
  ds_read_b64 v[114:115], v11 offset:5632
  ds_read_b64 v[120:121], v11 offset:6144
  s_waitcnt lgkmcnt(5)
  v_mfma_f32_16x16x32_bf16 v[128:131], v[48:51], v[16:19], v[244:247]
  v_mfma_f32_16x16x32_bf16 v[136:139], v[52:55], v[20:23], v[244:247]
  v_mfma_f32_16x16x32_bf16 v[144:147], v[56:59], v[24:27], v[244:247]
  v_mfma_f32_16x16x32_bf16 v[152:155], v[60:63], v[28:31], v[244:247]
  s_waitcnt lgkmcnt(0)
  v_cndmask_b32 v248, v164, v165, s[74:75]
  v_cndmask_b32 v252, v132, v133, s[74:75]
  v_cndmask_b32 v249, v160, v161, s[74:75]
  s_nop 0
  v_cndmask_b32 v253, v128, v129, s[74:75]
  v_cndmask_b32 v250, v166, v167, s[74:75]
  v_cndmask_b32 v254, v134, v135, s[74:75]
  v_cndmask_b32 v251, v162, v163, s[74:75]
  v_cndmask_b32 v255, v130, v131, s[74:75]
  v_cndmask_b32 v200, v249, v248, s[100:101]
  v_cndmask_b32 v192, v253, v252, s[100:101]
  v_cndmask_b32 v204, v251, v250, vcc
  v_cndmask_b32 v196, v255, v254, vcc
  v_cndmask_b32 v248, v172, v173, s[74:75]
  v_cndmask_b32 v252, v140, v141, s[74:75]
  v_cndmask_b32 v249, v168, v169, s[74:75]
  v_cndmask_b32 v253, v136, v137, s[74:75]
  v_cndmask_b32 v250, v174, v175, s[74:75]
  v_cndmask_b32 v254, v142, v143, s[74:75]
  v_cndmask_b32 v251, v170, v171, s[74:75]
  v_cndmask_b32 v255, v138, v139, s[74:75]
  v_cndmask_b32 v201, v249, v248, s[100:101]
  v_cndmask_b32 v193, v253, v252, s[100:101]
  v_cndmask_b32 v205, v251, v250, vcc
  v_cndmask_b32 v197, v255, v254, vcc
  v_cndmask_b32 v248, v180, v181, s[74:75]
  v_cndmask_b32 v252, v148, v149, s[74:75]
  v_cndmask_b32 v249, v176, v177, s[74:75]
  v_cndmask_b32 v253, v144, v145, s[74:75]
  v_cndmask_b32 v250, v182, v183, s[74:75]
  v_cndmask_b32 v254, v150, v151, s[74:75]
  v_cndmask_b32 v251, v178, v179, s[74:75]
  v_cndmask_b32 v255, v146, v147, s[74:75]
  v_cndmask_b32 v202, v249, v248, s[100:101]
  v_cndmask_b32 v194, v253, v252, s[100:101]
  v_cndmask_b32 v206, v251, v250, vcc
  v_cndmask_b32 v198, v255, v254, vcc
  v_cndmask_b32 v248, v188, v189, s[74:75]
  v_cndmask_b32 v252, v156, v157, s[74:75]
  v_cndmask_b32 v249, v184, v185, s[74:75]
  v_cndmask_b32 v253, v152, v153, s[74:75]
  v_cndmask_b32 v250, v190, v191, s[74:75]
  v_cndmask_b32 v254, v158, v159, s[74:75]
  v_cndmask_b32 v251, v186, v187, s[74:75]
  v_cndmask_b32 v255, v154, v155, s[74:75]
  v_cndmask_b32 v203, v249, v248, s[100:101]
  v_cndmask_b32 v195, v253, v252, s[100:101]
  v_cndmask_b32 v207, v251, v250, vcc
  v_cndmask_b32 v199, v255, v254, vcc
  v_permlane32_swap_b32 v200, v202
  v_permlane32_swap_b32 v192, v194
  v_permlane32_swap_b32 v201, v203
  v_permlane32_swap_b32 v193, v195
  v_permlane32_swap_b32 v204, v206
  v_permlane32_swap_b32 v196, v198
  v_permlane32_swap_b32 v205, v207
  v_permlane32_swap_b32 v197, v199
  v_permlane16_swap_b32 v200, v201
  v_permlane16_swap_b32 v192, v193
  v_permlane16_swap_b32 v202, v203
  v_permlane16_swap_b32 v194, v195
  v_permlane16_swap_b32 v204, v205
  v_permlane16_swap_b32 v196, v197
  v_permlane16_swap_b32 v206, v207
  v_permlane16_swap_b32 v198, v199
  v_max3_f32 v248, v200, v201, v202
  v_max3_f32 v252, v192, v193, v194
  v_max3_f32 v249, v204, v205, v203
  v_max3_f32 v253, v196, v197, v195
  v_max3_f32 v248, v248, v206, v207
  v_max3_f32 v252, v252, v198, v199
  v_max_f32 v248, v248, v249
  v_max_f32 v252, v252, v253
  v_mul_f32 v248, s64, v248
  v_mul_f32 v252, s64, v252
  v_fma_f32 v200, v200, s64, -v248
  v_fma_f32 v192, v192, s64, -v252
  v_fma_f32 v201, v201, s64, -v248
  v_fma_f32 v193, v193, s64, -v252
  v_fma_f32 v202, v202, s64, -v248
  v_fma_f32 v194, v194, s64, -v252
  v_fma_f32 v203, v203, s64, -v248
  v_fma_f32 v195, v195, s64, -v252
  v_fma_f32 v204, v204, s64, -v248
  v_fma_f32 v196, v196, s64, -v252
  v_fma_f32 v205, v205, s64, -v248
  v_fma_f32 v197, v197, s64, -v252
  v_fma_f32 v206, v206, s64, -v248
  v_fma_f32 v198, v198, s64, -v252
  v_fma_f32 v207, v207, s64, -v248
  v_fma_f32 v199, v199, s64, -v252
  v_exp_f32 v200, v200
  v_exp_f32 v192, v192
  v_exp_f32 v201, v201
  v_exp_f32 v193, v193
  v_exp_f32 v202, v202
  v_exp_f32 v194, v194
  v_exp_f32 v203, v203
  v_exp_f32 v195, v195
  v_exp_f32 v204, v204
  v_exp_f32 v196, v196
  v_exp_f32 v205, v205
  v_exp_f32 v197, v197
  v_exp_f32 v206, v206
  v_exp_f32 v198, v198
  v_exp_f32 v207, v207
  v_exp_f32 v199, v199
  v_add_f32 v248, v200, v201
  v_add_f32 v252, v192, v193
  v_add_f32 v249, v202, v203
  v_add_f32 v253, v194, v195
  v_add_f32 v250, v204, v205
  v_add_f32 v254, v196, v197
  v_add_f32 v251, v206, v207
  v_add_f32 v255, v198, v199
  v_add_f32 v248, v248, v249
  v_add_f32 v252, v252, v253
  v_add_f32 v250, v250, v251
  v_add_f32 v254, v254, v255
  v_add_f32 v248, v248, v250
  v_add_f32 v252, v252, v254
  v_rcp_f32 v248, v248
  v_rcp_f32 v252, v252
  v_mul_f32 v200, v200, v248
  v_mul_f32 v192, v192, v252
  v_mul_f32 v201, v201, v248
  v_mul_f32 v193, v193, v252
  v_mul_f32 v202, v202, v248
  v_mul_f32 v194, v194, v252
  v_mul_f32 v203, v203, v248
  v_mul_f32 v195, v195, v252
  v_mul_f32 v204, v204, v248
  v_mul_f32 v196, v196, v252
  v_mul_f32 v205, v205, v248
  v_mul_f32 v197, v197, v252
  v_mul_f32 v206, v206, v248
  v_mul_f32 v198, v198, v252
  v_mul_f32 v207, v207, v248
  v_mul_f32 v199, v199, v252
  v_cvt_pk_bf16_f32 v200, v200, v204
  v_cvt_pk_bf16_f32 v192, v192, v196
  v_cvt_pk_bf16_f32 v201, v201, v205
  v_cvt_pk_bf16_f32 v193, v193, v197
  v_cvt_pk_bf16_f32 v202, v202, v206
  v_cvt_pk_bf16_f32 v194, v194, v198
  v_cvt_pk_bf16_f32 v203, v203, v207
  v_cvt_pk_bf16_f32 v195, v195, v199
  v_permlane32_swap_b32 v200, v202
  v_permlane32_swap_b32 v192, v194
  v_permlane32_swap_b32 v201, v203
  v_permlane32_swap_b32 v193, v195
  s_nop 0
  v_permlane16_swap_b32 v200, v201
  v_permlane16_swap_b32 v192, v193
  v_permlane16_swap_b32 v202, v203
  v_permlane16_swap_b32 v194, v195
  v_perm_b32 v224, v200, v200, v240
  v_perm_b32 v208, v192, v192, v240
  v_perm_b32 v225, v200, v200, v241
  v_perm_b32 v209, v192, v192, v241
  v_perm_b32 v226, v200, v200, v242
  v_perm_b32 v210, v192, v192, v242
  v_perm_b32 v227, v200, v200, v243
  v_perm_b32 v211, v192, v192, v243
  v_perm_b32 v228, v201, v201, v240
  v_perm_b32 v212, v193, v193, v240
  v_perm_b32 v229, v201, v201, v241
  v_perm_b32 v213, v193, v193, v241
  v_perm_b32 v230, v201, v201, v242
  v_perm_b32 v214, v193, v193, v242
  v_perm_b32 v231, v201, v201, v243
  v_perm_b32 v215, v193, v193, v243
  v_perm_b32 v232, v202, v202, v240
  v_perm_b32 v216, v194, v194, v240
  v_perm_b32 v233, v202, v202, v241
  v_perm_b32 v217, v194, v194, v241
  v_perm_b32 v234, v202, v202, v242
  v_perm_b32 v218, v194, v194, v242
  v_perm_b32 v235, v202, v202, v243
  v_perm_b32 v219, v194, v194, v243
  v_perm_b32 v236, v203, v203, v240
  v_perm_b32 v220, v195, v195, v240
  v_perm_b32 v237, v203, v203, v241
  v_perm_b32 v221, v195, v195, v241
  v_perm_b32 v238, v203, v203, v242
  v_perm_b32 v222, v195, v195, v242
  v_perm_b32 v239, v203, v203, v243
  v_perm_b32 v223, v195, v195, v243
  v_mfma_f32_16x16x32_bf16 v[160:163], v[98:101], v[224:227], 0
  v_mfma_f32_16x16x32_bf16 v[128:131], v[96:99], v[208:211], 0
  v_mfma_f32_16x16x32_bf16 v[164:167], v[122:125], v[224:227], 0
  v_mfma_f32_16x16x32_bf16 v[132:135], v[120:123], v[208:211], 0
  v_mfma_f32_16x16x32_bf16 v[168:171], v[104:107], v[228:231], 0
  v_mfma_f32_16x16x32_bf16 v[136:139], v[102:105], v[212:215], 0
  v_mfma_f32_16x16x32_bf16 v[172:175], v[122:125], v[228:231], 0
  v_mfma_f32_16x16x32_bf16 v[140:143], v[120:123], v[212:215], 0
  v_mfma_f32_16x16x32_bf16 v[176:179], v[110:113], v[232:235], 0
  v_mfma_f32_16x16x32_bf16 v[144:147], v[108:111], v[216:219], 0
  v_mfma_f32_16x16x32_bf16 v[180:183], v[122:125], v[232:235], 0
  v_mfma_f32_16x16x32_bf16 v[148:151], v[120:123], v[216:219], 0
  v_mfma_f32_16x16x32_bf16 v[184:187], v[116:119], v[236:239], 0
  v_mfma_f32_16x16x32_bf16 v[152:155], v[114:117], v[220:223], 0
  v_mfma_f32_16x16x32_bf16 v[188:191], v[122:125], v[236:239], 0
  v_mfma_f32_16x16x32_bf16 v[156:159], v[120:123], v[220:223], 0
  v_cvt_pk_bf16_f32 v220, v160, v161
  v_cvt_pk_bf16_f32 v221, v162, v163
  v_cvt_pk_bf16_f32 v222, v168, v169
  v_cvt_pk_bf16_f32 v223, v170, v171
  v_cvt_pk_bf16_f32 v224, v176, v177
  v_cvt_pk_bf16_f32 v225, v178, v179
  v_cvt_pk_bf16_f32 v226, v184, v185
  v_cvt_pk_bf16_f32 v227, v186, v187
  v_cvt_pk_bf16_f32 v208, v128, v129
  v_cvt_pk_bf16_f32 v209, v130, v131
  v_cvt_pk_bf16_f32 v210, v136, v137
  v_cvt_pk_bf16_f32 v211, v138, v139
  v_cvt_pk_bf16_f32 v212, v144, v145
  v_cvt_pk_bf16_f32 v213, v146, v147
  v_cvt_pk_bf16_f32 v214, v152, v153
  v_cvt_pk_bf16_f32 v215, v154, v155
  s_mov_b64 exec, s[66:67]
  v_cvt_pk_bf16_f32 v216, v132, v133
  v_cvt_pk_bf16_f32 v217, v134, v135
  v_cvt_pk_bf16_f32 v228, v164, v165
  v_cvt_pk_bf16_f32 v229, v166, v167
  s_mov_b64 exec, s[68:69]
  v_cvt_pk_bf16_f32 v216, v140, v141
  v_cvt_pk_bf16_f32 v217, v142, v143
  v_cvt_pk_bf16_f32 v228, v172, v173
  v_cvt_pk_bf16_f32 v229, v174, v175
  s_mov_b64 exec, s[70:71]
  v_cvt_pk_bf16_f32 v216, v148, v149
  v_cvt_pk_bf16_f32 v217, v150, v151
  v_cvt_pk_bf16_f32 v228, v180, v181
  v_cvt_pk_bf16_f32 v229, v182, v183
  s_mov_b64 exec, s[72:73]
  v_cvt_pk_bf16_f32 v216, v156, v157
  v_cvt_pk_bf16_f32 v217, v158, v159
  v_cvt_pk_bf16_f32 v228, v188, v189
  v_cvt_pk_bf16_f32 v229, v190, v191
  s_mov_b64 exec, -1
  buffer_store_dwordx4 v[208:211], v8, s[44:47], s12 offen sc1
  buffer_store_dwordx4 v[212:215], v8, s[44:47], s12 offen offset:1024 sc1
  buffer_store_dwordx2 v[216:217], v9, s[44:47], s12 offen offset:2048 sc1
  buffer_store_dwordx4 v[220:223], v8, s[44:47], s13 offen sc1
  buffer_store_dwordx4 v[224:227], v8, s[44:47], s13 offen offset:1024 sc1
  buffer_store_dwordx2 v[228:229], v9, s[44:47], s13 offen offset:2048 sc1
  s_mov_b32 s66, 77824
  s_mov_b32 s67, 103424
  s_mov_b32 s68, 129024
  s_mov_b32 s69, 0
  s_mov_b32 s70, 6400
  s_mov_b32 s71, 3200
  s_waitcnt lgkmcnt(0)
  s_and_b32 s78, s78, s79
  s_cmp_ge_u32 s78, 1
  s_cbranch_scc1 k_zok
  s_mov_b32 s14, 0
gw_113:
  buffer_load_dword v254, v15, s[48:51], s77 offen sc1
  s_waitcnt vmcnt(0)
  v_readfirstlane_b32 s9, v254
  s_nop 0
  s_cmp_ge_u32 s9, 1
  s_cbranch_scc1 gwok_114
  s_sleep 1
  s_add_u32 s14, s14, 1
  s_cmp_lt_u32 s14, 65536
  s_cbranch_scc1 gw_113
gwok_114:
  s_add_u32 s77, s77, 192
  s_mov_b32 s14, 0
gw_115:
  buffer_load_dword v254, v15, s[48:51], s77 offen sc1
  s_waitcnt vmcnt(0)
  v_readfirstlane_b32 s9, v254
  s_nop 0
  s_cmp_ge_u32 s9, 1
  s_cbranch_scc1 gwok_116
  s_sleep 1
  s_add_u32 s14, s14, 1
  s_cmp_lt_u32 s14, 65536
  s_cbranch_scc1 gw_115
gwok_116:
k_zok:
  s_mov_b32 s78, 0
  s_mov_b32 s72, 0
  v_subrev_u32 v10, 16, v14
  v_bfe_u32 v5, v1, 2, 2
  v_and_b32 v6, 3, v1
  v_mad_u32_u24 v7, v2, 20, v5
  v_mul_u32_u24 v7, 160, v7
  v_lshl_add_u32 v252, v6, 3, v7
  v_lshl_add_u32 v7, v2, 2, v5
  v_mul_u32_u24 v7, 160, v7
  v_lshl_add_u32 v253, v6, 3, v7
  s_cmp_eq_u32 s78, 0
  s_cselect_b64 vcc, -1, 0
  v_cndmask_b32 v248, v252, v253, vcc
  s_and_b32 s74, s7, 3
  s_cmp_eq_u32 s74, 0
  s_cbranch_scc1 k_rot_doneA
k_rotA:
  s_mov_b32 s9, s66
  s_mov_b32 s66, s67
  s_mov_b32 s67, s68
  s_mov_b32 s68, s69
  s_mov_b32 s69, s9
  s_sub_u32 s74, s74, 1
  s_cmp_lg_u32 s74, 0
  s_cbranch_scc1 k_rotA
k_rot_doneA:
  s_sub_u32 s69, s69, s68
  s_sub_u32 s68, s68, s67
  s_sub_u32 s67, s67, s66
  s_and_b32 s74, s7, 3
  v_add_u32 v248, s66, v248
  v_add_u32 v252, s66, v252
  v_add_u32 v249, s71, v248
  v_add_u32 v250, s70, v248
  v_add_u32 v251, s70, v249
  v_mov_b32 v48, 0
  v_mov_b32 v49, 0
  v_mov_b32 v50, 0
  v_mov_b32 v51, 0
  v_mov_b32 v52, 0
  v_mov_b32 v53, 0
  v_mov_b32 v54, 0
  v_mov_b32 v55, 0
  v_mov_b32 v56, 0
  v_mov_b32 v57, 0
  v_mov_b32 v58, 0
  v_mov_b32 v59, 0
  v_mov_b32 v60, 0
  v_mov_b32 v61, 0
  v_mov_b32 v62, 0
  v_mov_b32 v63, 0
  v_mov_b32 v64, 0
  v_mov_b32 v65, 0
  v_mov_b32 v66, 0
  v_mov_b32 v67, 0
  v_mov_b32 v68, 0
  v_mov_b32 v69, 0
  v_mov_b32 v70, 0
  v_mov_b32 v71, 0
  v_mov_b32 v72, 0
  v_mov_b32 v73, 0
  v_mov_b32 v74, 0
  v_mov_b32 v75, 0
  v_mov_b32 v76, 0
  v_mov_b32 v77, 0
  v_mov_b32 v78, 0
  v_mov_b32 v79, 0
  v_mov_b32 v80, 0
  v_mov_b32 v81, 0
  v_mov_b32 v82, 0
  v_mov_b32 v83, 0
  v_mov_b32 v84, 0
  v_mov_b32 v85, 0
  v_mov_b32 v86, 0
  v_mov_b32 v87, 0
  s_lshl_b32 s9, s6, 7
  s_lshl_b32 s10, s8, 5
  s_add_u32 s9, s9, s10
  v_add_u32 v4, s9, v3
  v_mul_u32_u24 v4, 2560, v4
  s_mul_i32 s10, s7, 160
  s_add_u32 s72, s72, s10
  s_add_u32 s73, s72, 40960
  v_and_b32 v5, 1, v2
  v_lshlrev_b32 v5, 5, v5
  v_lshrrev_b32 v6, 1, v2
  v_lshl_add_u32 v5, v6, 4, v5
  v_add_u32 v5, v5, v4
  v_lshl_add_u32 v6, v2, 3, v4
  v_mov_b32 v12, 1
  s_add_u32 s9, s74, 0
  s_and_b32 s9, s9, 3
  s_mul_i32 s9, s9, 10240
  s_add_u32 s16, s9, s15
  s_add_u32 s17, s16, 2560
  s_add_u32 s18, s16, 5120
  s_add_u32 s19, s16, 7680
  s_add_u32 s9, s74, 1
  s_and_b32 s9, s9, 3
  s_mul_i32 s9, s9, 10240
  s_add_u32 s20, s9, s15
  s_add_u32 s21, s20, 2560
  s_add_u32 s22, s20, 5120
  s_add_u32 s23, s20, 7680
  s_add_u32 s9, s74, 2
  s_and_b32 s9, s9, 3
  s_mul_i32 s9, s9, 10240
  s_add_u32 s24, s9, s15
  s_add_u32 s25, s24, 2560
  s_add_u32 s26, s24, 5120
  s_add_u32 s27, s24, 7680
  s_add_u32 s9, s74, 3
  s_and_b32 s9, s9, 3
  s_mul_i32 s9, s9, 10240
  s_add_u32 s28, s9, s15
  s_add_u32 s29, s28, 2560
  s_add_u32 s30, s28, 5120
  s_add_u32 s31, s28, 7680
  s_waitcnt vmcnt(0)
  s_mov_b64 exec, 1
  buffer_atomic_add v12, v15, s[44:47], s76 offen sc1
  s_mov_b64 exec, -1
  ds_write_b32 v10, v12
  s_mov_b32 s14, 0
lz_117:
  ds_read_b32 v254, v0 offset:216
  s_waitcnt lgkmcnt(0)
  v_readfirstlane_b32 s9, v254
  s_nop 0
  s_cmp_eq_u32 s9, 0
  s_cbranch_scc1 lzok_118
  s_sleep 1
  s_add_u32 s14, s14, 1
  s_cmp_lt_u32 s14, 1048576
  s_cbranch_scc1 lz_117
lzok_118:
  ds_read_b64_tr_b16 v[16:17], v248 offset:0
  ds_read_b64_tr_b16 v[18:19], v249 offset:0
  ds_read_b64_tr_b16 v[20:21], v248 offset:32
  ds_read_b64_tr_b16 v[22:23], v249 offset:32
  ds_read_b64_tr_b16 v[24:25], v248 offset:64
  ds_read_b64_tr_b16 v[26:27], v249 offset:64
  ds_read_b64_tr_b16 v[28:29], v248 offset:96
  ds_read_b64_tr_b16 v[30:31], v249 offset:96
  ds_read_b64_tr_b16 v[32:33], v248 offset:128
  ds_read_b64_tr_b16 v[34:35], v249 offset:128
  s_mov_b32 s14, 0
gw_119:
  s_load_dword s9, s[34:35], s76 glc
  s_waitcnt lgkmcnt(0)
  s_cmp_ge_u32 s9, 8
  s_cbranch_scc1 gwok_120
  s_sleep 1
  s_add_u32 s14, s14, 1
  s_cmp_lt_u32 s14, 65536
  s_cbranch_scc1 gw_119
gwok_120:
  buffer_load_dwordx4 v[88:91], v8, s[44:47], s16 offen offset:0 sc1
  buffer_load_dwordx4 v[92:95], v8, s[44:47], s17 offen offset:0 sc1
  buffer_load_dwordx4 v[96:99], v8, s[44:47], s16 offen offset:1024 sc1
  buffer_load_dwordx4 v[100:103], v8, s[44:47], s17 offen offset:1024 sc1
  buffer_load_dwordx4 v[104:107], v8, s[44:47], s18 offen offset:0 sc1
  buffer_load_dwordx4 v[108:111], v8, s[44:47], s19 offen offset:0 sc1
  buffer_load_dwordx4 v[112:115], v8, s[44:47], s18 offen offset:1024 sc1
  buffer_load_dwordx4 v[116:119], v8, s[44:47], s19 offen offset:1024 sc1
  buffer_load_dwordx2 v[120:121], v9, s[44:47], s16 offen offset:2048 sc1
  buffer_load_dwordx2 v[122:123], v9, s[44:47], s18 offen offset:2048 sc1
  buffer_load_dwordx2 v[124:125], v9, s[44:47], s17 offen offset:2048 sc1
  buffer_load_dwordx2 v[126:127], v9, s[44:47], s19 offen offset:2048 sc1
  buffer_load_dwordx4 v[128:131], v8, s[44:47], s20 offen offset:0 sc1
  buffer_load_dwordx4 v[132:135], v8, s[44:47], s21 offen offset:0 sc1
  buffer_load_dwordx4 v[136:139], v8, s[44:47], s20 offen offset:1024 sc1
  buffer_load_dwordx4 v[140:143], v8, s[44:47], s21 offen offset:1024 sc1
  s_waitcnt vmcnt(14)
  v_mfma_f32_16x16x32_bf16 v[48:51], v[16:19], v[88:91], v[48:51]
  ds_read_b64_tr_b16 v[36:37], v250 offset:0
  v_mfma_f32_16x16x32_bf16 v[52:55], v[16:19], v[92:95], v[52:55]
  ds_read_b64_tr_b16 v[38:39], v251 offset:0
  v_mfma_f32_16x16x32_bf16 v[56:59], v[20:23], v[88:91], v[56:59]
  ds_read_b64_tr_b16 v[40:41], v250 offset:32
  v_mfma_f32_16x16x32_bf16 v[60:63], v[20:23], v[92:95], v[60:63]
  ds_read_b64_tr_b16 v[42:43], v251 offset:32
  buffer_load_dwordx4 v[144:147], v8, s[44:47], s22 offen offset:0 sc1
  v_mfma_f32_16x16x32_bf16 v[64:67], v[24:27], v[88:91], v[64:67]
  ds_read_b64_tr_b16 v[44:45], v250 offset:64
  v_mfma_f32_16x16x32_bf16 v[68:71], v[24:27], v[92:95], v[68:71]
  ds_read_b64_tr_b16 v[46:47], v251 offset:64
  v_mfma_f32_16x16x32_bf16 v[72:75], v[28:31], v[88:91], v[72:75]
  ds_read_b64_tr_b16 v[16:17], v250 offset:96
  v_mfma_f32_16x16x32_bf16 v[76:79], v[28:31], v[92:95], v[76:79]
  ds_read_b64_tr_b16 v[18:19], v251 offset:96
  buffer_load_dwordx4 v[148:151], v8, s[44:47], s23 offen offset:0 sc1
  s_waitcnt lgkmcnt(6)
  v_mfma_f32_16x16x32_bf16 v[80:83], v[32:35], v[88:91], v[80:83]
  ds_read_b64_tr_b16 v[20:21], v250 offset:128
  v_mfma_f32_16x16x32_bf16 v[84:87], v[32:35], v[92:95], v[84:87]
  ds_read_b64_tr_b16 v[22:23], v251 offset:128
  s_waitcnt vmcnt(14)
  v_mfma_f32_16x16x32_bf16 v[48:51], v[36:39], v[96:99], v[48:51]
  ds_read_b64_tr_b16 v[24:25], v248 offset:12800
  v_mfma_f32_16x16x32_bf16 v[52:55], v[36:39], v[100:103], v[52:55]
  ds_read_b64_tr_b16 v[26:27], v249 offset:12800
  buffer_load_dwordx4 v[152:155], v8, s[44:47], s22 offen offset:1024 sc1
  s_waitcnt lgkmcnt(6)
  v_mfma_f32_16x16x32_bf16 v[56:59], v[40:43], v[96:99], v[56:59]
  ds_read_b64_tr_b16 v[28:29], v248 offset:12832
  v_mfma_f32_16x16x32_bf16 v[60:63], v[40:43], v[100:103], v[60:63]
  ds_read_b64_tr_b16 v[30:31], v249 offset:12832
  v_mfma_f32_16x16x32_bf16 v[64:67], v[44:47], v[96:99], v[64:67]
  ds_read_b64_tr_b16 v[32:33], v248 offset:12864
  v_mfma_f32_16x16x32_bf16 v[68:71], v[44:47], v[100:103], v[68:71]
  ds_read_b64_tr_b16 v[34:35], v249 offset:12864
  buffer_load_dwordx4 v[156:159], v8, s[44:47], s23 offen offset:1024 sc1
  s_waitcnt lgkmcnt(6)
  v_mfma_f32_16x16x32_bf16 v[72:75], v[16:19], v[96:99], v[72:75]
  ds_read_b64_tr_b16 v[36:37], v248 offset:12896
  v_mfma_f32_16x16x32_bf16 v[76:79], v[16:19], v[100:103], v[76:79]
  ds_read_b64_tr_b16 v[38:39], v249 offset:12896
  v_mfma_f32_16x16x32_bf16 v[80:83], v[20:23], v[96:99], v[80:83]
  ds_read_b64_tr_b16 v[40:41], v248 offset:12928
  v_mfma_f32_16x16x32_bf16 v[84:87], v[20:23], v[100:103], v[84:87]
  ds_read_b64_tr_b16 v[42:43], v249 offset:12928
  buffer_load_dwordx2 v[160:161], v9, s[44:47], s20 offen offset:2048 sc1
  v_add_u32 v248, s67, v248
  v_add_u32 v249, s67, v249
  s_waitcnt vmcnt(15)
  s_waitcnt lgkmcnt(6)
  v_mfma_f32_16x16x32_bf16 v[48:51], v[24:27], v[104:107], v[48:51]
  ds_read_b64_tr_b16 v[44:45], v250 offset:12800
  v_mfma_f32_16x16x32_bf16 v[52:55], v[24:27], v[108:111], v[52:55]
  ds_read_b64_tr_b16 v[46:47], v251 offset:12800
  v_mfma_f32_16x16x32_bf16 v[56:59], v[28:31], v[104:107], v[56:59]
  ds_read_b64_tr_b16 v[16:17], v250 offset:12832
  v_mfma_f32_16x16x32_bf16 v[60:63], v[28:31], v[108:111], v[60:63]
  ds_read_b64_tr_b16 v[18:19], v251 offset:12832
  buffer_load_dwordx2 v[162:163], v9, s[44:47], s22 offen offset:2048 sc1
  s_waitcnt lgkmcnt(6)
  v_mfma_f32_16x16x32_bf16 v[64:67], v[32:35], v[104:107], v[64:67]
  ds_read_b64_tr_b16 v[20:21], v250 offset:12864
  v_mfma_f32_16x16x32_bf16 v[68:71], v[32:35], v[108:111], v[68:71]
  ds_read_b64_tr_b16 v[22:23], v251 offset:12864
  v_mfma_f32_16x16x32_bf16 v[72:75], v[36:39], v[104:107], v[72:75]
  ds_read_b64_tr_b16 v[24:25], v250 offset:12896
  v_mfma_f32_16x16x32_bf16 v[76:79], v[36:39], v[108:111], v[76:79]
  ds_read_b64_tr_b16 v[26:27], v251 offset:12896
  buffer_load_dwordx2 v[164:165], v9, s[44:47], s21 offen offset:2048 sc1
  s_waitcnt lgkmcnt(6)
  v_mfma_f32_16x16x32_bf16 v[80:83], v[40:43], v[104:107], v[80:83]
  ds_read_b64_tr_b16 v[28:29], v250 offset:12928
  v_mfma_f32_16x16x32_bf16 v[84:87], v[40:43], v[108:111], v[84:87]
  ds_read_b64_tr_b16 v[30:31], v251 offset:12928
  v_add_u32 v250, s67, v250
  v_add_u32 v251, s67, v251
  s_waitcnt vmcnt(15)
  v_mfma_f32_16x16x32_bf16 v[48:51], v[44:47], v[112:115], v[48:51]
  ds_read_b64_tr_b16 v[32:33], v252 offset:2560
  v_mfma_f32_16x16x32_bf16 v[52:55], v[44:47], v[116:119], v[52:55]
  ds_read_b64_tr_b16 v[34:35], v252 offset:15360
  buffer_load_dwordx2 v[166:167], v9, s[44:47], s23 offen offset:2048 sc1
  s_waitcnt lgkmcnt(6)
  v_mfma_f32_16x16x32_bf16 v[56:59], v[16:19], v[112:115], v[56:59]
  ds_read_b64_tr_b16 v[36:37], v252 offset:2592
  v_mfma_f32_16x16x32_bf16 v[60:63], v[16:19], v[116:119], v[60:63]
  ds_read_b64_tr_b16 v[38:39], v252 offset:15392
  v_mfma_f32_16x16x32_bf16 v[64:67], v[20:23], v[112:115], v[64:67]
  ds_read_b64_tr_b16 v[40:41], v252 offset:2624
  v_mfma_f32_16x16x32_bf16 v[68:71], v[20:23], v[116:119], v[68:71]
  ds_read_b64_tr_b16 v[42:43], v252 offset:15424
  buffer_load_dwordx4 v[168:171], v8, s[44:47], s24 offen offset:0 sc1
  s_waitcnt lgkmcnt(6)
  v_mfma_f32_16x16x32_bf16 v[72:75], v[24:27], v[112:115], v[72:75]
  ds_read_b64_tr_b16 v[44:45], v252 offset:2656
  v_mfma_f32_16x16x32_bf16 v[76:79], v[24:27], v[116:119], v[76:79]
  ds_read_b64_tr_b16 v[46:47], v252 offset:15456
  v_mfma_f32_16x16x32_bf16 v[80:83], v[28:31], v[112:115], v[80:83]
  ds_read_b64_tr_b16 v[16:17], v252 offset:2688
  v_mfma_f32_16x16x32_bf16 v[84:87], v[28:31], v[116:119], v[84:87]
  ds_read_b64_tr_b16 v[18:19], v252 offset:15488
  buffer_load_dwordx4 v[172:175], v8, s[44:47], s25 offen offset:0 sc1
  v_add_u32 v252, s67, v252
  s_waitcnt vmcnt(14)
  s_waitcnt lgkmcnt(6)
  v_mfma_f32_16x16x32_bf16 v[48:51], v[32:35], v[120:123], v[48:51]
  ds_read_b64_tr_b16 v[20:21], v248 offset:0
  v_mfma_f32_16x16x32_bf16 v[52:55], v[32:35], v[124:127], v[52:55]
  ds_read_b64_tr_b16 v[22:23], v249 offset:0
  v_mfma_f32_16x16x32_bf16 v[56:59], v[36:39], v[120:123], v[56:59]
  ds_read_b64_tr_b16 v[24:25], v248 offset:32
  v_mfma_f32_16x16x32_bf16 v[60:63], v[36:39], v[124:127], v[60:63]
  ds_read_b64_tr_b16 v[26:27], v249 offset:32
  buffer_load_dwordx4 v[176:179], v8, s[44:47], s24 offen offset:1024 sc1
  s_waitcnt lgkmcnt(6)
  v_mfma_f32_16x16x32_bf16 v[64:67], v[40:43], v[120:123], v[64:67]
  ds_read_b64_tr_b16 v[28:29], v248 offset:64
  v_mfma_f32_16x16x32_bf16 v[68:71], v[40:43], v[124:127], v[68:71]
  ds_read_b64_tr_b16 v[30:31], v249 offset:64
  v_mfma_f32_16x16x32_bf16 v[72:75], v[44:47], v[120:123], v[72:75]
  ds_read_b64_tr_b16 v[32:33], v248 offset:96
  v_mfma_f32_16x16x32_bf16 v[76:79], v[44:47], v[124:127], v[76:79]
  ds_read_b64_tr_b16 v[34:35], v249 offset:96
  buffer_load_dwordx4 v[180:183], v8, s[44:47], s25 offen offset:1024 sc1
  s_waitcnt lgkmcnt(6)
  v_mfma_f32_16x16x32_bf16 v[80:83], v[16:19], v[120:123], v[80:83]
  ds_read_b64_tr_b16 v[36:37], v248 offset:128
  v_mfma_f32_16x16x32_bf16 v[84:87], v[16:19], v[124:127], v[84:87]
  ds_read_b64_tr_b16 v[38:39], v249 offset:128
  v_mov_b32 v13, 2
  ds_write_b32 v10, v13
  s_waitcnt vmcnt(14)
  v_mfma_f32_16x16x32_bf16 v[48:51], v[20:23], v[128:131], v[48:51]
  ds_read_b64_tr_b16 v[40:41], v250 offset:0
  v_mfma_f32_16x16x32_bf16 v[52:55], v[20:23], v[132:135], v[52:55]
  ds_read_b64_tr_b16 v[42:43], v251 offset:0
  buffer_load_dwordx4 v[184:187], v8, s[44:47], s26 offen offset:0 sc1
  s_waitcnt lgkmcnt(7)
  v_mfma_f32_16x16x32_bf16 v[56:59], v[24:27], v[128:131], v[56:59]
  ds_read_b64_tr_b16 v[44:45], v250 offset:32
  v_mfma_f32_16x16x32_bf16 v[60:63], v[24:27], v[132:135], v[60:63]
  ds_read_b64_tr_b16 v[46:47], v251 offset:32
  v_mfma_f32_16x16x32_bf16 v[64:67], v[28:31], v[128:131], v[64:67]
  ds_read_b64_tr_b16 v[16:17], v250 offset:64
  v_mfma_f32_16x16x32_bf16 v[68:71], v[28:31], v[132:135], v[68:71]
  ds_read_b64_tr_b16 v[18:19], v251 offset:64
  buffer_load_dwordx4 v[188:191], v8, s[44:47], s27 offen offset:0 sc1
  s_waitcnt lgkmcnt(7)
  v_mfma_f32_16x16x32_bf16 v[72:75], v[32:35], v[128:131], v[72:75]
  ds_read_b64_tr_b16 v[20:21], v250 offset:96
  v_mfma_f32_16x16x32_bf16 v[76:79], v[32:35], v[132:135], v[76:79]
  ds_read_b64_tr_b16 v[22:23], v251 offset:96
  v_mfma_f32_16x16x32_bf16 v[80:83], v[36:39], v[128:131], v[80:83]
  ds_read_b64_tr_b16 v[24:25], v250 offset:128
  v_mfma_f32_16x16x32_bf16 v[84:87], v[36:39], v[132:135], v[84:87]
  ds_read_b64_tr_b16 v[26:27], v251 offset:128
  buffer_load_dwordx4 v[192:195], v8, s[44:47], s26 offen offset:1024 sc1
  s_waitcnt vmcnt(15)
  s_waitcnt lgkmcnt(6)
  v_mfma_f32_16x16x32_bf16 v[48:51], v[40:43], v[136:139], v[48:51]
  ds_read_b64_tr_b16 v[28:29], v248 offset:12800
  v_mfma_f32_16x16x32_bf16 v[52:55], v[40:43], v[140:143], v[52:55]
  ds_read_b64_tr_b16 v[30:31], v249 offset:12800
  v_mfma_f32_16x16x32_bf16 v[56:59], v[44:47], v[136:139], v[56:59]
  ds_read_b64_tr_b16 v[32:33], v248 offset:12832
  v_mfma_f32_16x16x32_bf16 v[60:63], v[44:47], v[140:143], v[60:63]
  ds_read_b64_tr_b16 v[34:35], v249 offset:12832
  buffer_load_dwordx4 v[196:199], v8, s[44:47], s27 offen offset:1024 sc1
  s_waitcnt lgkmcnt(6)
  v_mfma_f32_16x16x32_bf16 v[64:67], v[16:19], v[136:139], v[64:67]
  ds_read_b64_tr_b16 v[36:37], v248 offset:12864
  v_mfma_f32_16x16x32_bf16 v[68:71], v[16:19], v[140:143], v[68:71]
  ds_read_b64_tr_b16 v[38:39], v249 offset:12864
  v_mfma_f32_16x16x32_bf16 v[72:75], v[20:23], v[136:139], v[72:75]
  ds_read_b64_tr_b16 v[40:41], v248 offset:12896
  v_mfma_f32_16x16x32_bf16 v[76:79], v[20:23], v[140:143], v[76:79]
  ds_read_b64_tr_b16 v[42:43], v249 offset:12896
  buffer_load_dwordx2 v[200:201], v9, s[44:47], s24 offen offset:2048 sc1
  s_waitcnt lgkmcnt(6)
  v_mfma_f32_16x16x32_bf16 v[80:83], v[24:27], v[136:139], v[80:83]
  ds_read_b64_tr_b16 v[44:45], v248 offset:12928
  v_mfma_f32_16x16x32_bf16 v[84:87], v[24:27], v[140:143], v[84:87]
  ds_read_b64_tr_b16 v[46:47], v249 offset:12928
  v_add_u32 v248, s68, v248
  v_add_u32 v249, s68, v249
  s_waitcnt vmcnt(15)
  v_mfma_f32_16x16x32_bf16 v[48:51], v[28:31], v[144:147], v[48:51]
  ds_read_b64_tr_b16 v[16:17], v250 offset:12800
  v_mfma_f32_16x16x32_bf16 v[52:55], v[28:31], v[148:151], v[52:55]
  ds_read_b64_tr_b16 v[18:19], v251 offset:12800
  buffer_load_dwordx2 v[202:203], v9, s[44:47], s26 offen offset:2048 sc1
  s_waitcnt lgkmcnt(6)
  v_mfma_f32_16x16x32_bf16 v[56:59], v[32:35], v[144:147], v[56:59]
  ds_read_b64_tr_b16 v[20:21], v250 offset:12832
  v_mfma_f32_16x16x32_bf16 v[60:63], v[32:35], v[148:151], v[60:63]
  ds_read_b64_tr_b16 v[22:23], v251 offset:12832
  v_mfma_f32_16x16x32_bf16 v[64:67], v[36:39], v[144:147], v[64:67]
  ds_read_b64_tr_b16 v[24:25], v250 offset:12864
  v_mfma_f32_16x16x32_bf16 v[68:71], v[36:39], v[148:151], v[68:71]
  ds_read_b64_tr_b16 v[26:27], v251 offset:12864
  buffer_load_dwordx2 v[204:205], v9, s[44:47], s25 offen offset:2048 sc1
  s_waitcnt lgkmcnt(6)
  v_mfma_f32_16x16x32_bf16 v[72:75], v[40:43], v[144:147], v[72:75]
  ds_read_b64_tr_b16 v[28:29], v250 offset:12896
  v_mfma_f32_16x16x32_bf16 v[76:79], v[40:43], v[148:151], v[76:79]
  ds_read_b64_tr_b16 v[30:31], v251 offset:12896
  v_mfma_f32_16x16x32_bf16 v[80:83], v[44:47], v[144:147], v[80:83]
  ds_read_b64_tr_b16 v[32:33], v250 offset:12928
  v_mfma_f32_16x16x32_bf16 v[84:87], v[44:47], v[148:151], v[84:87]
  ds_read_b64_tr_b16 v[34:35], v251 offset:12928
  buffer_load_dwordx2 v[206:207], v9, s[44:47], s27 offen offset:2048 sc1
  v_add_u32 v250, s68, v250
  v_add_u32 v251, s68, v251
  s_waitcnt vmcnt(16)
  s_waitcnt lgkmcnt(6)
  v_mfma_f32_16x16x32_bf16 v[48:51], v[16:19], v[152:155], v[48:51]
  ds_read_b64_tr_b16 v[36:37], v252 offset:2560
  v_mfma_f32_16x16x32_bf16 v[52:55], v[16:19], v[156:159], v[52:55]
  ds_read_b64_tr_b16 v[38:39], v252 offset:15360
  v_mfma_f32_16x16x32_bf16 v[56:59], v[20:23], v[152:155], v[56:59]
  ds_read_b64_tr_b16 v[40:41], v252 offset:2592
  v_mfma_f32_16x16x32_bf16 v[60:63], v[20:23], v[156:159], v[60:63]
  ds_read_b64_tr_b16 v[42:43], v252 offset:15392
  buffer_load_dwordx4 v[208:211], v8, s[44:47], s28 offen offset:0 sc1
  s_waitcnt lgkmcnt(6)
  v_mfma_f32_16x16x32_bf16 v[64:67], v[24:27], v[152:155], v[64:67]
  ds_read_b64_tr_b16 v[44:45], v252 offset:2624
  v_mfma_f32_16x16x32_bf16 v[68:71], v[24:27], v[156:159], v[68:71]
  ds_read_b64_tr_b16 v[46:47], v252 offset:15424
  v_mfma_f32_16x16x32_bf16 v[72:75], v[28:31], v[152:155], v[72:75]
  ds_read_b64_tr_b16 v[16:17], v252 offset:2656
  v_mfma_f32_16x16x32_bf16 v[76:79], v[28:31], v[156:159], v[76:79]
  ds_read_b64_tr_b16 v[18:19], v252 offset:15456
  buffer_load_dwordx4 v[212:215], v8, s[44:47], s29 offen offset:0 sc1
  s_waitcnt lgkmcnt(6)
  v_mfma_f32_16x16x32_bf16 v[80:83], v[32:35], v[152:155], v[80:83]
  ds_read_b64_tr_b16 v[20:21], v252 offset:2688
  v_mfma_f32_16x16x32_bf16 v[84:87], v[32:35], v[156:159], v[84:87]
  ds_read_b64_tr_b16 v[22:23], v252 offset:15488
  v_add_u32 v252, s68, v252
  s_waitcnt vmcnt(14)
  v_mfma_f32_16x16x32_bf16 v[48:51], v[36:39], v[160:163], v[48:51]
  ds_read_b64_tr_b16 v[24:25], v248 offset:0
  v_mfma_f32_16x16x32_bf16 v[52:55], v[36:39], v[164:167], v[52:55]
  ds_read_b64_tr_b16 v[26:27], v249 offset:0
  buffer_load_dwordx4 v[216:219], v8, s[44:47], s28 offen offset:1024 sc1
  s_waitcnt lgkmcnt(6)
  v_mfma_f32_16x16x32_bf16 v[56:59], v[40:43], v[160:163], v[56:59]
  ds_read_b64_tr_b16 v[28:29], v248 offset:32
  v_mfma_f32_16x16x32_bf16 v[60:63], v[40:43], v[164:167], v[60:63]
  ds_read_b64_tr_b16 v[30:31], v249 offset:32
  v_mfma_f32_16x16x32_bf16 v[64:67], v[44:47], v[160:163], v[64:67]
  ds_read_b64_tr_b16 v[32:33], v248 offset:64
  v_mfma_f32_16x16x32_bf16 v[68:71], v[44:47], v[164:167], v[68:71]
  ds_read_b64_tr_b16 v[34:35], v249 offset:64
  buffer_load_dwordx4 v[220:223], v8, s[44:47], s29 offen offset:1024 sc1
  s_waitcnt lgkmcnt(6)
  v_mfma_f32_16x16x32_bf16 v[72:75], v[16:19], v[160:163], v[72:75]
  ds_read_b64_tr_b16 v[36:37], v248 offset:96
  v_mfma_f32_16x16x32_bf16 v[76:79], v[16:19], v[164:167], v[76:79]
  ds_read_b64_tr_b16 v[38:39], v249 offset:96
  v_mfma_f32_16x16x32_bf16 v[80:83], v[20:23], v[160:163], v[80:83]
  ds_read_b64_tr_b16 v[40:41], v248 offset:128
  v_mfma_f32_16x16x32_bf16 v[84:87], v[20:23], v[164:167], v[84:87]
  ds_read_b64_tr_b16 v[42:43], v249 offset:128
  buffer_load_dwordx4 v[224:227], v8, s[44:47], s30 offen offset:0 sc1
  s_waitcnt vmcnt(15)
  s_waitcnt lgkmcnt(6)
  v_mfma_f32_16x16x32_bf16 v[48:51], v[24:27], v[168:171], v[48:51]
  ds_read_b64_tr_b16 v[44:45], v250 offset:0
  v_mfma_f32_16x16x32_bf16 v[52:55], v[24:27], v[172:175], v[52:55]
  ds_read_b64_tr_b16 v[46:47], v251 offset:0
  v_mov_b32 v13, 3
  ds_write_b32 v10, v13
  v_mfma_f32_16x16x32_bf16 v[56:59], v[28:31], v[168:171], v[56:59]
  ds_read_b64_tr_b16 v[16:17], v250 offset:32
  v_mfma_f32_16x16x32_bf16 v[60:63], v[28:31], v[172:175], v[60:63]
  ds_read_b64_tr_b16 v[18:19], v251 offset:32
  buffer_load_dwordx4 v[228:231], v8, s[44:47], s31 offen offset:0 sc1
  s_waitcnt lgkmcnt(7)
  v_mfma_f32_16x16x32_bf16 v[64:67], v[32:35], v[168:171], v[64:67]
  ds_read_b64_tr_b16 v[20:21], v250 offset:64
  v_mfma_f32_16x16x32_bf16 v[68:71], v[32:35], v[172:175], v[68:71]
  ds_read_b64_tr_b16 v[22:23], v251 offset:64
  v_mfma_f32_16x16x32_bf16 v[72:75], v[36:39], v[168:171], v[72:75]
  ds_read_b64_tr_b16 v[24:25], v250 offset:96
  v_mfma_f32_16x16x32_bf16 v[76:79], v[36:39], v[172:175], v[76:79]
  ds_read_b64_tr_b16 v[26:27], v251 offset:96
  buffer_load_dwordx4 v[232:235], v8, s[44:47], s30 offen offset:1024 sc1
  s_waitcnt lgkmcnt(7)
  v_mfma_f32_16x16x32_bf16 v[80:83], v[40:43], v[168:171], v[80:83]
  ds_read_b64_tr_b16 v[28:29], v250 offset:128
  v_mfma_f32_16x16x32_bf16 v[84:87], v[40:43], v[172:175], v[84:87]
  ds_read_b64_tr_b16 v[30:31], v251 offset:128
  s_waitcnt vmcnt(15)
  v_mfma_f32_16x16x32_bf16 v[48:51], v[44:47], v[176:179], v[48:51]
  ds_read_b64_tr_b16 v[32:33], v248 offset:12800
  v_mfma_f32_16x16x32_bf16 v[52:55], v[44:47], v[180:183], v[52:55]
  ds_read_b64_tr_b16 v[34:35], v249 offset:12800
  buffer_load_dwordx4 v[236:239], v8, s[44:47], s31 offen offset:1024 sc1
  s_waitcnt lgkmcnt(6)
  v_mfma_f32_16x16x32_bf16 v[56:59], v[16:19], v[176:179], v[56:59]
  ds_read_b64_tr_b16 v[36:37], v248 offset:12832
  v_mfma_f32_16x16x32_bf16 v[60:63], v[16:19], v[180:183], v[60:63]
  ds_read_b64_tr_b16 v[38:39], v249 offset:12832
  v_mfma_f32_16x16x32_bf16 v[64:67], v[20:23], v[176:179], v[64:67]
  ds_read_b64_tr_b16 v[40:41], v248 offset:12864
  v_mfma_f32_16x16x32_bf16 v[68:71], v[20:23], v[180:183], v[68:71]
  ds_read_b64_tr_b16 v[42:43], v249 offset:12864
  buffer_load_dwordx2 v[240:241], v9, s[44:47], s28 offen offset:2048 sc1
  s_waitcnt lgkmcnt(6)
  v_mfma_f32_16x16x32_bf16 v[72:75], v[24:27], v[176:179], v[72:75]
  ds_read_b64_tr_b16 v[44:45], v248 offset:12896
  v_mfma_f32_16x16x32_bf16 v[76:79], v[24:27], v[180:183], v[76:79]
  ds_read_b64_tr_b16 v[46:47], v249 offset:12896
  v_mfma_f32_16x16x32_bf16 v[80:83], v[28:31], v[176:179], v[80:83]
  ds_read_b64_tr_b16 v[16:17], v248 offset:12928
  v_mfma_f32_16x16x32_bf16 v[84:87], v[28:31], v[180:183], v[84:87]
  ds_read_b64_tr_b16 v[18:19], v249 offset:12928
  buffer_load_dwordx2 v[242:243], v9, s[44:47], s30 offen offset:2048 sc1
  v_add_u32 v248, s69, v248
  v_add_u32 v249, s69, v249
  s_waitcnt vmcnt(16)
  s_waitcnt lgkmcnt(6)
  v_mfma_f32_16x16x32_bf16 v[48:51], v[32:35], v[184:187], v[48:51]
  ds_read_b64_tr_b16 v[20:21], v250 offset:12800
  v_mfma_f32_16x16x32_bf16 v[52:55], v[32:35], v[188:191], v[52:55]
  ds_read_b64_tr_b16 v[22:23], v251 offset:12800
  v_mfma_f32_16x16x32_bf16 v[56:59], v[36:39], v[184:187], v[56:59]
  ds_read_b64_tr_b16 v[24:25], v250 offset:12832
  v_mfma_f32_16x16x32_bf16 v[60:63], v[36:39], v[188:191], v[60:63]
  ds_read_b64_tr_b16 v[26:27], v251 offset:12832
  buffer_load_dwordx2 v[244:245], v9, s[44:47], s29 offen offset:2048 sc1
  s_waitcnt lgkmcnt(6)
  v_mfma_f32_16x16x32_bf16 v[64:67], v[40:43], v[184:187], v[64:67]
  ds_read_b64_tr_b16 v[28:29], v250 offset:12864
  v_mfma_f32_16x16x32_bf16 v[68:71], v[40:43], v[188:191], v[68:71]
  ds_read_b64_tr_b16 v[30:31], v251 offset:12864
  v_mfma_f32_16x16x32_bf16 v[72:75], v[44:47], v[184:187], v[72:75]
  ds_read_b64_tr_b16 v[32:33], v250 offset:12896
  v_mfma_f32_16x16x32_bf16 v[76:79], v[44:47], v[188:191], v[76:79]
  ds_read_b64_tr_b16 v[34:35], v251 offset:12896
  buffer_load_dwordx2 v[246:247], v9, s[44:47], s31 offen offset:2048 sc1
  s_waitcnt lgkmcnt(6)
  v_mfma_f32_16x16x32_bf16 v[80:83], v[16:19], v[184:187], v[80:83]
  ds_read_b64_tr_b16 v[36:37], v250 offset:12928
  v_mfma_f32_16x16x32_bf16 v[84:87], v[16:19], v[188:191], v[84:87]
  ds_read_b64_tr_b16 v[38:39], v251 offset:12928
  v_add_u32 v250, s69, v250
  v_add_u32 v251, s69, v251
  s_waitcnt vmcnt(16)
  v_mfma_f32_16x16x32_bf16 v[48:51], v[20:23], v[192:195], v[48:51]
  ds_read_b64_tr_b16 v[40:41], v252 offset:2560
  v_mfma_f32_16x16x32_bf16 v[52:55], v[20:23], v[196:199], v[52:55]
  ds_read_b64_tr_b16 v[42:43], v252 offset:15360
  s_waitcnt lgkmcnt(6)
  v_mfma_f32_16x16x32_bf16 v[56:59], v[24:27], v[192:195], v[56:59]
  ds_read_b64_tr_b16 v[44:45], v252 offset:2592
  v_mfma_f32_16x16x32_bf16 v[60:63], v[24:27], v[196:199], v[60:63]
  ds_read_b64_tr_b16 v[46:47], v252 offset:15392
  v_mfma_f32_16x16x32_bf16 v[64:67], v[28:31], v[192:195], v[64:67]
  ds_read_b64_tr_b16 v[16:17], v252 offset:2624
  v_mfma_f32_16x16x32_bf16 v[68:71], v[28:31], v[196:199], v[68:71]
  ds_read_b64_tr_b16 v[18:19], v252 offset:15424
  s_waitcnt lgkmcnt(6)
  v_mfma_f32_16x16x32_bf16 v[72:75], v[32:35], v[192:195], v[72:75]
  ds_read_b64_tr_b16 v[20:21], v252 offset:2656
  v_mfma_f32_16x16x32_bf16 v[76:79], v[32:35], v[196:199], v[76:79]
  ds_read_b64_tr_b16 v[22:23], v252 offset:15456
  v_mfma_f32_16x16x32_bf16 v[80:83], v[36:39], v[192:195], v[80:83]
  ds_read_b64_tr_b16 v[24:25], v252 offset:2688
  v_mfma_f32_16x16x32_bf16 v[84:87], v[36:39], v[196:199], v[84:87]
  ds_read_b64_tr_b16 v[26:27], v252 offset:15488
  v_add_u32 v252, s69, v252
  s_waitcnt vmcnt(12)
  s_waitcnt lgkmcnt(6)
  v_mfma_f32_16x16x32_bf16 v[48:51], v[40:43], v[200:203], v[48:51]
  ds_read_b64_tr_b16 v[28:29], v248 offset:0
  v_mfma_f32_16x16x32_bf16 v[52:55], v[40:43], v[204:207], v[52:55]
  ds_read_b64_tr_b16 v[30:31], v249 offset:0
  v_mfma_f32_16x16x32_bf16 v[56:59], v[44:47], v[200:203], v[56:59]
  ds_read_b64_tr_b16 v[32:33], v248 offset:32
  v_mfma_f32_16x16x32_bf16 v[60:63], v[44:47], v[204:207], v[60:63]
  ds_read_b64_tr_b16 v[34:35], v249 offset:32
  s_waitcnt lgkmcnt(6)
  v_mfma_f32_16x16x32_bf16 v[64:67], v[16:19], v[200:203], v[64:67]
  ds_read_b64_tr_b16 v[36:37], v248 offset:64
  v_mfma_f32_16x16x32_bf16 v[68:71], v[16:19], v[204:207], v[68:71]
  ds_read_b64_tr_b16 v[38:39], v249 offset:64
  v_mfma_f32_16x16x32_bf16 v[72:75], v[20:23], v[200:203], v[72:75]
  ds_read_b64_tr_b16 v[40:41], v248 offset:96
  v_mfma_f32_16x16x32_bf16 v[76:79], v[20:23], v[204:207], v[76:79]
  ds_read_b64_tr_b16 v[42:43], v249 offset:96
  s_waitcnt lgkmcnt(6)
  v_mfma_f32_16x16x32_bf16 v[80:83], v[24:27], v[200:203], v[80:83]
  ds_read_b64_tr_b16 v[44:45], v248 offset:128
  v_mfma_f32_16x16x32_bf16 v[84:87], v[24:27], v[204:207], v[84:87]
  ds_read_b64_tr_b16 v[46:47], v249 offset:128
  s_waitcnt vmcnt(10)
  v_mfma_f32_16x16x32_bf16 v[48:51], v[28:31], v[208:211], v[48:51]
  ds_read_b64_tr_b16 v[16:17], v250 offset:0
  v_mfma_f32_16x16x32_bf16 v[52:55], v[28:31], v[212:215], v[52:55]
  ds_read_b64_tr_b16 v[18:19], v251 offset:0
  s_waitcnt lgkmcnt(6)
  v_mfma_f32_16x16x32_bf16 v[56:59], v[32:35], v[208:211], v[56:59]
  ds_read_b64_tr_b16 v[20:21], v250 offset:32
  v_mfma_f32_16x16x32_bf16 v[60:63], v[32:35], v[212:215], v[60:63]
  ds_read_b64_tr_b16 v[22:23], v251 offset:32
  v_mfma_f32_16x16x32_bf16 v[64:67], v[36:39], v[208:211], v[64:67]
  ds_read_b64_tr_b16 v[24:25], v250 offset:64
  v_mfma_f32_16x16x32_bf16 v[68:71], v[36:39], v[212:215], v[68:71]
  ds_read_b64_tr_b16 v[26:27], v251 offset:64
  s_waitcnt lgkmcnt(6)
  v_mfma_f32_16x16x32_bf16 v[72:75], v[40:43], v[208:211], v[72:75]
  ds_read_b64_tr_b16 v[28:29], v250 offset:96
  v_mfma_f32_16x16x32_bf16 v[76:79], v[40:43], v[212:215], v[76:79]
  ds_read_b64_tr_b16 v[30:31], v251 offset:96
  v_mfma_f32_16x16x32_bf16 v[80:83], v[44:47], v[208:211], v[80:83]
  ds_read_b64_tr_b16 v[32:33], v250 offset:128
  v_mfma_f32_16x16x32_bf16 v[84:87], v[44:47], v[212:215], v[84:87]
  ds_read_b64_tr_b16 v[34:35], v251 offset:128
  s_waitcnt vmcnt(8)
  s_waitcnt lgkmcnt(6)
  v_mfma_f32_16x16x32_bf16 v[48:51], v[16:19], v[216:219], v[48:51]
  ds_read_b64_tr_b16 v[36:37], v248 offset:12800
  v_mfma_f32_16x16x32_bf16 v[52:55], v[16:19], v[220:223], v[52:55]
  ds_read_b64_tr_b16 v[38:39], v249 offset:12800
  v_mfma_f32_16x16x32_bf16 v[56:59], v[20:23], v[216:219], v[56:59]
  ds_read_b64_tr_b16 v[40:41], v248 offset:12832
  v_mfma_f32_16x16x32_bf16 v[60:63], v[20:23], v[220:223], v[60:63]
  ds_read_b64_tr_b16 v[42:43], v249 offset:12832
  s_waitcnt lgkmcnt(6)
  v_mfma_f32_16x16x32_bf16 v[64:67], v[24:27], v[216:219], v[64:67]
  ds_read_b64_tr_b16 v[44:45], v248 offset:12864
  v_mfma_f32_16x16x32_bf16 v[68:71], v[24:27], v[220:223], v[68:71]
  ds_read_b64_tr_b16 v[46:47], v249 offset:12864
  v_mfma_f32_16x16x32_bf16 v[72:75], v[28:31], v[216:219], v[72:75]
  ds_read_b64_tr_b16 v[16:17], v248 offset:12896
  v_mfma_f32_16x16x32_bf16 v[76:79], v[28:31], v[220:223], v[76:79]
  ds_read_b64_tr_b16 v[18:19], v249 offset:12896
  s_waitcnt lgkmcnt(6)
  v_mfma_f32_16x16x32_bf16 v[80:83], v[32:35], v[216:219], v[80:83]
  ds_read_b64_tr_b16 v[20:21], v248 offset:12928
  v_mfma_f32_16x16x32_bf16 v[84:87], v[32:35], v[220:223], v[84:87]
  ds_read_b64_tr_b16 v[22:23], v249 offset:12928
  s_waitcnt vmcnt(6)
  v_mfma_f32_16x16x32_bf16 v[48:51], v[36:39], v[224:227], v[48:51]
  ds_read_b64_tr_b16 v[24:25], v250 offset:12800
  v_mfma_f32_16x16x32_bf16 v[52:55], v[36:39], v[228:231], v[52:55]
  ds_read_b64_tr_b16 v[26:27], v251 offset:12800
  s_waitcnt lgkmcnt(6)
  v_mfma_f32_16x16x32_bf16 v[56:59], v[40:43], v[224:227], v[56:59]
  ds_read_b64_tr_b16 v[28:29], v250 offset:12832
  v_mfma_f32_16x16x32_bf16 v[60:63], v[40:43], v[228:231], v[60:63]
  ds_read_b64_tr_b16 v[30:31], v251 offset:12832
  v_mfma_f32_16x16x32_bf16 v[64:67], v[44:47], v[224:227], v[64:67]
  ds_read_b64_tr_b16 v[32:33], v250 offset:12864
  v_mfma_f32_16x16x32_bf16 v[68:71], v[44:47], v[228:231], v[68:71]
  ds_read_b64_tr_b16 v[34:35], v251 offset:12864
  s_waitcnt lgkmcnt(6)
  v_mfma_f32_16x16x32_bf16 v[72:75], v[16:19], v[224:227], v[72:75]
  ds_read_b64_tr_b16 v[36:37], v250 offset:12896
  v_mfma_f32_16x16x32_bf16 v[76:79], v[16:19], v[228:231], v[76:79]
  ds_read_b64_tr_b16 v[38:39], v251 offset:12896
  v_mfma_f32_16x16x32_bf16 v[80:83], v[20:23], v[224:227], v[80:83]
  ds_read_b64_tr_b16 v[40:41], v250 offset:12928
  v_mfma_f32_16x16x32_bf16 v[84:87], v[20:23], v[228:231], v[84:87]
  ds_read_b64_tr_b16 v[42:43], v251 offset:12928
  s_waitcnt vmcnt(4)
  s_waitcnt lgkmcnt(6)
  v_mfma_f32_16x16x32_bf16 v[48:51], v[24:27], v[232:235], v[48:51]
  ds_read_b64_tr_b16 v[44:45], v252 offset:2560
  v_mfma_f32_16x16x32_bf16 v[52:55], v[24:27], v[236:239], v[52:55]
  ds_read_b64_tr_b16 v[46:47], v252 offset:15360
  v_mfma_f32_16x16x32_bf16 v[56:59], v[28:31], v[232:235], v[56:59]
  ds_read_b64_tr_b16 v[16:17], v252 offset:2592
  v_mfma_f32_16x16x32_bf16 v[60:63], v[28:31], v[236:239], v[60:63]
  ds_read_b64_tr_b16 v[18:19], v252 offset:15392
  s_waitcnt lgkmcnt(6)
  v_mfma_f32_16x16x32_bf16 v[64:67], v[32:35], v[232:235], v[64:67]
  ds_read_b64_tr_b16 v[20:21], v252 offset:2624
  v_mfma_f32_16x16x32_bf16 v[68:71], v[32:35], v[236:239], v[68:71]
  ds_read_b64_tr_b16 v[22:23], v252 offset:15424
  v_mfma_f32_16x16x32_bf16 v[72:75], v[36:39], v[232:235], v[72:75]
  ds_read_b64_tr_b16 v[24:25], v252 offset:2656
  v_mfma_f32_16x16x32_bf16 v[76:79], v[36:39], v[236:239], v[76:79]
  ds_read_b64_tr_b16 v[26:27], v252 offset:15456
  s_waitcnt lgkmcnt(6)
  v_mfma_f32_16x16x32_bf16 v[80:83], v[40:43], v[232:235], v[80:83]
  ds_read_b64_tr_b16 v[28:29], v252 offset:2688
  v_mfma_f32_16x16x32_bf16 v[84:87], v[40:43], v[236:239], v[84:87]
  ds_read_b64_tr_b16 v[30:31], v252 offset:15488
  s_waitcnt vmcnt(0)
  v_mfma_f32_16x16x32_bf16 v[48:51], v[44:47], v[240:243], v[48:51]
  v_mfma_f32_16x16x32_bf16 v[52:55], v[44:47], v[244:247], v[52:55]
  s_waitcnt lgkmcnt(4)
  v_mfma_f32_16x16x32_bf16 v[56:59], v[16:19], v[240:243], v[56:59]
  v_mfma_f32_16x16x32_bf16 v[60:63], v[16:19], v[244:247], v[60:63]
  v_mfma_f32_16x16x32_bf16 v[64:67], v[20:23], v[240:243], v[64:67]
  v_mfma_f32_16x16x32_bf16 v[68:71], v[20:23], v[244:247], v[68:71]
  s_waitcnt lgkmcnt(0)
  v_mfma_f32_16x16x32_bf16 v[72:75], v[24:27], v[240:243], v[72:75]
  v_mfma_f32_16x16x32_bf16 v[76:79], v[24:27], v[244:247], v[76:79]
  v_mfma_f32_16x16x32_bf16 v[80:83], v[28:31], v[240:243], v[80:83]
  v_mfma_f32_16x16x32_bf16 v[84:87], v[28:31], v[244:247], v[84:87]
  v_cvt_pk_bf16_f32 v88, v48, v49
  v_cvt_pk_bf16_f32 v89, v50, v51
  v_cvt_pk_bf16_f32 v90, v56, v57
  v_cvt_pk_bf16_f32 v91, v58, v59
  v_cvt_pk_bf16_f32 v92, v64, v65
  v_cvt_pk_bf16_f32 v93, v66, v67
  v_cvt_pk_bf16_f32 v94, v72, v73
  v_cvt_pk_bf16_f32 v95, v74, v75
  v_cvt_pk_bf16_f32 v96, v80, v81
  v_cvt_pk_bf16_f32 v97, v82, v83
  v_cvt_pk_bf16_f32 v100, v52, v53
  v_cvt_pk_bf16_f32 v101, v54, v55
  v_cvt_pk_bf16_f32 v102, v60, v61
  v_cvt_pk_bf16_f32 v103, v62, v63
  v_cvt_pk_bf16_f32 v104, v68, v69
  v_cvt_pk_bf16_f32 v105, v70, v71
  v_cvt_pk_bf16_f32 v106, v76, v77
  v_cvt_pk_bf16_f32 v107, v78, v79
  v_cvt_pk_bf16_f32 v108, v84, v85
  v_cvt_pk_bf16_f32 v109, v86, v87
  v_permlane16_swap_b32 v88, v90
  v_permlane16_swap_b32 v89, v91
  v_permlane16_swap_b32 v92, v94
  v_permlane16_swap_b32 v93, v95
  v_permlane16_swap_b32 v100, v102
  v_permlane16_swap_b32 v101, v103
  v_permlane16_swap_b32 v104, v106
  v_permlane16_swap_b32 v105, v107
  buffer_store_dwordx4 v[88:91], v5, s[60:63], s72 offen offset:0
  buffer_store_dwordx4 v[92:95], v5, s[60:63], s72 offen offset:64
  buffer_store_dwordx2 v[96:97], v6, s[60:63], s72 offen offset:128
  buffer_store_dwordx4 v[100:103], v5, s[60:63], s73 offen offset:0
  buffer_store_dwordx4 v[104:107], v5, s[60:63], s73 offen offset:64
  buffer_store_dwordx2 v[108:109], v6, s[60:63], s73 offen offset:128
  s_mov_b32 s66, 129024
  s_mov_b32 s67, 0
  s_mov_b32 s68, 77824
  s_mov_b32 s69, 103424
  s_mov_b32 s70, 1280
  s_mov_b32 s71, 640
  s_and_b32 s9, s7, 3
  s_cmp_eq_u32 s9, 0
  s_cselect_b32 s66, 25600, s66
  s_cselect_b32 s67, 51200, s67
  s_cmp_eq_u32 s9, 1
  s_cselect_b32 s67, 25600, s67
  s_cselect_b32 s68, 51200, s68
  s_cmp_eq_u32 s9, 2
  s_cselect_b32 s68, 25600, s68
  s_cselect_b32 s69, 51200, s69
  s_cmp_eq_u32 s9, 3
  s_cselect_b32 s69, 25600, s69
  s_cselect_b32 s66, 51200, s66
  s_mov_b32 s78, 1
  s_mov_b32 s72, 42240
  s_add_u32 s15, s15, 2624000
  s_add_u32 s76, s76, 49152
  v_add_u32 v11, 240, v0
  s_branch k_P2h
k_h567:
  s_waitcnt lgkmcnt(0)
  s_cmp_eq_u32 s5, 0
  s_cselect_b32 s56, s20, s28
  s_cselect_b32 s57, s21, s29
  s_mov_b32 s58, 819200
  s_mov_b32 s59, 0x20000
  s_mov_b32 s44, s34
  s_mov_b32 s45, s35
  s_mov_b32 s46, 268435456
  s_mov_b32 s47, 0x20000
  s_mov_b32 s48, s32
  s_mov_b32 s49, s33
  s_mov_b32 s50, 256
  s_mov_b32 s51, 0x20000
  s_mov_b32 s52, s26
  s_mov_b32 s53, s27
  s_mov_b32 s54, 25600
  s_mov_b32 s55, 0x20000
  s_mov_b32 s60, s30
  s_mov_b32 s61, s31
  s_mov_b32 s62, 5242880
  s_mov_b32 s63, 0x20000
  v_mov_b32 v16, 0
  v_mov_b32 v17, 0
  v_mov_b32 v18, 0
  v_mov_b32 v19, 0
  v_mov_b32 v20, 1
  v_lshlrev_b32 v8, 4, v1
  s_cmp_eq_u32 s5, 0
  s_cbranch_scc0 k_noz
  s_cmp_eq_u32 s8, 7
  s_cbranch_scc0 k_noz
  s_cmp_lt_u32 s7, 4
  s_cbranch_scc0 k_noz
  s_cmp_eq_u32 s7, 2
  s_cselect_b32 s9, s6, 0
  s_cmp_ge_u32 s9, 8
  s_cbranch_scc1 k_noz
  s_mov_b32 s14, 0
lz_121:
  ds_read_b32 v248, v0 offset:140
  s_waitcnt lgkmcnt(0)
  v_readfirstlane_b32 s9, v248
  s_nop 0
  s_cmp_eq_u32 s9, 0
  s_cbranch_scc1 lzok_122
  s_sleep 4
  s_add_u32 s14, s14, 1
  s_cmp_lt_u32 s14, 1048576
  s_cbranch_scc1 lz_121
lzok_122:
  s_lshl_b32 s75, s7, 4
  s_add_u32 s75, s75, s6
  s_lshl_b32 s74, s75, 10
  s_add_u32 s74, s74, 9437184
  s_lshl_b32 s75, s75, 2
  s_add_u32 s75, s75, 0
  v_lshlrev_b32 v9, 8, v1
  s_mov_b64 exec, 15
  buffer_store_dwordx4 v[16:19], v9, s[44:47], s74 offen sc1
  s_mov_b64 exec, 1
  s_waitcnt vmcnt(0)
  buffer_store_dword v20, v15, s[48:51], s75 offen sc1
  s_mov_b64 exec, -1
k_noz:
  s_cmp_eq_u32 s5, 0
  s_cbranch_scc0 k_pfskip
  s_mov_b32 s14, 0
lz_123:
  ds_read_b32 v248, v0 offset:176
  s_waitcnt lgkmcnt(0)
  v_readfirstlane_b32 s9, v248
  s_nop 0
  s_cmp_eq_u32 s9, 0
  s_cbranch_scc1 lzok_124
  s_sleep 8
  s_add_u32 s14, s14, 1
  s_cmp_lt_u32 s14, 1048576
  s_cbranch_scc1 lz_123
lzok_124:
  v_lshlrev_b32 v8, 4, v1
  s_sub_u32 s9, s8, 6
  s_mul_i32 s9, s9, 10
  s_mul_i32 s10, s4, 20
  s_add_u32 s9, s9, s10
  s_mul_i32 s9, s9, 1280
  s_lshr_b32 s10, s7, 2
  s_mul_i32 s10, s10, 640
  s_add_u32 s9, s9, s10
  s_mov_b32 s66, -1
  s_mov_b32 s67, 0xff
  s_mov_b64 exec, s[66:67]
  buffer_load_dwordx4 v[24:27], v8, s[56:59], s9 offen
  s_add_u32 s9, s9, 1280
  buffer_load_dwordx4 v[24:27], v8, s[56:59], s9 offen
  s_add_u32 s9, s9, 1280
  buffer_load_dwordx4 v[24:27], v8, s[56:59], s9 offen
  s_add_u32 s9, s9, 1280
  buffer_load_dwordx4 v[24:27], v8, s[56:59], s9 offen
  s_add_u32 s9, s9, 1280
  buffer_load_dwordx4 v[24:27], v8, s[56:59], s9 offen
  s_add_u32 s9, s9, 1280
  buffer_load_dwordx4 v[24:27], v8, s[56:59], s9 offen
  s_add_u32 s9, s9, 1280
  buffer_load_dwordx4 v[24:27], v8, s[56:59], s9 offen
  s_add_u32 s9, s9, 1280
  buffer_load_dwordx4 v[24:27], v8, s[56:59], s9 offen
  s_add_u32 s9, s9, 1280
  buffer_load_dwordx4 v[24:27], v8, s[56:59], s9 offen
  s_add_u32 s9, s9, 1280
  buffer_load_dwordx4 v[24:27], v8, s[56:59], s9 offen
  s_add_u32 s9, s9, 1280
  s_mov_b64 exec, -1
  s_mov_b32 s14, 0
lz_125:
  ds_read_b32 v248, v0 offset:200
  s_waitcnt lgkmcnt(0)
  v_readfirstlane_b32 s9, v248
  s_nop 0
  s_cmp_eq_u32 s9, 0
  s_cbranch_scc1 lzok_126
  s_sleep 8
  s_add_u32 s14, s14, 1
  s_cmp_lt_u32 s14, 1048576
  s_cbranch_scc1 lz_125
lzok_126:
  s_mov_b32 s56, s28
  s_mov_b32 s57, s29
  v_lshlrev_b32 v8, 4, v1
  s_sub_u32 s9, s8, 6
  s_mul_i32 s9, s9, 10
  s_mul_i32 s10, s4, 20
  s_add_u32 s9, s9, s10
  s_mul_i32 s9, s9, 1280
  s_lshr_b32 s10, s7, 2
  s_mul_i32 s10, s10, 640
  s_add_u32 s9, s9, s10
  s_mov_b32 s66, -1
  s_mov_b32 s67, 0xff
  s_mov_b64 exec, s[66:67]
  buffer_load_dwordx4 v[24:27], v8, s[56:59], s9 offen
  s_add_u32 s9, s9, 1280
  buffer_load_dwordx4 v[24:27], v8, s[56:59], s9 offen
  s_add_u32 s9, s9, 1280
  buffer_load_dwordx4 v[24:27], v8, s[56:59], s9 offen
  s_add_u32 s9, s9, 1280
  buffer_load_dwordx4 v[24:27], v8, s[56:59], s9 offen
  s_add_u32 s9, s9, 1280
  buffer_load_dwordx4 v[24:27], v8, s[56:59], s9 offen
  s_add_u32 s9, s9, 1280
  buffer_load_dwordx4 v[24:27], v8, s[56:59], s9 offen
  s_add_u32 s9, s9, 1280
  buffer_load_dwordx4 v[24:27], v8, s[56:59], s9 offen
  s_add_u32 s9, s9, 1280
  buffer_load_dwordx4 v[24:27], v8, s[56:59], s9 offen
  s_add_u32 s9, s9, 1280
  buffer_load_dwordx4 v[24:27], v8, s[56:59], s9 offen
  s_add_u32 s9, s9, 1280
  buffer_load_dwordx4 v[24:27], v8, s[56:59], s9 offen
  s_add_u32 s9, s9, 1280
  s_mov_b64 exec, -1
k_pfskip:
  s_cmp_eq_u32 s5, 0
  s_cbranch_scc1 k_end
  s_cmp_eq_u32 s5, 0
  s_cselect_b32 s56, s20, s28
  s_cselect_b32 s57, s21, s29
  s_mov_b32 s58, 819200
  s_mov_b32 s59, 0x20000
  s_mov_b32 s44, s34
  s_mov_b32 s45, s35
  s_mov_b32 s46, 268435456
  s_mov_b32 s47, 0x20000
  s_mov_b32 s48, s32
  s_mov_b32 s49, s33
  s_mov_b32 s50, 256
  s_mov_b32 s51, 0x20000
  s_mov_b32 s52, s26
  s_mov_b32 s53, s27
  s_mov_b32 s54, 25600
  s_mov_b32 s55, 0x20000
  s_mov_b32 s60, s30
  s_mov_b32 s61, s31
  s_mov_b32 s62, 5242880
  s_mov_b32 s63, 0x20000
  s_sub_u32 s16, s8, 4
  v_mul_u32_u24 v8, 26, v1
  v_lshrrev_b32 v8, 8, v8
  v_mul_u32_u24 v9, 10, v8
  v_sub_u32 v9, v1, v9
  v_lshlrev_b32 v9, 4, v9
  v_mov_b32 v7, 0x7fffff00
  s_mov_b32 s66, -1
  s_mov_b32 s67, 0x0fffffff
  s_mov_b32 s68, -1
  s_mov_b32 s69, 0xff
  s_mul_i32 s70, s7, 160
  s_lshl_b32 s9, s16, 2
  v_add_u32 v14, s9, v0
  v_mul_u32_u24 v28, 1280, v8
  v_add_u32 v28, v28, v9
  v_add_u32 v29, 6720, v28
  v_add_u32 v30, 13440, v28
  v_add_u32 v31, 20160, v28
  s_mov_b32 s14, 0
lw_127:
  ds_read_b64 v[248:249], v0 offset:32
  s_waitcnt lgkmcnt(0)
  v_min_u32 v248, v248, v249
  s_nop 0
  v_readfirstlane_b32 s9, v248
  s_nop 0
  s_cmp_ge_u32 s9, 1
  s_cbranch_scc1 lwok_128
  s_sleep 1
  s_add_u32 s14, s14, 1
  s_cmp_lt_u32 s14, 1048576
  s_cbranch_scc1 lw_127
lwok_128:
  v_bfe_u32 v8, v1, 2, 2
  v_and_b32 v9, 3, v1
  v_mul_u32_u24 v10, 800, v2
  v_mad_u32_u24 v10, v8, 40, v10
  v_add_u32 v10, 159744, v10
  v_mov_b32 v11, 162944
  v_cmp_eq_u32 vcc, v9, v2
  v_add_u32 v12, 640, v10
  s_nop 0
  v_cndmask_b32 v10, v11, v10, vcc
  v_cndmask_b32 v11, v11, v12, vcc
  ds_read_b64_tr_b16 v[84:85], v11 offset:0
  ds_read_b64_tr_b16 v[94:95], v11 offset:8
  ds_read_b64_tr_b16 v[104:105], v11 offset:16
  ds_read_b64_tr_b16 v[114:115], v11 offset:24
  ds_read_b64_tr_b16 v[124:125], v11 offset:32
  ds_read_b64_tr_b16 v[76:77], v10 offset:0
  ds_read_b64_tr_b16 v[78:79], v10 offset:160
  ds_read_b64_tr_b16 v[80:81], v10 offset:320
  ds_read_b64_tr_b16 v[82:83], v10 offset:480
  ds_read_b64_tr_b16 v[86:87], v10 offset:8
  ds_read_b64_tr_b16 v[88:89], v10 offset:168
  ds_read_b64_tr_b16 v[90:91], v10 offset:328
  ds_read_b64_tr_b16 v[92:93], v10 offset:488
  ds_read_b64_tr_b16 v[96:97], v10 offset:16
  ds_read_b64_tr_b16 v[98:99], v10 offset:176
  ds_read_b64_tr_b16 v[100:101], v10 offset:336
  ds_read_b64_tr_b16 v[102:103], v10 offset:496
  ds_read_b64_tr_b16 v[106:107], v10 offset:24
  ds_read_b64_tr_b16 v[108:109], v10 offset:184
  ds_read_b64_tr_b16 v[110:111], v10 offset:344
  ds_read_b64_tr_b16 v[112:113], v10 offset:504
  ds_read_b64_tr_b16 v[116:117], v10 offset:32
  ds_read_b64_tr_b16 v[118:119], v10 offset:192
  ds_read_b64_tr_b16 v[120:121], v10 offset:352
  ds_read_b64_tr_b16 v[122:123], v10 offset:512
  s_lshl_b32 s9, s16, 5
  s_add_u32 s9, s9, 16
  v_add_u32 v12, s9, v3
  v_mul_u32_u24 v12, 544, v12
  v_add_u32 v12, 90112, v12
  v_mul_u32_u24 v13, 80, v2
  v_add_u32 v126, v13, v12
  v_mad_u32_u24 v127, v2, 48, v12
  s_mul_i32 s9, s16, 3072
  s_add_u32 s9, s9, 76800
  v_lshlrev_b32 v13, 4, v1
  v_add_u32 v13, s9, v13
  v_bfe_u32 v8, v1, 2, 2
  v_and_b32 v9, 3, v1
  v_lshrrev_b32 v10, 1, v2
  v_lshlrev_b32 v10, 4, v10
  v_and_b32 v11, 1, v2
  v_lshl_add_u32 v10, v11, 2, v10
  v_add_u32 v10, v10, v8
  s_add_u32 s22, s6, 48
  s_add_u32 s23, s6, 16
  s_lshl_b32 s23, s23, 2
  s_lshl_b32 s21, s22, 2
  s_add_u32 s21, s21, s16
  s_lshl_b32 s21, s21, 8
  s_add_u32 s21, s21, 9437184
  s_lshl_b32 s22, s22, 2
  s_add_u32 s22, s22, 0
  s_lshl_b32 s18, s7, 2
  s_add_u32 s18, s18, s16
  s_lshl_b32 s17, s18, 15
  s_add_u32 s17, s17, 8388608
  s_lshl_b32 s18, s18, 8
  s_add_u32 s18, s18, 9469952
  s_lshl_b32 s19, s7, 2
  s_add_u32 s19, s19, 128
  s_mul_i32 s20, s16, 80
  s_add_u32 s20, s20, 90112
  v_mul_u32_u24 v4, 544, v10
  v_lshl_add_u32 v4, v9, 3, v4
  v_add_u32 v5, 90432, v4
  v_add_u32 v4, s20, v4
  s_mul_i32 s9, s16, 48
  v_add_u32 v5, s9, v5
  v_mul_u32_u24 v6, 544, v3
  v_lshl_add_u32 v6, v2, 3, v6
  v_add_u32 v6, s20, v6
  v_mov_b32 v10, v1
  v_min_u32 v10, 104, v10
  v_mul_u32_u24 v8, 205, v10
  v_lshrrev_b32 v8, 10, v8
  v_min_u32 v8, 22, v8
  v_mul_u32_u24 v9, 5, v8
  v_sub_u32 v9, v10, v9
  v_min_u32 v9, 4, v9
  v_mul_u32_u24 v236, 544, v8
  v_lshl_add_u32 v236, v9, 4, v236
  v_add_u32 v236, s20, v236
  v_add_u32 v10, 64, v1
  v_min_u32 v10, 104, v10
  v_mul_u32_u24 v8, 205, v10
  v_lshrrev_b32 v8, 10, v8
  v_min_u32 v8, 22, v8
  v_mul_u32_u24 v9, 5, v8
  v_sub_u32 v9, v10, v9
  v_min_u32 v9, 4, v9
  v_mul_u32_u24 v237, 544, v8
  v_lshl_add_u32 v237, v9, 4, v237
  v_add_u32 v237, s20, v237
  v_lshrrev_b32 v8, 2, v3
  v_and_b32 v9, 3, v3
  v_mul_u32_u24 v10, 80, v2
  v_add_u32 v10, 90112, v10
  v_mul_u32_u24 v11, 544, v9
  v_add_u32 v11, v11, v10
  v_add_u32 v10, 10880, v10
  v_mov_b32 v12, 162944
  v_cmp_eq_u32 vcc, v8, v2
  s_nop 1
  v_cndmask_b32 v69, v12, v10, vcc
  v_cndmask_b32 v64, v12, v11, vcc
  v_add_u32 v11, 2176, v11
  v_cndmask_b32 v65, v12, v11, vcc
  v_add_u32 v11, 2176, v11
  v_cndmask_b32 v66, v12, v11, vcc
  v_add_u32 v11, 2176, v11
  v_cndmask_b32 v67, v12, v11, vcc
  v_add_u32 v11, 2176, v11
  v_cndmask_b32 v68, v12, v11, vcc
  s_mov_b32 s14, 0
lz_129:
  ds_read_b32 v248, v0 offset:176
  s_waitcnt lgkmcnt(0)
  v_readfirstlane_b32 s9, v248
  s_nop 0
  s_cmp_eq_u32 s9, 0
  s_cbranch_scc1 lzok_130
  s_sleep 8
  s_add_u32 s14, s14, 1
  s_cmp_lt_u32 s14, 1048576
  s_cbranch_scc1 lz_129
lzok_130:
  v_lshlrev_b32 v8, 4, v1
  s_sub_u32 s9, s8, 6
  s_mul_i32 s9, s9, 10
  s_mul_i32 s10, s4, 20
  s_add_u32 s9, s9, s10
  s_mul_i32 s9, s9, 1280
  s_lshr_b32 s10, s7, 2
  s_mul_i32 s10, s10, 640
  s_add_u32 s9, s9, s10
  s_mov_b32 s66, -1
  s_mov_b32 s67, 0xff
  s_mov_b64 exec, s[66:67]
  buffer_load_dwordx4 v[24:27], v8, s[56:59], s9 offen
  s_add_u32 s9, s9, 1280
  buffer_load_dwordx4 v[24:27], v8, s[56:59], s9 offen
  s_add_u32 s9, s9, 1280
  buffer_load_dwordx4 v[24:27], v8, s[56:59], s9 offen
  s_add_u32 s9, s9, 1280
  buffer_load_dwordx4 v[24:27], v8, s[56:59], s9 offen
  s_add_u32 s9, s9, 1280
  buffer_load_dwordx4 v[24:27], v8, s[56:59], s9 offen
  s_add_u32 s9, s9, 1280
  buffer_load_dwordx4 v[24:27], v8, s[56:59], s9 offen
  s_add_u32 s9, s9, 1280
  buffer_load_dwordx4 v[24:27], v8, s[56:59], s9 offen
  s_add_u32 s9, s9, 1280
  buffer_load_dwordx4 v[24:27], v8, s[56:59], s9 offen
  s_add_u32 s9, s9, 1280
  buffer_load_dwordx4 v[24:27], v8, s[56:59], s9 offen
  s_add_u32 s9, s9, 1280
  buffer_load_dwordx4 v[24:27], v8, s[56:59], s9 offen
  s_add_u32 s9, s9, 1280
  s_mov_b64 exec, -1
  s_mov_b32 s66, -1
  s_mov_b32 s67, 0x0fffffff
  s_cmp_eq_u32 s8, 6
  s_cbranch_scc1 k_hB2
  s_mov_b32 s14, 0
lz_131:
  ds_read_b32 v248, v0 offset:184
  s_waitcnt lgkmcnt(0)
  v_readfirstlane_b32 s9, v248
  s_nop 0
  s_cmp_eq_u32 s9, 0
  s_cbranch_scc1 lzok_132
  s_sleep 8
  s_add_u32 s14, s14, 1
  s_cmp_lt_u32 s14, 1048576
  s_cbranch_scc1 lz_131
lzok_132:
  s_load_dword s9, s[32:33], s19
  s_load_dword s10, s[32:33], s22
  s_load_dword s11, s[32:33], s23
  s_waitcnt lgkmcnt(0)
  s_and_b32 s9, s9, s10
  s_and_b32 s9, s9, s11
  s_cmp_ge_u32 s9, 1
  s_cbranch_scc1 k_hB2
  s_mov_b32 s14, 0
gw_133:
  buffer_load_dword v12, v15, s[48:51], s19 offen sc1
  s_waitcnt vmcnt(0)
  v_readfirstlane_b32 s9, v12
  s_nop 0
  s_cmp_ge_u32 s9, 1
  s_cbranch_scc1 gwok_134
  s_sleep 1
  s_add_u32 s14, s14, 1
  s_cmp_lt_u32 s14, 65536
  s_cbranch_scc1 gw_133
gwok_134:
  s_mov_b32 s14, 0
gw_135:
  buffer_load_dword v12, v15, s[48:51], s23 offen sc1
  s_waitcnt vmcnt(0)
  v_readfirstlane_b32 s9, v12
  s_nop 0
  s_cmp_ge_u32 s9, 1
  s_cbranch_scc1 gwok_136
  s_sleep 1
  s_add_u32 s14, s14, 1
  s_cmp_lt_u32 s14, 65536
  s_cbranch_scc1 gw_135
gwok_136:
  s_mov_b32 s14, 0
gw_137:
  buffer_load_dword v12, v15, s[48:51], s22 offen sc1
  s_waitcnt vmcnt(0)
  v_readfirstlane_b32 s9, v12
  s_nop 0
  s_cmp_ge_u32 s9, 1
  s_cbranch_scc1 gwok_138
  s_sleep 1
  s_add_u32 s14, s14, 1
  s_cmp_lt_u32 s14, 65536
  s_cbranch_scc1 gw_137
gwok_138:
k_hB2:
  s_mov_b32 s64, 0x3fb8aa3b
  s_mov_b32 s65, 0x3fb8aa3b
  s_mov_b32 s14, 0
lw_139:
  ds_read_b32 v248, v14 offset:80
  s_waitcnt lgkmcnt(0)
  v_readfirstlane_b32 s9, v248
  s_nop 0
  s_cmp_ge_u32 s9, 1
  s_cbranch_scc1 lwok_140
  s_sleep 1
  s_add_u32 s14, s14, 1
  s_cmp_lt_u32 s14, 1048576
  s_cbranch_scc1 lw_139
lwok_140:
  s_setprio 1
  ds_read_b128 v[36:39], v13 offset:0
  ds_read_b128 v[40:43], v13 offset:1024
  ds_read_b128 v[44:47], v13 offset:2048
  s_waitcnt lgkmcnt(0)
  v_mfma_f32_16x16x16_bf16 v[128:131], v[84:85], v[44:45], 0
  v_mfma_f32_16x16x16_bf16 v[132:135], v[94:95], v[44:45], 0
  v_mfma_f32_16x16x16_bf16 v[136:139], v[104:105], v[44:45], 0
  v_mfma_f32_16x16x16_bf16 v[140:143], v[114:115], v[44:45], 0
  v_mfma_f32_16x16x16_bf16 v[144:147], v[124:125], v[44:45], 0
  s_nop 1
  v_mfma_f32_16x16x32_bf16 v[128:131], v[76:79], v[36:39], v[128:131]
  v_mfma_f32_16x16x32_bf16 v[132:135], v[86:89], v[36:39], v[132:135]
  v_mfma_f32_16x16x32_bf16 v[136:139], v[96:99], v[36:39], v[136:139]
  v_mfma_f32_16x16x32_bf16 v[140:143], v[106:109], v[36:39], v[140:143]
  v_mfma_f32_16x16x32_bf16 v[144:147], v[116:119], v[36:39], v[144:147]
  v_mfma_f32_16x16x32_bf16 v[128:131], v[80:83], v[40:43], v[128:131]
  v_mfma_f32_16x16x32_bf16 v[132:135], v[90:93], v[40:43], v[132:135]
  v_mfma_f32_16x16x32_bf16 v[136:139], v[100:103], v[40:43], v[136:139]
  v_mfma_f32_16x16x32_bf16 v[140:143], v[110:113], v[40:43], v[140:143]
  v_mfma_f32_16x16x32_bf16 v[144:147], v[120:123], v[40:43], v[144:147]
  s_nop 3
  v_max3_f32 v248, v128, v129, v130
  v_min3_f32 v250, v128, v129, v130
  v_max3_f32 v249, v131, v132, v133
  v_min3_f32 v251, v131, v132, v133
  v_max3_f32 v248, v248, v134, v135
  v_min3_f32 v250, v250, v134, v135
  v_max3_f32 v249, v249, v136, v137
  v_min3_f32 v251, v251, v136, v137
  v_max3_f32 v248, v248, v138, v139
  v_min3_f32 v250, v250, v138, v139
  v_max3_f32 v249, v249, v140, v141
  v_min3_f32 v251, v251, v140, v141
  v_max3_f32 v248, v248, v142, v143
  v_min3_f32 v250, v250, v142, v143
  v_max3_f32 v249, v249, v144, v145
  v_min3_f32 v251, v251, v144, v145
  v_max3_f32 v248, v248, v146, v147
  v_min3_f32 v250, v250, v146, v147
  v_max_f32 v248, v248, v249
  v_min_f32 v250, v250, v251
  v_mul_f32 v248, s64, v248
  v_mul_f32 v250, s64, v250
  v_pk_fma_f32 v[148:149], v[128:129], s[64:65], v[250:251] op_sel_hi:[1,1,0] neg_lo:[1,0,0] neg_hi:[1,0,0]
  v_pk_fma_f32 v[128:129], v[128:129], s[64:65], v[248:249] op_sel_hi:[1,1,0] neg_lo:[0,0,1] neg_hi:[0,0,1]
  v_pk_fma_f32 v[150:151], v[130:131], s[64:65], v[250:251] op_sel_hi:[1,1,0] neg_lo:[1,0,0] neg_hi:[1,0,0]
  v_pk_fma_f32 v[130:131], v[130:131], s[64:65], v[248:249] op_sel_hi:[1,1,0] neg_lo:[0,0,1] neg_hi:[0,0,1]
  v_pk_fma_f32 v[152:153], v[132:133], s[64:65], v[250:251] op_sel_hi:[1,1,0] neg_lo:[1,0,0] neg_hi:[1,0,0]
  v_pk_fma_f32 v[132:133], v[132:133], s[64:65], v[248:249] op_sel_hi:[1,1,0] neg_lo:[0,0,1] neg_hi:[0,0,1]
  v_pk_fma_f32 v[154:155], v[134:135], s[64:65], v[250:251] op_sel_hi:[1,1,0] neg_lo:[1,0,0] neg_hi:[1,0,0]
  v_pk_fma_f32 v[134:135], v[134:135], s[64:65], v[248:249] op_sel_hi:[1,1,0] neg_lo:[0,0,1] neg_hi:[0,0,1]
  v_pk_fma_f32 v[156:157], v[136:137], s[64:65], v[250:251] op_sel_hi:[1,1,0] neg_lo:[1,0,0] neg_hi:[1,0,0]
  v_pk_fma_f32 v[136:137], v[136:137], s[64:65], v[248:249] op_sel_hi:[1,1,0] neg_lo:[0,0,1] neg_hi:[0,0,1]
  v_pk_fma_f32 v[158:159], v[138:139], s[64:65], v[250:251] op_sel_hi:[1,1,0] neg_lo:[1,0,0] neg_hi:[1,0,0]
  v_pk_fma_f32 v[138:139], v[138:139], s[64:65], v[248:249] op_sel_hi:[1,1,0] neg_lo:[0,0,1] neg_hi:[0,0,1]
  v_pk_fma_f32 v[160:161], v[140:141], s[64:65], v[250:251] op_sel_hi:[1,1,0] neg_lo:[1,0,0] neg_hi:[1,0,0]
  v_pk_fma_f32 v[140:141], v[140:141], s[64:65], v[248:249] op_sel_hi:[1,1,0] neg_lo:[0,0,1] neg_hi:[0,0,1]
  v_pk_fma_f32 v[162:163], v[142:143], s[64:65], v[250:251] op_sel_hi:[1,1,0] neg_lo:[1,0,0] neg_hi:[1,0,0]
  v_pk_fma_f32 v[142:143], v[142:143], s[64:65], v[248:249] op_sel_hi:[1,1,0] neg_lo:[0,0,1] neg_hi:[0,0,1]
  v_pk_fma_f32 v[164:165], v[144:145], s[64:65], v[250:251] op_sel_hi:[1,1,0] neg_lo:[1,0,0] neg_hi:[1,0,0]
  v_pk_fma_f32 v[144:145], v[144:145], s[64:65], v[248:249] op_sel_hi:[1,1,0] neg_lo:[0,0,1] neg_hi:[0,0,1]
  v_pk_fma_f32 v[166:167], v[146:147], s[64:65], v[250:251] op_sel_hi:[1,1,0] neg_lo:[1,0,0] neg_hi:[1,0,0]
  v_pk_fma_f32 v[146:147], v[146:147], s[64:65], v[248:249] op_sel_hi:[1,1,0] neg_lo:[0,0,1] neg_hi:[0,0,1]
  v_exp_f32 v128, v128
  v_exp_f32 v129, v129
  v_exp_f32 v130, v130
  v_exp_f32 v131, v131
  v_exp_f32 v132, v132
  v_exp_f32 v133, v133
  v_exp_f32 v134, v134
  v_exp_f32 v135, v135
  v_exp_f32 v136, v136
  v_exp_f32 v137, v137
  v_exp_f32 v138, v138
  v_exp_f32 v139, v139
  v_exp_f32 v140, v140
  v_exp_f32 v141, v141
  v_exp_f32 v142, v142
  v_exp_f32 v143, v143
  v_exp_f32 v144, v144
  v_exp_f32 v145, v145
  v_exp_f32 v146, v146
  v_exp_f32 v147, v147
  v_exp_f32 v148, v148
  v_pk_add_f32 v[248:249], v[128:129], v[130:131]
  v_exp_f32 v149, v149
  v_pk_add_f32 v[248:249], v[248:249], v[132:133]
  v_exp_f32 v150, v150
  v_pk_add_f32 v[248:249], v[248:249], v[134:135]
  v_exp_f32 v151, v151
  v_pk_add_f32 v[248:249], v[248:249], v[136:137]
  v_exp_f32 v152, v152
  v_pk_add_f32 v[248:249], v[248:249], v[138:139]
  v_exp_f32 v153, v153
  v_pk_add_f32 v[248:249], v[248:249], v[140:141]
  v_exp_f32 v154, v154
  v_pk_add_f32 v[248:249], v[248:249], v[142:143]
  v_exp_f32 v155, v155
  v_pk_add_f32 v[248:249], v[248:249], v[144:145]
  v_exp_f32 v156, v156
  v_pk_add_f32 v[248:249], v[248:249], v[146:147]
  v_exp_f32 v157, v157
  v_add_f32 v248, v248, v249
  v_exp_f32 v158, v158
  v_rcp_f32 v248, v248
  v_exp_f32 v159, v159
  v_exp_f32 v160, v160
  v_exp_f32 v161, v161
  v_exp_f32 v162, v162
  v_exp_f32 v163, v163
  v_exp_f32 v164, v164
  v_exp_f32 v165, v165
  v_exp_f32 v166, v166
  v_exp_f32 v167, v167
  v_pk_add_f32 v[250:251], v[148:149], v[150:151]
  v_pk_mul_f32 v[128:129], v[128:129], v[248:249] op_sel_hi:[1,0]
  v_pk_add_f32 v[250:251], v[250:251], v[152:153]
  v_pk_mul_f32 v[130:131], v[130:131], v[248:249] op_sel_hi:[1,0]
  v_pk_add_f32 v[250:251], v[250:251], v[154:155]
  v_pk_mul_f32 v[132:133], v[132:133], v[248:249] op_sel_hi:[1,0]
  v_pk_add_f32 v[250:251], v[250:251], v[156:157]
  v_pk_mul_f32 v[134:135], v[134:135], v[248:249] op_sel_hi:[1,0]
  v_pk_add_f32 v[250:251], v[250:251], v[158:159]
  v_pk_mul_f32 v[136:137], v[136:137], v[248:249] op_sel_hi:[1,0]
  v_pk_add_f32 v[250:251], v[250:251], v[160:161]
  v_pk_mul_f32 v[138:139], v[138:139], v[248:249] op_sel_hi:[1,0]
  v_pk_add_f32 v[250:251], v[250:251], v[162:163]
  v_pk_mul_f32 v[140:141], v[140:141], v[248:249] op_sel_hi:[1,0]
  v_pk_add_f32 v[250:251], v[250:251], v[164:165]
  v_pk_mul_f32 v[142:143], v[142:143], v[248:249] op_sel_hi:[1,0]
  v_pk_add_f32 v[250:251], v[250:251], v[166:167]
  v_pk_mul_f32 v[144:145], v[144:145], v[248:249] op_sel_hi:[1,0]
  v_add_f32 v250, v250, v251
  v_pk_mul_f32 v[146:147], v[146:147], v[248:249] op_sel_hi:[1,0]
  v_rcp_f32 v250, v250
  v_cvt_pk_bf16_f32 v36, v128, v129
  v_cvt_pk_bf16_f32 v37, v130, v131
  v_cvt_pk_bf16_f32 v38, v132, v133
  v_cvt_pk_bf16_f32 v39, v134, v135
  ds_write_b128 v126, v[36:39] offset:0
  v_cvt_pk_bf16_f32 v40, v136, v137
  v_cvt_pk_bf16_f32 v41, v138, v139
  v_cvt_pk_bf16_f32 v42, v140, v141
  v_cvt_pk_bf16_f32 v43, v142, v143
  ds_write_b128 v126, v[40:43] offset:16
  v_cvt_pk_bf16_f32 v44, v144, v145
  v_cvt_pk_bf16_f32 v45, v146, v147
  v_pk_mul_f32 v[148:149], v[148:149], v[250:251] op_sel_hi:[1,0]
  v_pk_mul_f32 v[150:151], v[150:151], v[250:251] op_sel_hi:[1,0]
  v_pk_mul_f32 v[152:153], v[152:153], v[250:251] op_sel_hi:[1,0]
  v_pk_mul_f32 v[154:155], v[154:155], v[250:251] op_sel_hi:[1,0]
  v_pk_mul_f32 v[156:157], v[156:157], v[250:251] op_sel_hi:[1,0]
  v_pk_mul_f32 v[158:159], v[158:159], v[250:251] op_sel_hi:[1,0]
  v_pk_mul_f32 v[160:161], v[160:161], v[250:251] op_sel_hi:[1,0]
  v_pk_mul_f32 v[162:163], v[162:163], v[250:251] op_sel_hi:[1,0]
  v_pk_mul_f32 v[164:165], v[164:165], v[250:251] op_sel_hi:[1,0]
  v_pk_mul_f32 v[166:167], v[166:167], v[250:251] op_sel_hi:[1,0]
  v_cvt_pk_bf16_f32 v46, v148, v149
  v_cvt_pk_bf16_f32 v47, v150, v151
  ds_write_b128 v126, v[44:47] offset:32
  v_cvt_pk_bf16_f32 v48, v152, v153
  v_cvt_pk_bf16_f32 v49, v154, v155
  v_cvt_pk_bf16_f32 v50, v156, v157
  v_cvt_pk_bf16_f32 v51, v158, v159
  ds_write_b128 v126, v[48:51] offset:48
  v_cvt_pk_bf16_f32 v52, v160, v161
  v_cvt_pk_bf16_f32 v53, v162, v163
  v_cvt_pk_bf16_f32 v54, v164, v165
  v_cvt_pk_bf16_f32 v55, v166, v167
  ds_write_b128 v126, v[52:55] offset:64
  v_mov_b32 v12, 1
  ds_write_b32 v14, v12 offset:64
  s_setprio 0
  s_mov_b32 s14, 0
lw_141:
  ds_read_b128 v[248:251], v0 offset:48
  ds_read_b128 v[252:255], v0 offset:64
  s_waitcnt lgkmcnt(0)
  v_min3_u32 v248, v248, v249, v250
  v_min3_u32 v251, v251, v252, v253
  v_min3_u32 v248, v248, v254, v255
  v_min_u32 v248, v248, v251
  s_nop 0
  v_readfirstlane_b32 s9, v248
  s_nop 0
  s_cmp_ge_u32 s9, 1
  s_cbranch_scc1 lwok_142
  s_sleep 1
  s_add_u32 s14, s14, 1
  s_cmp_lt_u32 s14, 1048576
  s_cbranch_scc1 lw_141
lwok_142:
  ds_read_b64_tr_b16 v[152:153], v4 offset:0
  ds_read_b64_tr_b16 v[154:155], v4 offset:4352
  ds_read_b64_tr_b16 v[156:157], v4 offset:32
  ds_read_b64_tr_b16 v[158:159], v4 offset:4384
  ds_read_b64_tr_b16 v[160:161], v4 offset:64
  ds_read_b64_tr_b16 v[162:163], v4 offset:4416
  ds_read_b64_tr_b16 v[164:165], v5 offset:0
  ds_read_b64_tr_b16 v[166:167], v5 offset:4352
  ds_read_b64_tr_b16 v[168:169], v5 offset:32
  ds_read_b64_tr_b16 v[170:171], v5 offset:4384
  ds_read_b64_tr_b16 v[172:173], v4 offset:17408
  ds_read_b64_tr_b16 v[174:175], v4 offset:21760
  ds_read_b64_tr_b16 v[176:177], v4 offset:17440
  ds_read_b64_tr_b16 v[178:179], v4 offset:21792
  ds_read_b64_tr_b16 v[180:181], v4 offset:17472
  ds_read_b64_tr_b16 v[182:183], v4 offset:21824
  ds_read_b64_tr_b16 v[184:185], v5 offset:17408
  ds_read_b64_tr_b16 v[186:187], v5 offset:21760
  ds_read_b64_tr_b16 v[188:189], v5 offset:17440
  ds_read_b64_tr_b16 v[190:191], v5 offset:21792
  s_waitcnt lgkmcnt(10)
  v_mfma_f32_16x16x32_bf16 v[128:131], v[152:155], v[164:167], 0
  v_mfma_f32_16x16x32_bf16 v[132:135], v[152:155], v[168:171], 0
  v_mfma_f32_16x16x32_bf16 v[136:139], v[156:159], v[164:167], 0
  v_mfma_f32_16x16x32_bf16 v[140:143], v[156:159], v[168:171], 0
  v_mfma_f32_16x16x32_bf16 v[144:147], v[160:163], v[164:167], 0
  v_mfma_f32_16x16x32_bf16 v[148:151], v[160:163], v[168:171], 0
  ds_read_b64_tr_b16 v[192:193], v4 offset:34816
  ds_read_b64_tr_b16 v[194:195], v4 offset:39168
  ds_read_b64_tr_b16 v[196:197], v4 offset:34848
  ds_read_b64_tr_b16 v[198:199], v4 offset:39200
  ds_read_b64_tr_b16 v[200:201], v4 offset:34880
  ds_read_b64_tr_b16 v[202:203], v4 offset:39232
  ds_read_b64_tr_b16 v[204:205], v5 offset:34816
  ds_read_b64_tr_b16 v[206:207], v5 offset:39168
  ds_read_b64_tr_b16 v[208:209], v5 offset:34848
  ds_read_b64_tr_b16 v[210:211], v5 offset:39200
  s_waitcnt lgkmcnt(10)
  v_mfma_f32_16x16x32_bf16 v[128:131], v[172:175], v[184:187], v[128:131]
  v_mfma_f32_16x16x32_bf16 v[132:135], v[172:175], v[188:191], v[132:135]
  v_mfma_f32_16x16x32_bf16 v[136:139], v[176:179], v[184:187], v[136:139]
  v_mfma_f32_16x16x32_bf16 v[140:143], v[176:179], v[188:191], v[140:143]
  v_mfma_f32_16x16x32_bf16 v[144:147], v[180:183], v[184:187], v[144:147]
  v_mfma_f32_16x16x32_bf16 v[148:151], v[180:183], v[188:191], v[148:151]
  ds_read_b64_tr_b16 v[212:213], v4 offset:52224
  ds_read_b64_tr_b16 v[214:215], v4 offset:56576
  ds_read_b64_tr_b16 v[216:217], v4 offset:52256
  ds_read_b64_tr_b16 v[218:219], v4 offset:56608
  ds_read_b64_tr_b16 v[220:221], v4 offset:52288
  ds_read_b64_tr_b16 v[222:223], v4 offset:56640
  ds_read_b64_tr_b16 v[224:225], v5 offset:52224
  ds_read_b64_tr_b16 v[226:227], v5 offset:56576
  ds_read_b64_tr_b16 v[228:229], v5 offset:52256
  ds_read_b64_tr_b16 v[230:231], v5 offset:56608
  s_waitcnt lgkmcnt(10)
  v_mfma_f32_16x16x32_bf16 v[128:131], v[192:195], v[204:207], v[128:131]
  v_mfma_f32_16x16x32_bf16 v[132:135], v[192:195], v[208:211], v[132:135]
  v_mfma_f32_16x16x32_bf16 v[136:139], v[196:199], v[204:207], v[136:139]
  v_mfma_f32_16x16x32_bf16 v[140:143], v[196:199], v[208:211], v[140:143]
  v_mfma_f32_16x16x32_bf16 v[144:147], v[200:203], v[204:207], v[144:147]
  v_mfma_f32_16x16x32_bf16 v[148:151], v[200:203], v[208:211], v[148:151]
  s_waitcnt lgkmcnt(0)
  v_mov_b32 v12, 1
  ds_write_b32 v14, v12 offset:112
  v_mfma_f32_16x16x32_bf16 v[128:131], v[212:215], v[224:227], v[128:131]
  v_mfma_f32_16x16x32_bf16 v[132:135], v[212:215], v[228:231], v[132:135]
  v_mfma_f32_16x16x32_bf16 v[136:139], v[216:219], v[224:227], v[136:139]
  v_mfma_f32_16x16x32_bf16 v[140:143], v[216:219], v[228:231], v[140:143]
  v_mfma_f32_16x16x32_bf16 v[144:147], v[220:223], v[224:227], v[144:147]
  v_mfma_f32_16x16x32_bf16 v[148:151], v[220:223], v[228:231], v[148:151]
  s_lshl_b32 s9, s6, 11
  s_add_u32 s9, s9, s17
  s_mov_b32 s100, 0x001f001f
  s_mov_b32 s101, 0x001f001f
  v_lshlrev_b32 v8, 4, v1
  v_cvt_pk_bf16_f32 v36, v128, v129
  v_cvt_pk_bf16_f32 v37, v130, v131
  v_cvt_pk_bf16_f32 v38, v132, v133
  v_cvt_pk_bf16_f32 v39, v134, v135
  v_cvt_pk_bf16_f32 v40, v136, v137
  v_cvt_pk_bf16_f32 v41, v138, v139
  v_cvt_pk_bf16_f32 v42, v140, v141
  v_cvt_pk_bf16_f32 v43, v142, v143
  v_cvt_pk_bf16_f32 v44, v144, v145
  v_cvt_pk_bf16_f32 v45, v146, v147
  v_cvt_pk_bf16_f32 v46, v148, v149
  v_cvt_pk_bf16_f32 v47, v150, v151
  ds_write_b64 v6, v[36:37] offset:0
  ds_write_b64 v6, v[40:41] offset:32
  s_mov_b64 exec, s[100:101]
  ds_write_b64 v6, v[38:39] offset:8704
  ds_write_b64 v6, v[42:43] offset:8736
  s_mov_b32 exec_hi, 0
  ds_write_b64 v6, v[46:47] offset:8768
  s_mov_b32 exec_lo, -1
  ds_write_b64 v6, v[44:45] offset:64
  s_mov_b64 exec, -1
  ds_read_b128 v[48:51], v236
  ds_read_b128 v[52:55], v237
  s_waitcnt lgkmcnt(1)
  buffer_store_dwordx4 v[48:51], v8, s[44:47], s9 offen sc1
  s_waitcnt lgkmcnt(0)
  buffer_store_dwordx4 v[52:55], v8, s[44:47], s9 offen offset:1024 sc1
  v_mov_b32 v12, 1
  ds_write_b32 v14, v12 offset:0
  s_mov_b32 s14, 0
lw_143:
  ds_read_b32 v248, v14 offset:80
  s_waitcnt lgkmcnt(0)
  v_readfirstlane_b32 s9, v248
  s_nop 0
  s_cmp_ge_u32 s9, 2
  s_cbranch_scc1 lwok_144
  s_sleep 1
  s_add_u32 s14, s14, 1
  s_cmp_lt_u32 s14, 1048576
  s_cbranch_scc1 lw_143
lwok_144:
  ds_read_b128 v[36:39], v13 offset:0
  ds_read_b128 v[40:43], v13 offset:1024
  ds_read_b128 v[44:47], v13 offset:2048
  s_lshl_b32 s9, 1, s6
  v_mov_b32 v12, s9
  s_waitcnt lgkmcnt(0)
  v_mfma_f32_16x16x16_bf16 v[128:131], v[84:85], v[44:45], 0
  v_mfma_f32_16x16x16_bf16 v[132:135], v[94:95], v[44:45], 0
  v_mfma_f32_16x16x16_bf16 v[136:139], v[104:105], v[44:45], 0
  v_mfma_f32_16x16x16_bf16 v[140:143], v[114:115], v[44:45], 0
  v_mfma_f32_16x16x16_bf16 v[144:147], v[124:125], v[44:45], 0
  s_nop 1
  v_mfma_f32_16x16x32_bf16 v[128:131], v[76:79], v[36:39], v[128:131]
  v_mfma_f32_16x16x32_bf16 v[132:135], v[86:89], v[36:39], v[132:135]
  v_mfma_f32_16x16x32_bf16 v[136:139], v[96:99], v[36:39], v[136:139]
  v_mfma_f32_16x16x32_bf16 v[140:143], v[106:109], v[36:39], v[140:143]
  v_mfma_f32_16x16x32_bf16 v[144:147], v[116:119], v[36:39], v[144:147]
  v_mfma_f32_16x16x32_bf16 v[128:131], v[80:83], v[40:43], v[128:131]
  v_mfma_f32_16x16x32_bf16 v[132:135], v[90:93], v[40:43], v[132:135]
  v_mfma_f32_16x16x32_bf16 v[136:139], v[100:103], v[40:43], v[136:139]
  v_mfma_f32_16x16x32_bf16 v[140:143], v[110:113], v[40:43], v[140:143]
  v_mfma_f32_16x16x32_bf16 v[144:147], v[120:123], v[40:43], v[144:147]
  s_mov_b64 exec, 1
  s_waitcnt vmcnt(0)
  buffer_atomic_or v12, v15, s[44:47], s18 offen sc1
  s_mov_b64 exec, -1
  v_max3_f32 v248, v128, v129, v130
  v_min3_f32 v250, v128, v129, v130
  v_max3_f32 v249, v131, v132, v133
  v_min3_f32 v251, v131, v132, v133
  v_max3_f32 v248, v248, v134, v135
  v_min3_f32 v250, v250, v134, v135
  v_max3_f32 v249, v249, v136, v137
  v_min3_f32 v251, v251, v136, v137
  v_max3_f32 v248, v248, v138, v139
  v_min3_f32 v250, v250, v138, v139
  v_max3_f32 v249, v249, v140, v141
  v_min3_f32 v251, v251, v140, v141
  v_max3_f32 v248, v248, v142, v143
  v_min3_f32 v250, v250, v142, v143
  v_max3_f32 v249, v249, v144, v145
  v_min3_f32 v251, v251, v144, v145
  v_max3_f32 v248, v248, v146, v147
  v_min3_f32 v250, v250, v146, v147
  v_max_f32 v248, v248, v249
  v_min_f32 v250, v250, v251
  v_mul_f32 v248, s64, v248
  v_mul_f32 v250, s64, v250
  v_pk_fma_f32 v[148:149], v[128:129], s[64:65], v[250:251] op_sel_hi:[1,1,0] neg_lo:[1,0,0] neg_hi:[1,0,0]
  v_pk_fma_f32 v[128:129], v[128:129], s[64:65], v[248:249] op_sel_hi:[1,1,0] neg_lo:[0,0,1] neg_hi:[0,0,1]
  v_pk_fma_f32 v[150:151], v[130:131], s[64:65], v[250:251] op_sel_hi:[1,1,0] neg_lo:[1,0,0] neg_hi:[1,0,0]
  v_pk_fma_f32 v[130:131], v[130:131], s[64:65], v[248:249] op_sel_hi:[1,1,0] neg_lo:[0,0,1] neg_hi:[0,0,1]
  v_pk_fma_f32 v[152:153], v[132:133], s[64:65], v[250:251] op_sel_hi:[1,1,0] neg_lo:[1,0,0] neg_hi:[1,0,0]
  v_pk_fma_f32 v[132:133], v[132:133], s[64:65], v[248:249] op_sel_hi:[1,1,0] neg_lo:[0,0,1] neg_hi:[0,0,1]
  v_pk_fma_f32 v[154:155], v[134:135], s[64:65], v[250:251] op_sel_hi:[1,1,0] neg_lo:[1,0,0] neg_hi:[1,0,0]
  v_pk_fma_f32 v[134:135], v[134:135], s[64:65], v[248:249] op_sel_hi:[1,1,0] neg_lo:[0,0,1] neg_hi:[0,0,1]
  v_pk_fma_f32 v[156:157], v[136:137], s[64:65], v[250:251] op_sel_hi:[1,1,0] neg_lo:[1,0,0] neg_hi:[1,0,0]
  v_pk_fma_f32 v[136:137], v[136:137], s[64:65], v[248:249] op_sel_hi:[1,1,0] neg_lo:[0,0,1] neg_hi:[0,0,1]
  v_pk_fma_f32 v[158:159], v[138:139], s[64:65], v[250:251] op_sel_hi:[1,1,0] neg_lo:[1,0,0] neg_hi:[1,0,0]
  v_pk_fma_f32 v[138:139], v[138:139], s[64:65], v[248:249] op_sel_hi:[1,1,0] neg_lo:[0,0,1] neg_hi:[0,0,1]
  v_pk_fma_f32 v[160:161], v[140:141], s[64:65], v[250:251] op_sel_hi:[1,1,0] neg_lo:[1,0,0] neg_hi:[1,0,0]
  v_pk_fma_f32 v[140:141], v[140:141], s[64:65], v[248:249] op_sel_hi:[1,1,0] neg_lo:[0,0,1] neg_hi:[0,0,1]
  v_pk_fma_f32 v[162:163], v[142:143], s[64:65], v[250:251] op_sel_hi:[1,1,0] neg_lo:[1,0,0] neg_hi:[1,0,0]
  v_pk_fma_f32 v[142:143], v[142:143], s[64:65], v[248:249] op_sel_hi:[1,1,0] neg_lo:[0,0,1] neg_hi:[0,0,1]
  v_pk_fma_f32 v[164:165], v[144:145], s[64:65], v[250:251] op_sel_hi:[1,1,0] neg_lo:[1,0,0] neg_hi:[1,0,0]
  v_pk_fma_f32 v[144:145], v[144:145], s[64:65], v[248:249] op_sel_hi:[1,1,0] neg_lo:[0,0,1] neg_hi:[0,0,1]
  v_pk_fma_f32 v[166:167], v[146:147], s[64:65], v[250:251] op_sel_hi:[1,1,0] neg_lo:[1,0,0] neg_hi:[1,0,0]
  v_pk_fma_f32 v[146:147], v[146:147], s[64:65], v[248:249] op_sel_hi:[1,1,0] neg_lo:[0,0,1] neg_hi:[0,0,1]
  v_exp_f32 v128, v128
  v_exp_f32 v129, v129
  v_exp_f32 v130, v130
  v_exp_f32 v131, v131
  v_exp_f32 v132, v132
  v_exp_f32 v133, v133
  v_exp_f32 v134, v134
  v_exp_f32 v135, v135
  v_exp_f32 v136, v136
  v_exp_f32 v137, v137
  v_exp_f32 v138, v138
  v_exp_f32 v139, v139
  v_exp_f32 v140, v140
  v_exp_f32 v141, v141
  v_exp_f32 v142, v142
  v_exp_f32 v143, v143
  v_exp_f32 v144, v144
  v_exp_f32 v145, v145
  v_exp_f32 v146, v146
  v_exp_f32 v147, v147
  v_exp_f32 v148, v148
  v_pk_add_f32 v[248:249], v[128:129], v[130:131]
  v_exp_f32 v149, v149
  v_pk_add_f32 v[248:249], v[248:249], v[132:133]
  v_exp_f32 v150, v150
  v_pk_add_f32 v[248:249], v[248:249], v[134:135]
  v_exp_f32 v151, v151
  v_pk_add_f32 v[248:249], v[248:249], v[136:137]
  v_exp_f32 v152, v152
  v_pk_add_f32 v[248:249], v[248:249], v[138:139]
  v_exp_f32 v153, v153
  v_pk_add_f32 v[248:249], v[248:249], v[140:141]
  v_exp_f32 v154, v154
  v_pk_add_f32 v[248:249], v[248:249], v[142:143]
  v_exp_f32 v155, v155
  v_pk_add_f32 v[248:249], v[248:249], v[144:145]
  v_exp_f32 v156, v156
  v_pk_add_f32 v[248:249], v[248:249], v[146:147]
  v_exp_f32 v157, v157
  v_add_f32 v248, v248, v249
  v_exp_f32 v158, v158
  v_rcp_f32 v248, v248
  v_exp_f32 v159, v159
  v_exp_f32 v160, v160
  v_exp_f32 v161, v161
  v_exp_f32 v162, v162
  v_exp_f32 v163, v163
  v_exp_f32 v164, v164
  v_exp_f32 v165, v165
  v_exp_f32 v166, v166
  v_exp_f32 v167, v167
  v_pk_add_f32 v[250:251], v[148:149], v[150:151]
  v_pk_mul_f32 v[128:129], v[128:129], v[248:249] op_sel_hi:[1,0]
  v_pk_add_f32 v[250:251], v[250:251], v[152:153]
  v_pk_mul_f32 v[130:131], v[130:131], v[248:249] op_sel_hi:[1,0]
  v_pk_add_f32 v[250:251], v[250:251], v[154:155]
  v_pk_mul_f32 v[132:133], v[132:133], v[248:249] op_sel_hi:[1,0]
  v_pk_add_f32 v[250:251], v[250:251], v[156:157]
  v_pk_mul_f32 v[134:135], v[134:135], v[248:249] op_sel_hi:[1,0]
  v_pk_add_f32 v[250:251], v[250:251], v[158:159]
  v_pk_mul_f32 v[136:137], v[136:137], v[248:249] op_sel_hi:[1,0]
  v_pk_add_f32 v[250:251], v[250:251], v[160:161]
  v_pk_mul_f32 v[138:139], v[138:139], v[248:249] op_sel_hi:[1,0]
  v_pk_add_f32 v[250:251], v[250:251], v[162:163]
  v_pk_mul_f32 v[140:141], v[140:141], v[248:249] op_sel_hi:[1,0]
  v_pk_add_f32 v[250:251], v[250:251], v[164:165]
  v_pk_mul_f32 v[142:143], v[142:143], v[248:249] op_sel_hi:[1,0]
  v_pk_add_f32 v[250:251], v[250:251], v[166:167]
  v_pk_mul_f32 v[144:145], v[144:145], v[248:249] op_sel_hi:[1,0]
  v_add_f32 v250, v250, v251
  v_pk_mul_f32 v[146:147], v[146:147], v[248:249] op_sel_hi:[1,0]
  v_rcp_f32 v250, v250
  v_cvt_pk_bf16_f32 v76, v128, v129
  v_cvt_pk_bf16_f32 v77, v130, v131
  v_cvt_pk_bf16_f32 v78, v132, v133
  v_cvt_pk_bf16_f32 v79, v134, v135
  v_cvt_pk_bf16_f32 v80, v136, v137
  v_cvt_pk_bf16_f32 v81, v138, v139
  v_cvt_pk_bf16_f32 v82, v140, v141
  v_cvt_pk_bf16_f32 v83, v142, v143
  v_cvt_pk_bf16_f32 v84, v144, v145
  v_cvt_pk_bf16_f32 v85, v146, v147
  v_pk_mul_f32 v[148:149], v[148:149], v[250:251] op_sel_hi:[1,0]
  v_pk_mul_f32 v[150:151], v[150:151], v[250:251] op_sel_hi:[1,0]
  v_pk_mul_f32 v[152:153], v[152:153], v[250:251] op_sel_hi:[1,0]
  v_pk_mul_f32 v[154:155], v[154:155], v[250:251] op_sel_hi:[1,0]
  v_pk_mul_f32 v[156:157], v[156:157], v[250:251] op_sel_hi:[1,0]
  v_pk_mul_f32 v[158:159], v[158:159], v[250:251] op_sel_hi:[1,0]
  v_pk_mul_f32 v[160:161], v[160:161], v[250:251] op_sel_hi:[1,0]
  v_pk_mul_f32 v[162:163], v[162:163], v[250:251] op_sel_hi:[1,0]
  v_pk_mul_f32 v[164:165], v[164:165], v[250:251] op_sel_hi:[1,0]
  v_pk_mul_f32 v[166:167], v[166:167], v[250:251] op_sel_hi:[1,0]
  v_cvt_pk_bf16_f32 v86, v148, v149
  v_cvt_pk_bf16_f32 v87, v150, v151
  v_cvt_pk_bf16_f32 v88, v152, v153
  v_cvt_pk_bf16_f32 v89, v154, v155
  v_cvt_pk_bf16_f32 v90, v156, v157
  v_cvt_pk_bf16_f32 v91, v158, v159
  v_cvt_pk_bf16_f32 v92, v160, v161
  v_cvt_pk_bf16_f32 v93, v162, v163
  v_cvt_pk_bf16_f32 v94, v164, v165
  v_cvt_pk_bf16_f32 v95, v166, v167
  v_lshlrev_b32 v8, 4, v1
  v_lshlrev_b32 v9, 3, v1
  s_lshl_b32 s9, s6, 2
  s_add_u32 s9, s9, s16
  s_mul_i32 s9, s9, 40960
  s_mul_i32 s10, s5, 2621440
  s_add_u32 s15, s9, s10
  s_mul_i32 s10, s7, 5120
  s_add_u32 s12, s15, s10
  s_add_u32 s13, s12, 2560
  s_mov_b32 s14, 0
lw_145:
  ds_read_b128 v[248:251], v0 offset:96
  s_waitcnt lgkmcnt(0)
  v_min3_u32 v248, v248, v249, v250
  v_min_u32 v248, v248, v251
  s_nop 0
  v_readfirstlane_b32 s9, v248
  s_nop 0
  s_cmp_ge_u32 s9, 1
  s_cbranch_scc1 lwok_146
  s_sleep 1
  s_add_u32 s14, s14, 1
  s_cmp_lt_u32 s14, 1048576
  s_cbranch_scc1 lw_145
lwok_146:
  ds_read_b128 v[16:19], v69 offset:0
  ds_read_b128 v[20:23], v64 offset:0
  ds_read_b128 v[24:27], v65 offset:0
  ds_read_b128 v[28:31], v66 offset:0
  ds_read_b128 v[32:35], v67 offset:0
  ds_read_b128 v[36:39], v68 offset:0
  ds_read_b128 v[40:43], v69 offset:16
  ds_read_b128 v[44:47], v64 offset:16
  ds_read_b128 v[48:51], v65 offset:16
  ds_read_b128 v[52:55], v66 offset:16
  ds_read_b128 v[56:59], v67 offset:16
  s_waitcnt lgkmcnt(9)
  v_mfma_f32_16x16x32_bf16 v[148:151], v[16:19], v[76:79], 0
  ds_read_b128 v[60:63], v68 offset:16
  v_mfma_f32_16x16x32_bf16 v[128:131], v[20:23], v[76:79], 0
  ds_read_b128 v[16:19], v69 offset:32
  s_waitcnt lgkmcnt(9)
  v_mfma_f32_16x16x32_bf16 v[132:135], v[24:27], v[76:79], 0
  ds_read_b128 v[20:23], v64 offset:32
  v_mfma_f32_16x16x32_bf16 v[136:139], v[28:31], v[76:79], 0
  ds_read_b128 v[24:27], v65 offset:32
  s_waitcnt lgkmcnt(9)
  v_mfma_f32_16x16x32_bf16 v[140:143], v[32:35], v[76:79], 0
  ds_read_b128 v[28:31], v66 offset:32
  v_mfma_f32_16x16x32_bf16 v[144:147], v[36:39], v[76:79], 0
  ds_read_b128 v[32:35], v67 offset:32
  s_waitcnt lgkmcnt(9)
  v_mfma_f32_16x16x32_bf16 v[148:151], v[40:43], v[80:83], v[148:151]
  ds_read_b128 v[36:39], v68 offset:32
  v_mfma_f32_16x16x32_bf16 v[128:131], v[44:47], v[80:83], v[128:131]
  ds_read_b128 v[40:43], v69 offset:48
  s_waitcnt lgkmcnt(9)
  v_mfma_f32_16x16x32_bf16 v[132:135], v[48:51], v[80:83], v[132:135]
  ds_read_b128 v[44:47], v64 offset:48
  v_mfma_f32_16x16x32_bf16 v[136:139], v[52:55], v[80:83], v[136:139]
  ds_read_b128 v[48:51], v65 offset:48
  s_waitcnt lgkmcnt(9)
  v_mfma_f32_16x16x32_bf16 v[140:143], v[56:59], v[80:83], v[140:143]
  ds_read_b128 v[52:55], v66 offset:48
  v_mfma_f32_16x16x32_bf16 v[144:147], v[60:63], v[80:83], v[144:147]
  ds_read_b128 v[56:59], v67 offset:48
  s_waitcnt lgkmcnt(9)
  v_mfma_f32_16x16x32_bf16 v[148:151], v[16:19], v[84:87], v[148:151]
  ds_read_b128 v[60:63], v68 offset:48
  v_mfma_f32_16x16x32_bf16 v[128:131], v[20:23], v[84:87], v[128:131]
  ds_read_b128 v[16:19], v69 offset:64
  s_waitcnt lgkmcnt(9)
  v_mfma_f32_16x16x32_bf16 v[132:135], v[24:27], v[84:87], v[132:135]
  ds_read_b128 v[20:23], v64 offset:64
  v_mfma_f32_16x16x32_bf16 v[136:139], v[28:31], v[84:87], v[136:139]
  ds_read_b128 v[24:27], v65 offset:64
  s_waitcnt lgkmcnt(9)
  v_mfma_f32_16x16x32_bf16 v[140:143], v[32:35], v[84:87], v[140:143]
  ds_read_b128 v[28:31], v66 offset:64
  v_mfma_f32_16x16x32_bf16 v[144:147], v[36:39], v[84:87], v[144:147]
  ds_read_b128 v[32:35], v67 offset:64
  s_waitcnt lgkmcnt(9)
  v_mfma_f32_16x16x32_bf16 v[148:151], v[40:43], v[88:91], v[148:151]
  ds_read_b128 v[36:39], v68 offset:64
  v_mfma_f32_16x16x32_bf16 v[128:131], v[44:47], v[88:91], v[128:131]
  s_waitcnt lgkmcnt(8)
  v_mfma_f32_16x16x32_bf16 v[132:135], v[48:51], v[88:91], v[132:135]
  v_mfma_f32_16x16x32_bf16 v[136:139], v[52:55], v[88:91], v[136:139]
  s_waitcnt lgkmcnt(6)
  v_mfma_f32_16x16x32_bf16 v[140:143], v[56:59], v[88:91], v[140:143]
  v_mfma_f32_16x16x32_bf16 v[144:147], v[60:63], v[88:91], v[144:147]
  s_waitcnt lgkmcnt(4)
  v_mfma_f32_16x16x32_bf16 v[148:151], v[16:19], v[92:95], v[148:151]
  v_mfma_f32_16x16x32_bf16 v[128:131], v[20:23], v[92:95], v[128:131]
  s_waitcnt lgkmcnt(2)
  v_mfma_f32_16x16x32_bf16 v[132:135], v[24:27], v[92:95], v[132:135]
  v_mfma_f32_16x16x32_bf16 v[136:139], v[28:31], v[92:95], v[136:139]
  s_waitcnt lgkmcnt(0)
  v_mfma_f32_16x16x32_bf16 v[140:143], v[32:35], v[92:95], v[140:143]
  v_mfma_f32_16x16x32_bf16 v[144:147], v[36:39], v[92:95], v[144:147]
  s_nop 0
  v_add_f32 v10, 0x358637bd, v148
  v_rcp_f32 v10, v10
  s_nop 0
  v_pk_mul_f32 v[128:129], v[128:129], v[10:11] op_sel_hi:[1,0]
  v_pk_mul_f32 v[130:131], v[130:131], v[10:11] op_sel_hi:[1,0]
  v_pk_mul_f32 v[132:133], v[132:133], v[10:11] op_sel_hi:[1,0]
  v_pk_mul_f32 v[134:135], v[134:135], v[10:11] op_sel_hi:[1,0]
  v_pk_mul_f32 v[136:137], v[136:137], v[10:11] op_sel_hi:[1,0]
  v_pk_mul_f32 v[138:139], v[138:139], v[10:11] op_sel_hi:[1,0]
  v_pk_mul_f32 v[140:141], v[140:141], v[10:11] op_sel_hi:[1,0]
  v_pk_mul_f32 v[142:143], v[142:143], v[10:11] op_sel_hi:[1,0]
  v_pk_mul_f32 v[144:145], v[144:145], v[10:11] op_sel_hi:[1,0]
  v_pk_mul_f32 v[146:147], v[146:147], v[10:11] op_sel_hi:[1,0]
  v_cvt_pk_bf16_f32 v232, v128, v129
  v_cvt_pk_bf16_f32 v233, v130, v131
  v_cvt_pk_bf16_f32 v234, v132, v133
  v_cvt_pk_bf16_f32 v235, v134, v135
  v_cvt_pk_bf16_f32 v236, v136, v137
  v_cvt_pk_bf16_f32 v237, v138, v139
  v_cvt_pk_bf16_f32 v238, v140, v141
  v_cvt_pk_bf16_f32 v239, v142, v143
  v_cvt_pk_bf16_f32 v240, v144, v145
  v_cvt_pk_bf16_f32 v241, v146, v147
  buffer_store_dwordx4 v[232:235], v8, s[44:47], s13 offen sc1
  buffer_store_dwordx4 v[236:239], v8, s[44:47], s13 offen offset:1024 sc1
  buffer_store_dwordx2 v[240:241], v9, s[44:47], s13 offen offset:2048 sc1
  v_mov_b32 v12, 1
  s_mov_b64 exec, 1
  s_waitcnt vmcnt(0)
  buffer_atomic_add v12, v15, s[44:47], s21 offen sc1
k_end:
  s_endpgm
.section .rodata,"a"
.p2align 6
.amdhsa_kernel concat_heads__sliding_local_dilated__linear_kernel_hedgehog__prompt_kernel
  .amdhsa_next_free_vgpr 256
  .amdhsa_next_free_sgpr 102
  .amdhsa_accum_offset 256
  .amdhsa_group_segment_fixed_size 0
  .amdhsa_kernarg_size 80
  .amdhsa_user_sgpr_count 2
  .amdhsa_user_sgpr_kernarg_segment_ptr 1
  .amdhsa_system_sgpr_workgroup_id_x 1
.end_amdhsa_kernel
```
